```python
import torch

def _softmax(x, axis=-1):
    return torch.softmax(x, dim=axis)
def _gelu(x):
    return torch.nn.functional.gelu(x, approximate="tanh")
def _silu(x):
    return torch.nn.functional.silu(x)
def _sigmoid(x):
    return torch.sigmoid(x)
def _layernorm(x, axis=-1, eps=1e-5):
    m = x.mean(dim=axis, keepdim=True)
    v = x.var(dim=axis, keepdim=True, unbiased=False)
    return (x - m) / torch.sqrt(v + eps)
def _scatter_add(tgt, idx, src, axis=0):
    return tgt.clone().index_add_(axis, idx, src)
def _segment_sum(src, seg, n):
    out = torch.zeros((n,) + src.shape[1:], dtype=src.dtype)
    return out.index_add_(0, seg, src)
def _pad(x, pw):
    flat = tuple(v for pair in reversed(pw) for v in pair)
    return torch.nn.functional.pad(x, flat)

kernel_name = 'sequential_preLN__sliding_block__glu_gated_glu__prompt'

def setup_inputs():

    _w = (lambda a: (lambda t: t.to(torch.bfloat16) if t.is_floating_point() else t)(torch.as_tensor(a)))
    def _A_setup():
        B, S, D = 1, 2048, 640
        return {
            "x": _w((lambda *s: torch.randn(*s, dtype=torch.bfloat16) * 0.05)(B, S, D)),
            "wqkv": _w((lambda *s: torch.randn(*s, dtype=torch.bfloat16) * 0.05)(D, 3 * D)),
            "wo": _w((lambda *s: torch.randn(*s, dtype=torch.bfloat16) * 0.05)(D, D)),
        }
    _A_in = _A_setup()

    def _B_setup():
        B, S, D, F = 1, 2048, 640, 1728
        return {
            "x": _w((lambda *s: torch.randn(*s, dtype=torch.bfloat16) * 0.05)(B, S, D)),
            "w_gate": _w((lambda *s: torch.randn(*s, dtype=torch.bfloat16) * 0.05)(D, F)),
            "w_up": _w((lambda *s: torch.randn(*s, dtype=torch.bfloat16) * 0.05)(D, F)),
            "w_down": _w((lambda *s: torch.randn(*s, dtype=torch.bfloat16) * 0.05)(F, D)),
        }
    _B_in = _B_setup()

    return {
        "A_x": _A_in["x"],
        "A_wqkv": _A_in["wqkv"],
        "A_wo": _A_in["wo"],
        "B_x": _B_in["x"],
        "B_w_gate": _B_in["w_gate"],
        "B_w_up": _B_in["w_up"],
        "B_w_down": _B_in["w_down"],
    }

def reference(A_x, A_wqkv, A_wo, B_x, B_w_gate, B_w_up, B_w_down):
    def _A_ref(x, wqkv, wo):
        B, S, D = x.shape
        H = 32; Dh = D // H; W = 256
        qkv = (lambda x, *d: x.permute(*d))((x @ wqkv).reshape(B, S, 3, H, Dh), 2, 0, 3, 1, 4)
        q, k, v = qkv[0], qkv[1], qkv[2]
        scores = torch.einsum("bhqd,bhkd->bhqk", q, k) * (Dh ** -0.5)
        idx = torch.arange(S)
        mask = (idx[:, None] - idx[None, :] >= 0) & (idx[:, None] - idx[None, :] < W)
        scores = torch.where(mask[None, None], scores, -1e9)
        p = _softmax(scores, axis=-1)
        o = torch.einsum("bhqk,bhkd->bhqd", p, v)
        return (lambda x, *d: x.permute(*d))(o, 0, 2, 1, 3).reshape(B, S, D) @ wo

    def _B_ref(x, w_gate, w_up, w_down):
        g = torch.einsum("bsd,df->bsf", x, w_gate)
        u = torch.einsum("bsd,df->bsf", x, w_up)
        h = _sigmoid(g) * u
        return torch.einsum("bsf,fd->bsd", h, w_down)

    x = A_x
    h = x + _A_ref(_layernorm(x, axis=-1), A_wqkv, A_wo)
    h2 = h + _B_ref(_layernorm(h, axis=-1), B_w_gate, B_w_up, B_w_down)
    return h2
```

```asm
; @launch grid=(256,1,1) block=(512,1,1) lds=163840
.amdgcn_target "amdgcn-amd-amdhsa--gfx950"
.text
.globl sequential_preLN__sliding_block__glu_gated_glu__prompt_kernel
.p2align 8
.type sequential_preLN__sliding_block__glu_gated_glu__prompt_kernel,@function
sequential_preLN__sliding_block__glu_gated_glu__prompt_kernel:
  s_cmp_ge_u32 s2, 256
  s_cbranch_scc1 Lk_end
  s_load_dwordx16 s[60:75], s[0:1], 0
  s_load_dwordx4 s[20:23], s[0:1], 64
  s_getpc_b64 s[98:99]
Lk_pc:
  s_lshr_b32 s25, s2, 3
  v_lshlrev_b32 v2, 5, v0
  v_add_u32 v2, s25, v2
  v_lshlrev_b32 v2, 7, v2
  v_cmp_gt_u32 vcc, Lk_endcode-Lk_pc-4, v2
  s_nop 0
  s_and_saveexec_b64 s[96:97], vcc
  s_cbranch_execz Lk_nt
  global_load_dword v255, v2, s[98:99]
Lk_nt:
  s_mov_b64 exec, -1
  s_and_b32 s24, s2, 7
  v_lshrrev_b32 v4, 6, v0
  v_and_b32 v1, 63, v0
  v_readfirstlane_b32 s26, v4
  s_lshr_b32 s30, s24, 1
  s_lshl_b32 s30, s30, 2
  s_and_b32 s32, s25, 3
  s_add_u32 s30, s30, s32
  s_and_b32 s31, s24, 1
  s_lshl_b32 s31, s31, 3
  s_lshr_b32 s33, s25, 2
  s_add_u32 s31, s31, s33
  v_lshrrev_b32 v13, 3, v1
  v_and_b32 v14, 7, v1
  v_lshrrev_b32 v60, 4, v1
  v_bfe_u32 v61, v1, 2, 2
  v_and_b32 v62, 3, v1
  v_and_b32 v64, 31, v1
  v_lshrrev_b32 v65, 5, v1
  v_mov_b32 v123, 0x7f000000
  s_cmp_lt_u32 s26, 4
  s_cbranch_scc1 LA_comp
  s_cmp_eq_u32 s31, 15
  s_cbranch_scc1 LA_comp
  s_cmp_ge_u32 s26, 6
  s_cbranch_scc1 LA_pk
  s_mul_i32 s40, s32, 3
  s_add_u32 s40, s40, s33
  s_cmp_ge_u32 s40, 10
  s_cselect_b32 s41, 10, 0
  s_sub_u32 s40, s40, s41
  s_cmp_eq_u32 s26, 5
  s_cbranch_scc1 LA_wl
  s_lshl_b32 s36, s30, 7
  v_add_u32 v15, s36, v13
  v_mul_u32_u24 v15, 1280, v15
  v_xor_b32 v66, v14, v60
  v_xor_b32 v63, 4, v66
  v_lshl_add_u32 v2, v66, 4, v15
  v_lshl_add_u32 v3, v63, 4, v15
  s_waitcnt lgkmcnt(0)
  s_mov_b32 s4, s60
  s_mov_b32 s5, s61
  s_mov_b32 s6, 0x280000
  s_mov_b32 s7, 0x20000
  s_mov_b32 s16, s62
  s_mov_b32 s17, s63
  s_mov_b32 s18, 0x258000
  s_mov_b32 s19, 0x20000
  s_mov_b32 s8, s22
  s_mov_b32 s9, s23
  s_mov_b32 s10, 0x2453000
  s_mov_b32 s11, 0x20000
  s_mov_b32 s12, s74
  s_mov_b32 s13, s75
  s_mov_b32 s14, 0x280000
  s_mov_b32 s15, 0x20000
  s_add_u32 s78, s22, 0xff0000
  s_addc_u32 s79, s23, 0
  s_load_dword s27, s[78:79], 0
  s_lshl_b32 s42, s40, 7
  s_mov_b32 m0, 0x0
  s_add_u32 s43, s42, 0x0
  buffer_load_dwordx4 v2, s[4:7], s43 offen  lds
  s_mov_b32 m0, 0x400
  s_add_u32 s43, s42, 0x2800
  buffer_load_dwordx4 v3, s[4:7], s43 offen  lds
  s_mov_b32 m0, 0x800
  s_add_u32 s43, s42, 0x5000
  buffer_load_dwordx4 v2, s[4:7], s43 offen  lds
  s_mov_b32 m0, 0xc00
  s_add_u32 s43, s42, 0x7800
  buffer_load_dwordx4 v3, s[4:7], s43 offen  lds
  s_mov_b32 m0, 0x1000
  s_add_u32 s43, s42, 0xa000
  buffer_load_dwordx4 v2, s[4:7], s43 offen  lds
  s_mov_b32 m0, 0x1400
  s_add_u32 s43, s42, 0xc800
  buffer_load_dwordx4 v3, s[4:7], s43 offen  lds
  s_mov_b32 m0, 0x1800
  s_add_u32 s43, s42, 0xf000
  buffer_load_dwordx4 v2, s[4:7], s43 offen  lds
  s_mov_b32 m0, 0x1c00
  s_add_u32 s43, s42, 0x11800
  buffer_load_dwordx4 v3, s[4:7], s43 offen  lds
  s_mov_b32 m0, 0x2000
  s_add_u32 s43, s42, 0x14000
  buffer_load_dwordx4 v2, s[4:7], s43 offen  lds
  s_mov_b32 m0, 0x2400
  s_add_u32 s43, s42, 0x16800
  buffer_load_dwordx4 v3, s[4:7], s43 offen  lds
  s_mov_b32 m0, 0x2800
  s_add_u32 s43, s42, 0x19000
  buffer_load_dwordx4 v2, s[4:7], s43 offen  lds
  s_mov_b32 m0, 0x2c00
  s_add_u32 s43, s42, 0x1b800
  buffer_load_dwordx4 v3, s[4:7], s43 offen  lds
  s_mov_b32 m0, 0x3000
  s_add_u32 s43, s42, 0x1e000
  buffer_load_dwordx4 v2, s[4:7], s43 offen  lds
  s_mov_b32 m0, 0x3400
  s_add_u32 s43, s42, 0x20800
  buffer_load_dwordx4 v3, s[4:7], s43 offen  lds
  s_mov_b32 m0, 0x3800
  s_add_u32 s43, s42, 0x23000
  buffer_load_dwordx4 v2, s[4:7], s43 offen  lds
  s_mov_b32 m0, 0x3c00
  s_add_u32 s43, s42, 0x25800
  buffer_load_dwordx4 v3, s[4:7], s43 offen  lds
  s_add_u32 s40, s40, 1
  s_cmp_eq_u32 s40, 10
  s_cselect_b32 s40, 0, s40
  s_lshl_b32 s42, s40, 7
  s_mov_b32 m0, 0x8000
  s_add_u32 s43, s42, 0x0
  buffer_load_dwordx4 v2, s[4:7], s43 offen  lds
  s_mov_b32 m0, 0x8400
  s_add_u32 s43, s42, 0x2800
  buffer_load_dwordx4 v3, s[4:7], s43 offen  lds
  s_mov_b32 m0, 0x8800
  s_add_u32 s43, s42, 0x5000
  buffer_load_dwordx4 v2, s[4:7], s43 offen  lds
  s_mov_b32 m0, 0x8c00
  s_add_u32 s43, s42, 0x7800
  buffer_load_dwordx4 v3, s[4:7], s43 offen  lds
  s_mov_b32 m0, 0x9000
  s_add_u32 s43, s42, 0xa000
  buffer_load_dwordx4 v2, s[4:7], s43 offen  lds
  s_mov_b32 m0, 0x9400
  s_add_u32 s43, s42, 0xc800
  buffer_load_dwordx4 v3, s[4:7], s43 offen  lds
  s_mov_b32 m0, 0x9800
  s_add_u32 s43, s42, 0xf000
  buffer_load_dwordx4 v2, s[4:7], s43 offen  lds
  s_mov_b32 m0, 0x9c00
  s_add_u32 s43, s42, 0x11800
  buffer_load_dwordx4 v3, s[4:7], s43 offen  lds
  s_mov_b32 m0, 0xa000
  s_add_u32 s43, s42, 0x14000
  buffer_load_dwordx4 v2, s[4:7], s43 offen  lds
  s_mov_b32 m0, 0xa400
  s_add_u32 s43, s42, 0x16800
  buffer_load_dwordx4 v3, s[4:7], s43 offen  lds
  s_mov_b32 m0, 0xa800
  s_add_u32 s43, s42, 0x19000
  buffer_load_dwordx4 v2, s[4:7], s43 offen  lds
  s_mov_b32 m0, 0xac00
  s_add_u32 s43, s42, 0x1b800
  buffer_load_dwordx4 v3, s[4:7], s43 offen  lds
  s_mov_b32 m0, 0xb000
  s_add_u32 s43, s42, 0x1e000
  buffer_load_dwordx4 v2, s[4:7], s43 offen  lds
  s_mov_b32 m0, 0xb400
  s_add_u32 s43, s42, 0x20800
  buffer_load_dwordx4 v3, s[4:7], s43 offen  lds
  s_mov_b32 m0, 0xb800
  s_add_u32 s43, s42, 0x23000
  buffer_load_dwordx4 v2, s[4:7], s43 offen  lds
  s_mov_b32 m0, 0xbc00
  s_add_u32 s43, s42, 0x25800
  buffer_load_dwordx4 v3, s[4:7], s43 offen  lds
  s_add_u32 s40, s40, 1
  s_cmp_eq_u32 s40, 10
  s_cselect_b32 s40, 0, s40
  v_lshlrev_b32 v41, 4, v1
  s_lshl_b32 s45, s30, 11
  s_add_u32 s45, s45, 0xf50000
  v_lshlrev_b32 v43, 3, v1
  v_add_u32 v43, 0x20000, v43
  s_cmp_lt_u32 s31, 5
  s_cselect_b32 s47, 0x3ea52b5c, 1.0
  v_mov_b32 v38, 0
  v_mov_b32 v46, 0x20400
  ds_write_b32 v46, v38
  ds_write_b32 v46, v38 offset:4
  s_waitcnt lgkmcnt(0)
  s_add_u32 s27, s27, 1
  s_waitcnt vmcnt(16)
  s_barrier
  s_lshl_b32 s42, s40, 7
  s_mov_b32 m0, 0x10000
  s_add_u32 s43, s42, 0x0
  buffer_load_dwordx4 v2, s[4:7], s43 offen  lds
  s_mov_b32 m0, 0x10400
  s_add_u32 s43, s42, 0x2800
  buffer_load_dwordx4 v3, s[4:7], s43 offen  lds
  s_mov_b32 m0, 0x10800
  s_add_u32 s43, s42, 0x5000
  buffer_load_dwordx4 v2, s[4:7], s43 offen  lds
  s_mov_b32 m0, 0x10c00
  s_add_u32 s43, s42, 0x7800
  buffer_load_dwordx4 v3, s[4:7], s43 offen  lds
  s_mov_b32 m0, 0x11000
  s_add_u32 s43, s42, 0xa000
  buffer_load_dwordx4 v2, s[4:7], s43 offen  lds
  s_mov_b32 m0, 0x11400
  s_add_u32 s43, s42, 0xc800
  buffer_load_dwordx4 v3, s[4:7], s43 offen  lds
  s_mov_b32 m0, 0x11800
  s_add_u32 s43, s42, 0xf000
  buffer_load_dwordx4 v2, s[4:7], s43 offen  lds
  s_mov_b32 m0, 0x11c00
  s_add_u32 s43, s42, 0x11800
  buffer_load_dwordx4 v3, s[4:7], s43 offen  lds
  s_mov_b32 m0, 0x12000
  s_add_u32 s43, s42, 0x14000
  buffer_load_dwordx4 v2, s[4:7], s43 offen  lds
  s_mov_b32 m0, 0x12400
  s_add_u32 s43, s42, 0x16800
  buffer_load_dwordx4 v3, s[4:7], s43 offen  lds
  s_mov_b32 m0, 0x12800
  s_add_u32 s43, s42, 0x19000
  buffer_load_dwordx4 v2, s[4:7], s43 offen  lds
  s_mov_b32 m0, 0x12c00
  s_add_u32 s43, s42, 0x1b800
  buffer_load_dwordx4 v3, s[4:7], s43 offen  lds
  s_mov_b32 m0, 0x13000
  s_add_u32 s43, s42, 0x1e000
  buffer_load_dwordx4 v2, s[4:7], s43 offen  lds
  s_mov_b32 m0, 0x13400
  s_add_u32 s43, s42, 0x20800
  buffer_load_dwordx4 v3, s[4:7], s43 offen  lds
  s_mov_b32 m0, 0x13800
  s_add_u32 s43, s42, 0x23000
  buffer_load_dwordx4 v2, s[4:7], s43 offen  lds
  s_mov_b32 m0, 0x13c00
  s_add_u32 s43, s42, 0x25800
  buffer_load_dwordx4 v3, s[4:7], s43 offen  lds
  s_add_u32 s40, s40, 1
  s_cmp_eq_u32 s40, 10
  s_cselect_b32 s40, 0, s40
  s_lshl_b32 s42, s40, 7
  s_mov_b32 m0, 0x18000
  s_add_u32 s43, s42, 0x0
  buffer_load_dwordx4 v2, s[4:7], s43 offen  lds
  s_mov_b32 m0, 0x18400
  s_add_u32 s43, s42, 0x2800
  buffer_load_dwordx4 v3, s[4:7], s43 offen  lds
  s_mov_b32 m0, 0x18800
  s_add_u32 s43, s42, 0x5000
  buffer_load_dwordx4 v2, s[4:7], s43 offen  lds
  s_mov_b32 m0, 0x18c00
  s_add_u32 s43, s42, 0x7800
  buffer_load_dwordx4 v3, s[4:7], s43 offen  lds
  s_mov_b32 m0, 0x19000
  s_add_u32 s43, s42, 0xa000
  buffer_load_dwordx4 v2, s[4:7], s43 offen  lds
  s_mov_b32 m0, 0x19400
  s_add_u32 s43, s42, 0xc800
  buffer_load_dwordx4 v3, s[4:7], s43 offen  lds
  s_mov_b32 m0, 0x19800
  s_add_u32 s43, s42, 0xf000
  buffer_load_dwordx4 v2, s[4:7], s43 offen  lds
  s_mov_b32 m0, 0x19c00
  s_add_u32 s43, s42, 0x11800
  buffer_load_dwordx4 v3, s[4:7], s43 offen  lds
  s_mov_b32 m0, 0x1a000
  s_add_u32 s43, s42, 0x14000
  buffer_load_dwordx4 v2, s[4:7], s43 offen  lds
  s_mov_b32 m0, 0x1a400
  s_add_u32 s43, s42, 0x16800
  buffer_load_dwordx4 v3, s[4:7], s43 offen  lds
  s_mov_b32 m0, 0x1a800
  s_add_u32 s43, s42, 0x19000
  buffer_load_dwordx4 v2, s[4:7], s43 offen  lds
  s_mov_b32 m0, 0x1ac00
  s_add_u32 s43, s42, 0x1b800
  buffer_load_dwordx4 v3, s[4:7], s43 offen  lds
  s_mov_b32 m0, 0x1b000
  s_add_u32 s43, s42, 0x1e000
  buffer_load_dwordx4 v2, s[4:7], s43 offen  lds
  s_mov_b32 m0, 0x1b400
  s_add_u32 s43, s42, 0x20800
  buffer_load_dwordx4 v3, s[4:7], s43 offen  lds
  s_mov_b32 m0, 0x1b800
  s_add_u32 s43, s42, 0x23000
  buffer_load_dwordx4 v2, s[4:7], s43 offen  lds
  s_mov_b32 m0, 0x1bc00
  s_add_u32 s43, s42, 0x25800
  buffer_load_dwordx4 v3, s[4:7], s43 offen  lds
  s_add_u32 s40, s40, 1
  s_cmp_eq_u32 s40, 10
  s_cselect_b32 s40, 0, s40
  s_waitcnt vmcnt(32)
  s_barrier
  s_lshl_b32 s42, s40, 7
  s_mov_b32 m0, 0x0
  s_add_u32 s43, s42, 0x0
  buffer_load_dwordx4 v2, s[4:7], s43 offen  lds
  s_mov_b32 m0, 0x400
  s_add_u32 s43, s42, 0x2800
  buffer_load_dwordx4 v3, s[4:7], s43 offen  lds
  s_mov_b32 m0, 0x800
  s_add_u32 s43, s42, 0x5000
  buffer_load_dwordx4 v2, s[4:7], s43 offen  lds
  s_mov_b32 m0, 0xc00
  s_add_u32 s43, s42, 0x7800
  buffer_load_dwordx4 v3, s[4:7], s43 offen  lds
  s_mov_b32 m0, 0x1000
  s_add_u32 s43, s42, 0xa000
  buffer_load_dwordx4 v2, s[4:7], s43 offen  lds
  s_mov_b32 m0, 0x1400
  s_add_u32 s43, s42, 0xc800
  buffer_load_dwordx4 v3, s[4:7], s43 offen  lds
  s_mov_b32 m0, 0x1800
  s_add_u32 s43, s42, 0xf000
  buffer_load_dwordx4 v2, s[4:7], s43 offen  lds
  s_mov_b32 m0, 0x1c00
  s_add_u32 s43, s42, 0x11800
  buffer_load_dwordx4 v3, s[4:7], s43 offen  lds
  s_mov_b32 m0, 0x2000
  s_add_u32 s43, s42, 0x14000
  buffer_load_dwordx4 v2, s[4:7], s43 offen  lds
  s_mov_b32 m0, 0x2400
  s_add_u32 s43, s42, 0x16800
  buffer_load_dwordx4 v3, s[4:7], s43 offen  lds
  s_mov_b32 m0, 0x2800
  s_add_u32 s43, s42, 0x19000
  buffer_load_dwordx4 v2, s[4:7], s43 offen  lds
  s_mov_b32 m0, 0x2c00
  s_add_u32 s43, s42, 0x1b800
  buffer_load_dwordx4 v3, s[4:7], s43 offen  lds
  s_mov_b32 m0, 0x3000
  s_add_u32 s43, s42, 0x1e000
  buffer_load_dwordx4 v2, s[4:7], s43 offen  lds
  s_mov_b32 m0, 0x3400
  s_add_u32 s43, s42, 0x20800
  buffer_load_dwordx4 v3, s[4:7], s43 offen  lds
  s_mov_b32 m0, 0x3800
  s_add_u32 s43, s42, 0x23000
  buffer_load_dwordx4 v2, s[4:7], s43 offen  lds
  s_mov_b32 m0, 0x3c00
  s_add_u32 s43, s42, 0x25800
  buffer_load_dwordx4 v3, s[4:7], s43 offen  lds
  s_add_u32 s40, s40, 1
  s_cmp_eq_u32 s40, 10
  s_cselect_b32 s40, 0, s40
  s_waitcnt vmcnt(32)
  s_barrier
  s_lshl_b32 s42, s40, 7
  s_mov_b32 m0, 0x8000
  s_add_u32 s43, s42, 0x0
  buffer_load_dwordx4 v2, s[4:7], s43 offen  lds
  s_mov_b32 m0, 0x8400
  s_add_u32 s43, s42, 0x2800
  buffer_load_dwordx4 v3, s[4:7], s43 offen  lds
  s_mov_b32 m0, 0x8800
  s_add_u32 s43, s42, 0x5000
  buffer_load_dwordx4 v2, s[4:7], s43 offen  lds
  s_mov_b32 m0, 0x8c00
  s_add_u32 s43, s42, 0x7800
  buffer_load_dwordx4 v3, s[4:7], s43 offen  lds
  s_mov_b32 m0, 0x9000
  s_add_u32 s43, s42, 0xa000
  buffer_load_dwordx4 v2, s[4:7], s43 offen  lds
  s_mov_b32 m0, 0x9400
  s_add_u32 s43, s42, 0xc800
  buffer_load_dwordx4 v3, s[4:7], s43 offen  lds
  s_mov_b32 m0, 0x9800
  s_add_u32 s43, s42, 0xf000
  buffer_load_dwordx4 v2, s[4:7], s43 offen  lds
  s_mov_b32 m0, 0x9c00
  s_add_u32 s43, s42, 0x11800
  buffer_load_dwordx4 v3, s[4:7], s43 offen  lds
  s_mov_b32 m0, 0xa000
  s_add_u32 s43, s42, 0x14000
  buffer_load_dwordx4 v2, s[4:7], s43 offen  lds
  s_mov_b32 m0, 0xa400
  s_add_u32 s43, s42, 0x16800
  buffer_load_dwordx4 v3, s[4:7], s43 offen  lds
  s_mov_b32 m0, 0xa800
  s_add_u32 s43, s42, 0x19000
  buffer_load_dwordx4 v2, s[4:7], s43 offen  lds
  s_mov_b32 m0, 0xac00
  s_add_u32 s43, s42, 0x1b800
  buffer_load_dwordx4 v3, s[4:7], s43 offen  lds
  s_mov_b32 m0, 0xb000
  s_add_u32 s43, s42, 0x1e000
  buffer_load_dwordx4 v2, s[4:7], s43 offen  lds
  s_mov_b32 m0, 0xb400
  s_add_u32 s43, s42, 0x20800
  buffer_load_dwordx4 v3, s[4:7], s43 offen  lds
  s_mov_b32 m0, 0xb800
  s_add_u32 s43, s42, 0x23000
  buffer_load_dwordx4 v2, s[4:7], s43 offen  lds
  s_mov_b32 m0, 0xbc00
  s_add_u32 s43, s42, 0x25800
  buffer_load_dwordx4 v3, s[4:7], s43 offen  lds
  s_add_u32 s40, s40, 1
  s_cmp_eq_u32 s40, 10
  s_cselect_b32 s40, 0, s40
  s_waitcnt vmcnt(32)
  s_barrier
  s_lshl_b32 s42, s40, 7
  s_mov_b32 m0, 0x10000
  s_add_u32 s43, s42, 0x0
  buffer_load_dwordx4 v2, s[4:7], s43 offen  lds
  s_mov_b32 m0, 0x10400
  s_add_u32 s43, s42, 0x2800
  buffer_load_dwordx4 v3, s[4:7], s43 offen  lds
  s_mov_b32 m0, 0x10800
  s_add_u32 s43, s42, 0x5000
  buffer_load_dwordx4 v2, s[4:7], s43 offen  lds
  s_mov_b32 m0, 0x10c00
  s_add_u32 s43, s42, 0x7800
  buffer_load_dwordx4 v3, s[4:7], s43 offen  lds
  s_mov_b32 m0, 0x11000
  s_add_u32 s43, s42, 0xa000
  buffer_load_dwordx4 v2, s[4:7], s43 offen  lds
  s_mov_b32 m0, 0x11400
  s_add_u32 s43, s42, 0xc800
  buffer_load_dwordx4 v3, s[4:7], s43 offen  lds
  s_mov_b32 m0, 0x11800
  s_add_u32 s43, s42, 0xf000
  buffer_load_dwordx4 v2, s[4:7], s43 offen  lds
  s_mov_b32 m0, 0x11c00
  s_add_u32 s43, s42, 0x11800
  buffer_load_dwordx4 v3, s[4:7], s43 offen  lds
  s_mov_b32 m0, 0x12000
  s_add_u32 s43, s42, 0x14000
  buffer_load_dwordx4 v2, s[4:7], s43 offen  lds
  s_mov_b32 m0, 0x12400
  s_add_u32 s43, s42, 0x16800
  buffer_load_dwordx4 v3, s[4:7], s43 offen  lds
  s_mov_b32 m0, 0x12800
  s_add_u32 s43, s42, 0x19000
  buffer_load_dwordx4 v2, s[4:7], s43 offen  lds
  s_mov_b32 m0, 0x12c00
  s_add_u32 s43, s42, 0x1b800
  buffer_load_dwordx4 v3, s[4:7], s43 offen  lds
  s_mov_b32 m0, 0x13000
  s_add_u32 s43, s42, 0x1e000
  buffer_load_dwordx4 v2, s[4:7], s43 offen  lds
  s_mov_b32 m0, 0x13400
  s_add_u32 s43, s42, 0x20800
  buffer_load_dwordx4 v3, s[4:7], s43 offen  lds
  s_mov_b32 m0, 0x13800
  s_add_u32 s43, s42, 0x23000
  buffer_load_dwordx4 v2, s[4:7], s43 offen  lds
  s_mov_b32 m0, 0x13c00
  s_add_u32 s43, s42, 0x25800
  buffer_load_dwordx4 v3, s[4:7], s43 offen  lds
  s_add_u32 s40, s40, 1
  s_cmp_eq_u32 s40, 10
  s_cselect_b32 s40, 0, s40
  s_waitcnt vmcnt(32)
  s_barrier
  s_lshl_b32 s42, s40, 7
  s_mov_b32 m0, 0x18000
  s_add_u32 s43, s42, 0x0
  buffer_load_dwordx4 v2, s[4:7], s43 offen  lds
  s_mov_b32 m0, 0x18400
  s_add_u32 s43, s42, 0x2800
  buffer_load_dwordx4 v3, s[4:7], s43 offen  lds
  s_mov_b32 m0, 0x18800
  s_add_u32 s43, s42, 0x5000
  buffer_load_dwordx4 v2, s[4:7], s43 offen  lds
  s_mov_b32 m0, 0x18c00
  s_add_u32 s43, s42, 0x7800
  buffer_load_dwordx4 v3, s[4:7], s43 offen  lds
  s_mov_b32 m0, 0x19000
  s_add_u32 s43, s42, 0xa000
  buffer_load_dwordx4 v2, s[4:7], s43 offen  lds
  s_mov_b32 m0, 0x19400
  s_add_u32 s43, s42, 0xc800
  buffer_load_dwordx4 v3, s[4:7], s43 offen  lds
  s_mov_b32 m0, 0x19800
  s_add_u32 s43, s42, 0xf000
  buffer_load_dwordx4 v2, s[4:7], s43 offen  lds
  s_mov_b32 m0, 0x19c00
  s_add_u32 s43, s42, 0x11800
  buffer_load_dwordx4 v3, s[4:7], s43 offen  lds
  s_mov_b32 m0, 0x1a000
  s_add_u32 s43, s42, 0x14000
  buffer_load_dwordx4 v2, s[4:7], s43 offen  lds
  s_mov_b32 m0, 0x1a400
  s_add_u32 s43, s42, 0x16800
  buffer_load_dwordx4 v3, s[4:7], s43 offen  lds
  s_mov_b32 m0, 0x1a800
  s_add_u32 s43, s42, 0x19000
  buffer_load_dwordx4 v2, s[4:7], s43 offen  lds
  s_mov_b32 m0, 0x1ac00
  s_add_u32 s43, s42, 0x1b800
  buffer_load_dwordx4 v3, s[4:7], s43 offen  lds
  s_mov_b32 m0, 0x1b000
  s_add_u32 s43, s42, 0x1e000
  buffer_load_dwordx4 v2, s[4:7], s43 offen  lds
  s_mov_b32 m0, 0x1b400
  s_add_u32 s43, s42, 0x20800
  buffer_load_dwordx4 v3, s[4:7], s43 offen  lds
  s_mov_b32 m0, 0x1b800
  s_add_u32 s43, s42, 0x23000
  buffer_load_dwordx4 v2, s[4:7], s43 offen  lds
  s_mov_b32 m0, 0x1bc00
  s_add_u32 s43, s42, 0x25800
  buffer_load_dwordx4 v3, s[4:7], s43 offen  lds
  s_add_u32 s40, s40, 1
  s_cmp_eq_u32 s40, 10
  s_cselect_b32 s40, 0, s40
  s_waitcnt vmcnt(32)
  s_barrier
  s_lshl_b32 s42, s40, 7
  s_mov_b32 m0, 0x0
  s_add_u32 s43, s42, 0x0
  buffer_load_dwordx4 v2, s[4:7], s43 offen  lds
  s_mov_b32 m0, 0x400
  s_add_u32 s43, s42, 0x2800
  buffer_load_dwordx4 v3, s[4:7], s43 offen  lds
  s_mov_b32 m0, 0x800
  s_add_u32 s43, s42, 0x5000
  buffer_load_dwordx4 v2, s[4:7], s43 offen  lds
  s_mov_b32 m0, 0xc00
  s_add_u32 s43, s42, 0x7800
  buffer_load_dwordx4 v3, s[4:7], s43 offen  lds
  s_mov_b32 m0, 0x1000
  s_add_u32 s43, s42, 0xa000
  buffer_load_dwordx4 v2, s[4:7], s43 offen  lds
  s_mov_b32 m0, 0x1400
  s_add_u32 s43, s42, 0xc800
  buffer_load_dwordx4 v3, s[4:7], s43 offen  lds
  s_mov_b32 m0, 0x1800
  s_add_u32 s43, s42, 0xf000
  buffer_load_dwordx4 v2, s[4:7], s43 offen  lds
  s_mov_b32 m0, 0x1c00
  s_add_u32 s43, s42, 0x11800
  buffer_load_dwordx4 v3, s[4:7], s43 offen  lds
  s_mov_b32 m0, 0x2000
  s_add_u32 s43, s42, 0x14000
  buffer_load_dwordx4 v2, s[4:7], s43 offen  lds
  s_mov_b32 m0, 0x2400
  s_add_u32 s43, s42, 0x16800
  buffer_load_dwordx4 v3, s[4:7], s43 offen  lds
  s_mov_b32 m0, 0x2800
  s_add_u32 s43, s42, 0x19000
  buffer_load_dwordx4 v2, s[4:7], s43 offen  lds
  s_mov_b32 m0, 0x2c00
  s_add_u32 s43, s42, 0x1b800
  buffer_load_dwordx4 v3, s[4:7], s43 offen  lds
  s_mov_b32 m0, 0x3000
  s_add_u32 s43, s42, 0x1e000
  buffer_load_dwordx4 v2, s[4:7], s43 offen  lds
  s_mov_b32 m0, 0x3400
  s_add_u32 s43, s42, 0x20800
  buffer_load_dwordx4 v3, s[4:7], s43 offen  lds
  s_mov_b32 m0, 0x3800
  s_add_u32 s43, s42, 0x23000
  buffer_load_dwordx4 v2, s[4:7], s43 offen  lds
  s_mov_b32 m0, 0x3c00
  s_add_u32 s43, s42, 0x25800
  buffer_load_dwordx4 v3, s[4:7], s43 offen  lds
  s_add_u32 s40, s40, 1
  s_cmp_eq_u32 s40, 10
  s_cselect_b32 s40, 0, s40
  s_waitcnt vmcnt(32)
  s_barrier
  s_lshl_b32 s42, s40, 7
  s_mov_b32 m0, 0x8000
  s_add_u32 s43, s42, 0x0
  buffer_load_dwordx4 v2, s[4:7], s43 offen  lds
  s_mov_b32 m0, 0x8400
  s_add_u32 s43, s42, 0x2800
  buffer_load_dwordx4 v3, s[4:7], s43 offen  lds
  s_mov_b32 m0, 0x8800
  s_add_u32 s43, s42, 0x5000
  buffer_load_dwordx4 v2, s[4:7], s43 offen  lds
  s_mov_b32 m0, 0x8c00
  s_add_u32 s43, s42, 0x7800
  buffer_load_dwordx4 v3, s[4:7], s43 offen  lds
  s_mov_b32 m0, 0x9000
  s_add_u32 s43, s42, 0xa000
  buffer_load_dwordx4 v2, s[4:7], s43 offen  lds
  s_mov_b32 m0, 0x9400
  s_add_u32 s43, s42, 0xc800
  buffer_load_dwordx4 v3, s[4:7], s43 offen  lds
  s_mov_b32 m0, 0x9800
  s_add_u32 s43, s42, 0xf000
  buffer_load_dwordx4 v2, s[4:7], s43 offen  lds
  s_mov_b32 m0, 0x9c00
  s_add_u32 s43, s42, 0x11800
  buffer_load_dwordx4 v3, s[4:7], s43 offen  lds
  s_mov_b32 m0, 0xa000
  s_add_u32 s43, s42, 0x14000
  buffer_load_dwordx4 v2, s[4:7], s43 offen  lds
  s_mov_b32 m0, 0xa400
  s_add_u32 s43, s42, 0x16800
  buffer_load_dwordx4 v3, s[4:7], s43 offen  lds
  s_mov_b32 m0, 0xa800
  s_add_u32 s43, s42, 0x19000
  buffer_load_dwordx4 v2, s[4:7], s43 offen  lds
  s_mov_b32 m0, 0xac00
  s_add_u32 s43, s42, 0x1b800
  buffer_load_dwordx4 v3, s[4:7], s43 offen  lds
  s_mov_b32 m0, 0xb000
  s_add_u32 s43, s42, 0x1e000
  buffer_load_dwordx4 v2, s[4:7], s43 offen  lds
  s_mov_b32 m0, 0xb400
  s_add_u32 s43, s42, 0x20800
  buffer_load_dwordx4 v3, s[4:7], s43 offen  lds
  s_mov_b32 m0, 0xb800
  s_add_u32 s43, s42, 0x23000
  buffer_load_dwordx4 v2, s[4:7], s43 offen  lds
  s_mov_b32 m0, 0xbc00
  s_add_u32 s43, s42, 0x25800
  buffer_load_dwordx4 v3, s[4:7], s43 offen  lds
  s_add_u32 s40, s40, 1
  s_cmp_eq_u32 s40, 10
  s_cselect_b32 s40, 0, s40
  s_add_u32 s46, s45, 0
  buffer_load_dwordx3 v[128:130], v41, s[8:11], s46 offen offset:0 sc1
  buffer_load_dwordx3 v[132:134], v41, s[8:11], s46 offen offset:1024 sc1
  s_waitcnt vmcnt(34)
  s_barrier
  s_waitcnt vmcnt(18)
  s_barrier
  v_mov_b32 v39, s27
  s_mov_b32 s28, 0
  s_waitcnt vmcnt(0)
Lrec1:
  v_xor_b32 v46, v130, v39
  v_xor_b32 v47, v134, v39
  v_or_b32 v46, v46, v47
  v_cmp_ne_u32 vcc, 0, v46
  s_add_u32 s28, s28, 1
  s_nop 4
  s_cbranch_vccz Lrec1ok
  s_cmp_gt_u32 s28, 1000000
  s_cbranch_scc1 Lrec1ok
  s_sleep 8
  s_add_u32 s46, s45, 0
  buffer_load_dwordx3 v[128:130], v41, s[8:11], s46 offen offset:0 sc1
  buffer_load_dwordx3 v[132:134], v41, s[8:11], s46 offen offset:1024 sc1
  s_waitcnt vmcnt(0)
  s_branch Lrec1
Lrec1ok:
  v_mul_f32 v129, s47, v129
  ds_write_b64 v43, v[128:129] offset:0
  v_mul_f32 v133, s47, v133
  ds_write_b64 v43, v[132:133] offset:512
  s_waitcnt lgkmcnt(0)
  s_barrier
  s_barrier
  s_branch LA_b11
LA_wl:
  v_mul_u32_u24 v2, 3840, v61
  v_lshl_add_u32 v2, v60, 6, v2
  v_lshl_add_u32 v2, v62, 4, v2
  s_lshl_b32 s36, s31, 8
  v_add_u32 v2, s36, v2
  v_xor_b32 v3, 32, v2
  s_waitcnt lgkmcnt(0)
  s_mov_b32 s4, s60
  s_mov_b32 s5, s61
  s_mov_b32 s6, 0x280000
  s_mov_b32 s7, 0x20000
  s_mov_b32 s16, s62
  s_mov_b32 s17, s63
  s_mov_b32 s18, 0x258000
  s_mov_b32 s19, 0x20000
  s_mov_b32 s8, s22
  s_mov_b32 s9, s23
  s_mov_b32 s10, 0x2453000
  s_mov_b32 s11, 0x20000
  s_mov_b32 s12, s74
  s_mov_b32 s13, s75
  s_mov_b32 s14, 0x280000
  s_mov_b32 s15, 0x20000
  s_add_u32 s78, s22, 0xff0000
  s_addc_u32 s79, s23, 0
  s_load_dword s27, s[78:79], 0
  s_mul_i32 s42, s40, 245760
  s_mov_b32 m0, 0x4000
  s_add_u32 s43, s42, 0x0
  buffer_load_dwordx4 v2, s[16:19], s43 offen  lds
  s_mov_b32 m0, 0x4400
  s_add_u32 s43, s42, 0x3c00
  buffer_load_dwordx4 v2, s[16:19], s43 offen  lds
  s_mov_b32 m0, 0x4800
  s_add_u32 s43, s42, 0x7800
  buffer_load_dwordx4 v3, s[16:19], s43 offen  lds
  s_mov_b32 m0, 0x4c00
  s_add_u32 s43, s42, 0xb400
  buffer_load_dwordx4 v3, s[16:19], s43 offen  lds
  s_mov_b32 m0, 0x5000
  s_add_u32 s43, s42, 0xf000
  buffer_load_dwordx4 v2, s[16:19], s43 offen  lds
  s_mov_b32 m0, 0x5400
  s_add_u32 s43, s42, 0x12c00
  buffer_load_dwordx4 v2, s[16:19], s43 offen  lds
  s_mov_b32 m0, 0x5800
  s_add_u32 s43, s42, 0x16800
  buffer_load_dwordx4 v3, s[16:19], s43 offen  lds
  s_mov_b32 m0, 0x5c00
  s_add_u32 s43, s42, 0x1a400
  buffer_load_dwordx4 v3, s[16:19], s43 offen  lds
  s_mov_b32 m0, 0x6000
  s_add_u32 s43, s42, 0x1e000
  buffer_load_dwordx4 v2, s[16:19], s43 offen  lds
  s_mov_b32 m0, 0x6400
  s_add_u32 s43, s42, 0x21c00
  buffer_load_dwordx4 v2, s[16:19], s43 offen  lds
  s_mov_b32 m0, 0x6800
  s_add_u32 s43, s42, 0x25800
  buffer_load_dwordx4 v3, s[16:19], s43 offen  lds
  s_mov_b32 m0, 0x6c00
  s_add_u32 s43, s42, 0x29400
  buffer_load_dwordx4 v3, s[16:19], s43 offen  lds
  s_mov_b32 m0, 0x7000
  s_add_u32 s43, s42, 0x2d000
  buffer_load_dwordx4 v2, s[16:19], s43 offen  lds
  s_mov_b32 m0, 0x7400
  s_add_u32 s43, s42, 0x30c00
  buffer_load_dwordx4 v2, s[16:19], s43 offen  lds
  s_mov_b32 m0, 0x7800
  s_add_u32 s43, s42, 0x34800
  buffer_load_dwordx4 v3, s[16:19], s43 offen  lds
  s_mov_b32 m0, 0x7c00
  s_add_u32 s43, s42, 0x38400
  buffer_load_dwordx4 v3, s[16:19], s43 offen  lds
  s_add_u32 s40, s40, 1
  s_cmp_eq_u32 s40, 10
  s_cselect_b32 s40, 0, s40
  s_mul_i32 s42, s40, 245760
  s_mov_b32 m0, 0xc000
  s_add_u32 s43, s42, 0x0
  buffer_load_dwordx4 v2, s[16:19], s43 offen  lds
  s_mov_b32 m0, 0xc400
  s_add_u32 s43, s42, 0x3c00
  buffer_load_dwordx4 v2, s[16:19], s43 offen  lds
  s_mov_b32 m0, 0xc800
  s_add_u32 s43, s42, 0x7800
  buffer_load_dwordx4 v3, s[16:19], s43 offen  lds
  s_mov_b32 m0, 0xcc00
  s_add_u32 s43, s42, 0xb400
  buffer_load_dwordx4 v3, s[16:19], s43 offen  lds
  s_mov_b32 m0, 0xd000
  s_add_u32 s43, s42, 0xf000
  buffer_load_dwordx4 v2, s[16:19], s43 offen  lds
  s_mov_b32 m0, 0xd400
  s_add_u32 s43, s42, 0x12c00
  buffer_load_dwordx4 v2, s[16:19], s43 offen  lds
  s_mov_b32 m0, 0xd800
  s_add_u32 s43, s42, 0x16800
  buffer_load_dwordx4 v3, s[16:19], s43 offen  lds
  s_mov_b32 m0, 0xdc00
  s_add_u32 s43, s42, 0x1a400
  buffer_load_dwordx4 v3, s[16:19], s43 offen  lds
  s_mov_b32 m0, 0xe000
  s_add_u32 s43, s42, 0x1e000
  buffer_load_dwordx4 v2, s[16:19], s43 offen  lds
  s_mov_b32 m0, 0xe400
  s_add_u32 s43, s42, 0x21c00
  buffer_load_dwordx4 v2, s[16:19], s43 offen  lds
  s_mov_b32 m0, 0xe800
  s_add_u32 s43, s42, 0x25800
  buffer_load_dwordx4 v3, s[16:19], s43 offen  lds
  s_mov_b32 m0, 0xec00
  s_add_u32 s43, s42, 0x29400
  buffer_load_dwordx4 v3, s[16:19], s43 offen  lds
  s_mov_b32 m0, 0xf000
  s_add_u32 s43, s42, 0x2d000
  buffer_load_dwordx4 v2, s[16:19], s43 offen  lds
  s_mov_b32 m0, 0xf400
  s_add_u32 s43, s42, 0x30c00
  buffer_load_dwordx4 v2, s[16:19], s43 offen  lds
  s_mov_b32 m0, 0xf800
  s_add_u32 s43, s42, 0x34800
  buffer_load_dwordx4 v3, s[16:19], s43 offen  lds
  s_mov_b32 m0, 0xfc00
  s_add_u32 s43, s42, 0x38400
  buffer_load_dwordx4 v3, s[16:19], s43 offen  lds
  s_add_u32 s40, s40, 1
  s_cmp_eq_u32 s40, 10
  s_cselect_b32 s40, 0, s40
  v_lshlrev_b32 v41, 4, v1
  s_lshl_b32 s45, s31, 14
  s_add_u32 s45, s45, 0xf60000
  v_lshlrev_b32 v44, 8, v61
  v_lshl_add_u32 v44, v62, 4, v44
  v_lshl_add_u32 v44, v65, 6, v44
  v_and_b32 v45, 1, v60
  v_lshl_add_u32 v44, v45, 3, v44
  v_add_u32 v44, 0x14000, v44
  v_xor_b32 v45, 32, v44
  s_waitcnt lgkmcnt(0)
  s_add_u32 s27, s27, 1
  s_waitcnt vmcnt(16)
  s_barrier
  s_mul_i32 s42, s40, 245760
  s_mov_b32 m0, 0x14000
  s_add_u32 s43, s42, 0x0
  buffer_load_dwordx4 v2, s[16:19], s43 offen  lds
  s_mov_b32 m0, 0x14400
  s_add_u32 s43, s42, 0x3c00
  buffer_load_dwordx4 v2, s[16:19], s43 offen  lds
  s_mov_b32 m0, 0x14800
  s_add_u32 s43, s42, 0x7800
  buffer_load_dwordx4 v3, s[16:19], s43 offen  lds
  s_mov_b32 m0, 0x14c00
  s_add_u32 s43, s42, 0xb400
  buffer_load_dwordx4 v3, s[16:19], s43 offen  lds
  s_mov_b32 m0, 0x15000
  s_add_u32 s43, s42, 0xf000
  buffer_load_dwordx4 v2, s[16:19], s43 offen  lds
  s_mov_b32 m0, 0x15400
  s_add_u32 s43, s42, 0x12c00
  buffer_load_dwordx4 v2, s[16:19], s43 offen  lds
  s_mov_b32 m0, 0x15800
  s_add_u32 s43, s42, 0x16800
  buffer_load_dwordx4 v3, s[16:19], s43 offen  lds
  s_mov_b32 m0, 0x15c00
  s_add_u32 s43, s42, 0x1a400
  buffer_load_dwordx4 v3, s[16:19], s43 offen  lds
  s_mov_b32 m0, 0x16000
  s_add_u32 s43, s42, 0x1e000
  buffer_load_dwordx4 v2, s[16:19], s43 offen  lds
  s_mov_b32 m0, 0x16400
  s_add_u32 s43, s42, 0x21c00
  buffer_load_dwordx4 v2, s[16:19], s43 offen  lds
  s_mov_b32 m0, 0x16800
  s_add_u32 s43, s42, 0x25800
  buffer_load_dwordx4 v3, s[16:19], s43 offen  lds
  s_mov_b32 m0, 0x16c00
  s_add_u32 s43, s42, 0x29400
  buffer_load_dwordx4 v3, s[16:19], s43 offen  lds
  s_mov_b32 m0, 0x17000
  s_add_u32 s43, s42, 0x2d000
  buffer_load_dwordx4 v2, s[16:19], s43 offen  lds
  s_mov_b32 m0, 0x17400
  s_add_u32 s43, s42, 0x30c00
  buffer_load_dwordx4 v2, s[16:19], s43 offen  lds
  s_mov_b32 m0, 0x17800
  s_add_u32 s43, s42, 0x34800
  buffer_load_dwordx4 v3, s[16:19], s43 offen  lds
  s_mov_b32 m0, 0x17c00
  s_add_u32 s43, s42, 0x38400
  buffer_load_dwordx4 v3, s[16:19], s43 offen  lds
  s_add_u32 s40, s40, 1
  s_cmp_eq_u32 s40, 10
  s_cselect_b32 s40, 0, s40
  s_mul_i32 s42, s40, 245760
  s_mov_b32 m0, 0x1c000
  s_add_u32 s43, s42, 0x0
  buffer_load_dwordx4 v2, s[16:19], s43 offen  lds
  s_mov_b32 m0, 0x1c400
  s_add_u32 s43, s42, 0x3c00
  buffer_load_dwordx4 v2, s[16:19], s43 offen  lds
  s_mov_b32 m0, 0x1c800
  s_add_u32 s43, s42, 0x7800
  buffer_load_dwordx4 v3, s[16:19], s43 offen  lds
  s_mov_b32 m0, 0x1cc00
  s_add_u32 s43, s42, 0xb400
  buffer_load_dwordx4 v3, s[16:19], s43 offen  lds
  s_mov_b32 m0, 0x1d000
  s_add_u32 s43, s42, 0xf000
  buffer_load_dwordx4 v2, s[16:19], s43 offen  lds
  s_mov_b32 m0, 0x1d400
  s_add_u32 s43, s42, 0x12c00
  buffer_load_dwordx4 v2, s[16:19], s43 offen  lds
  s_mov_b32 m0, 0x1d800
  s_add_u32 s43, s42, 0x16800
  buffer_load_dwordx4 v3, s[16:19], s43 offen  lds
  s_mov_b32 m0, 0x1dc00
  s_add_u32 s43, s42, 0x1a400
  buffer_load_dwordx4 v3, s[16:19], s43 offen  lds
  s_mov_b32 m0, 0x1e000
  s_add_u32 s43, s42, 0x1e000
  buffer_load_dwordx4 v2, s[16:19], s43 offen  lds
  s_mov_b32 m0, 0x1e400
  s_add_u32 s43, s42, 0x21c00
  buffer_load_dwordx4 v2, s[16:19], s43 offen  lds
  s_mov_b32 m0, 0x1e800
  s_add_u32 s43, s42, 0x25800
  buffer_load_dwordx4 v3, s[16:19], s43 offen  lds
  s_mov_b32 m0, 0x1ec00
  s_add_u32 s43, s42, 0x29400
  buffer_load_dwordx4 v3, s[16:19], s43 offen  lds
  s_mov_b32 m0, 0x1f000
  s_add_u32 s43, s42, 0x2d000
  buffer_load_dwordx4 v2, s[16:19], s43 offen  lds
  s_mov_b32 m0, 0x1f400
  s_add_u32 s43, s42, 0x30c00
  buffer_load_dwordx4 v2, s[16:19], s43 offen  lds
  s_mov_b32 m0, 0x1f800
  s_add_u32 s43, s42, 0x34800
  buffer_load_dwordx4 v3, s[16:19], s43 offen  lds
  s_mov_b32 m0, 0x1fc00
  s_add_u32 s43, s42, 0x38400
  buffer_load_dwordx4 v3, s[16:19], s43 offen  lds
  s_add_u32 s40, s40, 1
  s_cmp_eq_u32 s40, 10
  s_cselect_b32 s40, 0, s40
  s_waitcnt vmcnt(32)
  s_barrier
  s_mul_i32 s42, s40, 245760
  s_mov_b32 m0, 0x4000
  s_add_u32 s43, s42, 0x0
  buffer_load_dwordx4 v2, s[16:19], s43 offen  lds
  s_mov_b32 m0, 0x4400
  s_add_u32 s43, s42, 0x3c00
  buffer_load_dwordx4 v2, s[16:19], s43 offen  lds
  s_mov_b32 m0, 0x4800
  s_add_u32 s43, s42, 0x7800
  buffer_load_dwordx4 v3, s[16:19], s43 offen  lds
  s_mov_b32 m0, 0x4c00
  s_add_u32 s43, s42, 0xb400
  buffer_load_dwordx4 v3, s[16:19], s43 offen  lds
  s_mov_b32 m0, 0x5000
  s_add_u32 s43, s42, 0xf000
  buffer_load_dwordx4 v2, s[16:19], s43 offen  lds
  s_mov_b32 m0, 0x5400
  s_add_u32 s43, s42, 0x12c00
  buffer_load_dwordx4 v2, s[16:19], s43 offen  lds
  s_mov_b32 m0, 0x5800
  s_add_u32 s43, s42, 0x16800
  buffer_load_dwordx4 v3, s[16:19], s43 offen  lds
  s_mov_b32 m0, 0x5c00
  s_add_u32 s43, s42, 0x1a400
  buffer_load_dwordx4 v3, s[16:19], s43 offen  lds
  s_mov_b32 m0, 0x6000
  s_add_u32 s43, s42, 0x1e000
  buffer_load_dwordx4 v2, s[16:19], s43 offen  lds
  s_mov_b32 m0, 0x6400
  s_add_u32 s43, s42, 0x21c00
  buffer_load_dwordx4 v2, s[16:19], s43 offen  lds
  s_mov_b32 m0, 0x6800
  s_add_u32 s43, s42, 0x25800
  buffer_load_dwordx4 v3, s[16:19], s43 offen  lds
  s_mov_b32 m0, 0x6c00
  s_add_u32 s43, s42, 0x29400
  buffer_load_dwordx4 v3, s[16:19], s43 offen  lds
  s_mov_b32 m0, 0x7000
  s_add_u32 s43, s42, 0x2d000
  buffer_load_dwordx4 v2, s[16:19], s43 offen  lds
  s_mov_b32 m0, 0x7400
  s_add_u32 s43, s42, 0x30c00
  buffer_load_dwordx4 v2, s[16:19], s43 offen  lds
  s_mov_b32 m0, 0x7800
  s_add_u32 s43, s42, 0x34800
  buffer_load_dwordx4 v3, s[16:19], s43 offen  lds
  s_mov_b32 m0, 0x7c00
  s_add_u32 s43, s42, 0x38400
  buffer_load_dwordx4 v3, s[16:19], s43 offen  lds
  s_add_u32 s40, s40, 1
  s_cmp_eq_u32 s40, 10
  s_cselect_b32 s40, 0, s40
  s_waitcnt vmcnt(32)
  s_barrier
  s_mul_i32 s42, s40, 245760
  s_mov_b32 m0, 0xc000
  s_add_u32 s43, s42, 0x0
  buffer_load_dwordx4 v2, s[16:19], s43 offen  lds
  s_mov_b32 m0, 0xc400
  s_add_u32 s43, s42, 0x3c00
  buffer_load_dwordx4 v2, s[16:19], s43 offen  lds
  s_mov_b32 m0, 0xc800
  s_add_u32 s43, s42, 0x7800
  buffer_load_dwordx4 v3, s[16:19], s43 offen  lds
  s_mov_b32 m0, 0xcc00
  s_add_u32 s43, s42, 0xb400
  buffer_load_dwordx4 v3, s[16:19], s43 offen  lds
  s_mov_b32 m0, 0xd000
  s_add_u32 s43, s42, 0xf000
  buffer_load_dwordx4 v2, s[16:19], s43 offen  lds
  s_mov_b32 m0, 0xd400
  s_add_u32 s43, s42, 0x12c00
  buffer_load_dwordx4 v2, s[16:19], s43 offen  lds
  s_mov_b32 m0, 0xd800
  s_add_u32 s43, s42, 0x16800
  buffer_load_dwordx4 v3, s[16:19], s43 offen  lds
  s_mov_b32 m0, 0xdc00
  s_add_u32 s43, s42, 0x1a400
  buffer_load_dwordx4 v3, s[16:19], s43 offen  lds
  s_mov_b32 m0, 0xe000
  s_add_u32 s43, s42, 0x1e000
  buffer_load_dwordx4 v2, s[16:19], s43 offen  lds
  s_mov_b32 m0, 0xe400
  s_add_u32 s43, s42, 0x21c00
  buffer_load_dwordx4 v2, s[16:19], s43 offen  lds
  s_mov_b32 m0, 0xe800
  s_add_u32 s43, s42, 0x25800
  buffer_load_dwordx4 v3, s[16:19], s43 offen  lds
  s_mov_b32 m0, 0xec00
  s_add_u32 s43, s42, 0x29400
  buffer_load_dwordx4 v3, s[16:19], s43 offen  lds
  s_mov_b32 m0, 0xf000
  s_add_u32 s43, s42, 0x2d000
  buffer_load_dwordx4 v2, s[16:19], s43 offen  lds
  s_mov_b32 m0, 0xf400
  s_add_u32 s43, s42, 0x30c00
  buffer_load_dwordx4 v2, s[16:19], s43 offen  lds
  s_mov_b32 m0, 0xf800
  s_add_u32 s43, s42, 0x34800
  buffer_load_dwordx4 v3, s[16:19], s43 offen  lds
  s_mov_b32 m0, 0xfc00
  s_add_u32 s43, s42, 0x38400
  buffer_load_dwordx4 v3, s[16:19], s43 offen  lds
  s_add_u32 s40, s40, 1
  s_cmp_eq_u32 s40, 10
  s_cselect_b32 s40, 0, s40
  s_waitcnt vmcnt(32)
  s_barrier
  s_mul_i32 s42, s40, 245760
  s_mov_b32 m0, 0x14000
  s_add_u32 s43, s42, 0x0
  buffer_load_dwordx4 v2, s[16:19], s43 offen  lds
  s_mov_b32 m0, 0x14400
  s_add_u32 s43, s42, 0x3c00
  buffer_load_dwordx4 v2, s[16:19], s43 offen  lds
  s_mov_b32 m0, 0x14800
  s_add_u32 s43, s42, 0x7800
  buffer_load_dwordx4 v3, s[16:19], s43 offen  lds
  s_mov_b32 m0, 0x14c00
  s_add_u32 s43, s42, 0xb400
  buffer_load_dwordx4 v3, s[16:19], s43 offen  lds
  s_mov_b32 m0, 0x15000
  s_add_u32 s43, s42, 0xf000
  buffer_load_dwordx4 v2, s[16:19], s43 offen  lds
  s_mov_b32 m0, 0x15400
  s_add_u32 s43, s42, 0x12c00
  buffer_load_dwordx4 v2, s[16:19], s43 offen  lds
  s_mov_b32 m0, 0x15800
  s_add_u32 s43, s42, 0x16800
  buffer_load_dwordx4 v3, s[16:19], s43 offen  lds
  s_mov_b32 m0, 0x15c00
  s_add_u32 s43, s42, 0x1a400
  buffer_load_dwordx4 v3, s[16:19], s43 offen  lds
  s_mov_b32 m0, 0x16000
  s_add_u32 s43, s42, 0x1e000
  buffer_load_dwordx4 v2, s[16:19], s43 offen  lds
  s_mov_b32 m0, 0x16400
  s_add_u32 s43, s42, 0x21c00
  buffer_load_dwordx4 v2, s[16:19], s43 offen  lds
  s_mov_b32 m0, 0x16800
  s_add_u32 s43, s42, 0x25800
  buffer_load_dwordx4 v3, s[16:19], s43 offen  lds
  s_mov_b32 m0, 0x16c00
  s_add_u32 s43, s42, 0x29400
  buffer_load_dwordx4 v3, s[16:19], s43 offen  lds
  s_mov_b32 m0, 0x17000
  s_add_u32 s43, s42, 0x2d000
  buffer_load_dwordx4 v2, s[16:19], s43 offen  lds
  s_mov_b32 m0, 0x17400
  s_add_u32 s43, s42, 0x30c00
  buffer_load_dwordx4 v2, s[16:19], s43 offen  lds
  s_mov_b32 m0, 0x17800
  s_add_u32 s43, s42, 0x34800
  buffer_load_dwordx4 v3, s[16:19], s43 offen  lds
  s_mov_b32 m0, 0x17c00
  s_add_u32 s43, s42, 0x38400
  buffer_load_dwordx4 v3, s[16:19], s43 offen  lds
  s_add_u32 s40, s40, 1
  s_cmp_eq_u32 s40, 10
  s_cselect_b32 s40, 0, s40
  s_waitcnt vmcnt(32)
  s_barrier
  s_mul_i32 s42, s40, 245760
  s_mov_b32 m0, 0x1c000
  s_add_u32 s43, s42, 0x0
  buffer_load_dwordx4 v2, s[16:19], s43 offen  lds
  s_mov_b32 m0, 0x1c400
  s_add_u32 s43, s42, 0x3c00
  buffer_load_dwordx4 v2, s[16:19], s43 offen  lds
  s_mov_b32 m0, 0x1c800
  s_add_u32 s43, s42, 0x7800
  buffer_load_dwordx4 v3, s[16:19], s43 offen  lds
  s_mov_b32 m0, 0x1cc00
  s_add_u32 s43, s42, 0xb400
  buffer_load_dwordx4 v3, s[16:19], s43 offen  lds
  s_mov_b32 m0, 0x1d000
  s_add_u32 s43, s42, 0xf000
  buffer_load_dwordx4 v2, s[16:19], s43 offen  lds
  s_mov_b32 m0, 0x1d400
  s_add_u32 s43, s42, 0x12c00
  buffer_load_dwordx4 v2, s[16:19], s43 offen  lds
  s_mov_b32 m0, 0x1d800
  s_add_u32 s43, s42, 0x16800
  buffer_load_dwordx4 v3, s[16:19], s43 offen  lds
  s_mov_b32 m0, 0x1dc00
  s_add_u32 s43, s42, 0x1a400
  buffer_load_dwordx4 v3, s[16:19], s43 offen  lds
  s_mov_b32 m0, 0x1e000
  s_add_u32 s43, s42, 0x1e000
  buffer_load_dwordx4 v2, s[16:19], s43 offen  lds
  s_mov_b32 m0, 0x1e400
  s_add_u32 s43, s42, 0x21c00
  buffer_load_dwordx4 v2, s[16:19], s43 offen  lds
  s_mov_b32 m0, 0x1e800
  s_add_u32 s43, s42, 0x25800
  buffer_load_dwordx4 v3, s[16:19], s43 offen  lds
  s_mov_b32 m0, 0x1ec00
  s_add_u32 s43, s42, 0x29400
  buffer_load_dwordx4 v3, s[16:19], s43 offen  lds
  s_mov_b32 m0, 0x1f000
  s_add_u32 s43, s42, 0x2d000
  buffer_load_dwordx4 v2, s[16:19], s43 offen  lds
  s_mov_b32 m0, 0x1f400
  s_add_u32 s43, s42, 0x30c00
  buffer_load_dwordx4 v2, s[16:19], s43 offen  lds
  s_mov_b32 m0, 0x1f800
  s_add_u32 s43, s42, 0x34800
  buffer_load_dwordx4 v3, s[16:19], s43 offen  lds
  s_mov_b32 m0, 0x1fc00
  s_add_u32 s43, s42, 0x38400
  buffer_load_dwordx4 v3, s[16:19], s43 offen  lds
  s_add_u32 s40, s40, 1
  s_cmp_eq_u32 s40, 10
  s_cselect_b32 s40, 0, s40
  s_waitcnt vmcnt(32)
  s_barrier
  s_mul_i32 s42, s40, 245760
  s_mov_b32 m0, 0x4000
  s_add_u32 s43, s42, 0x0
  buffer_load_dwordx4 v2, s[16:19], s43 offen  lds
  s_mov_b32 m0, 0x4400
  s_add_u32 s43, s42, 0x3c00
  buffer_load_dwordx4 v2, s[16:19], s43 offen  lds
  s_mov_b32 m0, 0x4800
  s_add_u32 s43, s42, 0x7800
  buffer_load_dwordx4 v3, s[16:19], s43 offen  lds
  s_mov_b32 m0, 0x4c00
  s_add_u32 s43, s42, 0xb400
  buffer_load_dwordx4 v3, s[16:19], s43 offen  lds
  s_mov_b32 m0, 0x5000
  s_add_u32 s43, s42, 0xf000
  buffer_load_dwordx4 v2, s[16:19], s43 offen  lds
  s_mov_b32 m0, 0x5400
  s_add_u32 s43, s42, 0x12c00
  buffer_load_dwordx4 v2, s[16:19], s43 offen  lds
  s_mov_b32 m0, 0x5800
  s_add_u32 s43, s42, 0x16800
  buffer_load_dwordx4 v3, s[16:19], s43 offen  lds
  s_mov_b32 m0, 0x5c00
  s_add_u32 s43, s42, 0x1a400
  buffer_load_dwordx4 v3, s[16:19], s43 offen  lds
  s_mov_b32 m0, 0x6000
  s_add_u32 s43, s42, 0x1e000
  buffer_load_dwordx4 v2, s[16:19], s43 offen  lds
  s_mov_b32 m0, 0x6400
  s_add_u32 s43, s42, 0x21c00
  buffer_load_dwordx4 v2, s[16:19], s43 offen  lds
  s_mov_b32 m0, 0x6800
  s_add_u32 s43, s42, 0x25800
  buffer_load_dwordx4 v3, s[16:19], s43 offen  lds
  s_mov_b32 m0, 0x6c00
  s_add_u32 s43, s42, 0x29400
  buffer_load_dwordx4 v3, s[16:19], s43 offen  lds
  s_mov_b32 m0, 0x7000
  s_add_u32 s43, s42, 0x2d000
  buffer_load_dwordx4 v2, s[16:19], s43 offen  lds
  s_mov_b32 m0, 0x7400
  s_add_u32 s43, s42, 0x30c00
  buffer_load_dwordx4 v2, s[16:19], s43 offen  lds
  s_mov_b32 m0, 0x7800
  s_add_u32 s43, s42, 0x34800
  buffer_load_dwordx4 v3, s[16:19], s43 offen  lds
  s_mov_b32 m0, 0x7c00
  s_add_u32 s43, s42, 0x38400
  buffer_load_dwordx4 v3, s[16:19], s43 offen  lds
  s_add_u32 s40, s40, 1
  s_cmp_eq_u32 s40, 10
  s_cselect_b32 s40, 0, s40
  s_waitcnt vmcnt(32)
  s_barrier
  s_mul_i32 s42, s40, 245760
  s_mov_b32 m0, 0xc000
  s_add_u32 s43, s42, 0x0
  buffer_load_dwordx4 v2, s[16:19], s43 offen  lds
  s_mov_b32 m0, 0xc400
  s_add_u32 s43, s42, 0x3c00
  buffer_load_dwordx4 v2, s[16:19], s43 offen  lds
  s_mov_b32 m0, 0xc800
  s_add_u32 s43, s42, 0x7800
  buffer_load_dwordx4 v3, s[16:19], s43 offen  lds
  s_mov_b32 m0, 0xcc00
  s_add_u32 s43, s42, 0xb400
  buffer_load_dwordx4 v3, s[16:19], s43 offen  lds
  s_mov_b32 m0, 0xd000
  s_add_u32 s43, s42, 0xf000
  buffer_load_dwordx4 v2, s[16:19], s43 offen  lds
  s_mov_b32 m0, 0xd400
  s_add_u32 s43, s42, 0x12c00
  buffer_load_dwordx4 v2, s[16:19], s43 offen  lds
  s_mov_b32 m0, 0xd800
  s_add_u32 s43, s42, 0x16800
  buffer_load_dwordx4 v3, s[16:19], s43 offen  lds
  s_mov_b32 m0, 0xdc00
  s_add_u32 s43, s42, 0x1a400
  buffer_load_dwordx4 v3, s[16:19], s43 offen  lds
  s_mov_b32 m0, 0xe000
  s_add_u32 s43, s42, 0x1e000
  buffer_load_dwordx4 v2, s[16:19], s43 offen  lds
  s_mov_b32 m0, 0xe400
  s_add_u32 s43, s42, 0x21c00
  buffer_load_dwordx4 v2, s[16:19], s43 offen  lds
  s_mov_b32 m0, 0xe800
  s_add_u32 s43, s42, 0x25800
  buffer_load_dwordx4 v3, s[16:19], s43 offen  lds
  s_mov_b32 m0, 0xec00
  s_add_u32 s43, s42, 0x29400
  buffer_load_dwordx4 v3, s[16:19], s43 offen  lds
  s_mov_b32 m0, 0xf000
  s_add_u32 s43, s42, 0x2d000
  buffer_load_dwordx4 v2, s[16:19], s43 offen  lds
  s_mov_b32 m0, 0xf400
  s_add_u32 s43, s42, 0x30c00
  buffer_load_dwordx4 v2, s[16:19], s43 offen  lds
  s_mov_b32 m0, 0xf800
  s_add_u32 s43, s42, 0x34800
  buffer_load_dwordx4 v3, s[16:19], s43 offen  lds
  s_mov_b32 m0, 0xfc00
  s_add_u32 s43, s42, 0x38400
  buffer_load_dwordx4 v3, s[16:19], s43 offen  lds
  s_add_u32 s40, s40, 1
  s_cmp_eq_u32 s40, 10
  s_cselect_b32 s40, 0, s40
  s_waitcnt vmcnt(32)
  s_barrier
  s_waitcnt vmcnt(16)
  s_barrier
  s_waitcnt vmcnt(0)
  s_barrier
  s_barrier
  s_branch LA_b11
LA_pk:
  v_lshlrev_b32 v40, 4, v64
  v_lshlrev_b32 v41, 4, v1
  v_mov_b32 v38, 0
  s_mul_i32 s34, s30, 15
  s_add_u32 s34, s34, s31
  v_and_b32 v66, 15, v1
  v_mul_u32_u24 v69, 3840, v60
  v_lshl_add_u32 v69, v66, 4, v69
  s_mul_i32 s37, s30, 153600
  s_lshl_b32 s38, s31, 8
  s_add_u32 s37, s37, s38
  s_waitcnt lgkmcnt(0)
  s_mov_b32 s4, s60
  s_mov_b32 s5, s61
  s_mov_b32 s6, 0x280000
  s_mov_b32 s7, 0x20000
  s_mov_b32 s16, s62
  s_mov_b32 s17, s63
  s_mov_b32 s18, 0x258000
  s_mov_b32 s19, 0x20000
  s_mov_b32 s8, s22
  s_mov_b32 s9, s23
  s_mov_b32 s10, 0x2453000
  s_mov_b32 s11, 0x20000
  s_mov_b32 s12, s74
  s_mov_b32 s13, s75
  s_mov_b32 s14, 0x280000
  s_mov_b32 s15, 0x20000
  s_add_u32 s78, s22, 0xff0000
  s_addc_u32 s79, s23, 0
  s_load_dword s27, s[78:79], 0
  s_cmp_eq_u32 s26, 7
  s_cbranch_scc1 LA_pl
  s_mov_b32 s48, s68
  s_mov_b32 s49, s69
  s_mov_b32 s50, 0x21c000
  s_mov_b32 s51, 0x20000
  s_mov_b32 s52, s70
  s_mov_b32 s53, s71
  s_mov_b32 s54, 0x21c000
  s_mov_b32 s55, 0x20000
  s_lshr_b32 s44, s34, 3
  s_and_b32 s45, s34, 7
  s_mul_i32 s56, s45, 276480
  s_lshl_b32 s57, s44, 7
  s_add_u32 s56, s56, s57
  s_mul_i32 s57, s44, 167936
  s_add_u32 s57, s57, 0x2000000
  s_lshr_b32 s58, s45, 2
  s_lshl_b32 s58, s58, 9
  s_and_b32 s59, s45, 3
  s_lshl_b32 s59, s59, 2
  s_add_u32 s58, s58, s59
  s_add_u32 s58, s58, s57
  s_add_u32 s58, s58, 40960
  s_mul_i32 s59, s45, 5120
  s_add_u32 s57, s57, s59
  s_lshl_b32 s59, s34, 2
  s_lshl_b32 s59, s59, 5
  s_add_u32 s59, s59, 0x1e00000
  s_cmp_lt_u32 s34, 216
  s_cselect_b32 s44, s56, 0
  s_cselect_b32 s56, s56, 0x7f000000
  s_add_u32 s40, s68, s44
  s_addc_u32 s41, s69, 0
  s_add_u32 s42, s70, s44
  s_addc_u32 s43, s71, 0
  v_mul_u32_u24 v52, 3456, v13
  v_lshl_add_u32 v52, v14, 4, v52
  v_and_b32 v54, 1, v60
  v_lshlrev_b32 v53, 11, v54
  v_lshl_add_u32 v53, v65, 10, v53
  v_lshl_add_u32 v53, v61, 7, v53
  v_and_b32 v55, 1, v1
  v_lshl_add_u32 v53, v55, 4, v53
  v_bfe_u32 v55, v1, 1, 1
  v_lshl_add_u32 v53, v55, 3, v53
  v_add_u32 v53, 0x21000, v53
  v_and_b32 v55, 1, v61
  v_cmp_eq_u32 vcc, v54, v55
  v_mov_b32 v55, 0x3f803f80
  s_nop 0
  v_cndmask_b32 v28, 0, v55, vcc
  v_mov_b32 v29, v28
  v_mov_b32 v30, v28
  v_mov_b32 v31, v28
  v_mov_b32 v55, 0xffff
  s_waitcnt lgkmcnt(0)
  s_add_u32 s27, s27, 1
  s_lshl_b32 s35, s31, 14
  s_and_b32 s36, s26, 1
  s_lshl_b32 s39, s36, 13
  s_add_u32 s35, s35, s39
  s_add_u32 s35, s35, 0xf60000
  v_lshlrev_b32 v44, 8, v61
  v_lshl_add_u32 v44, v62, 4, v44
  v_lshl_add_u32 v44, v65, 6, v44
  v_and_b32 v45, 1, v60
  v_lshl_add_u32 v44, v45, 3, v44
  s_lshl_b32 s36, s36, 12
  s_add_u32 s36, s36, 0x14000
  v_add_u32 v44, s36, v44
  v_xor_b32 v45, 32, v44
  v_mov_b32 v39, s27
  s_barrier
  s_barrier
  s_barrier
  s_barrier
  s_barrier
  s_barrier
  s_add_u32 s39, s35, 0
  buffer_load_dwordx3 v[160:162], v41, s[8:11], s39 offen offset:0 sc1
  buffer_load_dwordx3 v[164:166], v41, s[8:11], s39 offen offset:1024 sc1
  buffer_load_dwordx3 v[168:170], v41, s[8:11], s39 offen offset:2048 sc1
  buffer_load_dwordx3 v[172:174], v41, s[8:11], s39 offen offset:3072 sc1
  s_barrier
  s_add_u32 s39, s35, 4096
  buffer_load_dwordx3 v[176:178], v41, s[8:11], s39 offen offset:0 sc1
  buffer_load_dwordx3 v[180:182], v41, s[8:11], s39 offen offset:1024 sc1
  buffer_load_dwordx3 v[184:186], v41, s[8:11], s39 offen offset:2048 sc1
  buffer_load_dwordx3 v[188:190], v41, s[8:11], s39 offen offset:3072 sc1
  s_barrier
  s_mov_b32 m0, 0x21000
  s_add_u32 s44, s56, 0x0
  buffer_load_dwordx4 v52, s[48:51], s44 offen nt lds
  s_mov_b32 m0, 0x21400
  s_add_u32 s44, s56, 0x6c00
  buffer_load_dwordx4 v52, s[48:51], s44 offen nt lds
  s_mov_b32 m0, 0x21800
  s_add_u32 s44, s56, 0x0
  buffer_load_dwordx4 v52, s[52:55], s44 offen nt lds
  s_mov_b32 m0, 0x21c00
  s_add_u32 s44, s56, 0x6c00
  buffer_load_dwordx4 v52, s[52:55], s44 offen nt lds
  s_mov_b32 m0, 0x22000
  s_add_u32 s44, s56, 0xd800
  buffer_load_dwordx4 v52, s[48:51], s44 offen nt lds
  s_mov_b32 m0, 0x22400
  s_add_u32 s44, s56, 0x14400
  buffer_load_dwordx4 v52, s[48:51], s44 offen nt lds
  s_mov_b32 m0, 0x22800
  s_add_u32 s44, s56, 0xd800
  buffer_load_dwordx4 v52, s[52:55], s44 offen nt lds
  s_mov_b32 m0, 0x22c00
  s_add_u32 s44, s56, 0x14400
  buffer_load_dwordx4 v52, s[52:55], s44 offen nt lds
  s_mov_b32 m0, 0x23000
  s_add_u32 s44, s56, 0x1b000
  buffer_load_dwordx4 v52, s[48:51], s44 offen nt lds
  s_mov_b32 m0, 0x23400
  s_add_u32 s44, s56, 0x21c00
  buffer_load_dwordx4 v52, s[48:51], s44 offen nt lds
  s_mov_b32 m0, 0x23800
  s_add_u32 s44, s56, 0x1b000
  buffer_load_dwordx4 v52, s[52:55], s44 offen nt lds
  s_mov_b32 m0, 0x23c00
  s_add_u32 s44, s56, 0x21c00
  buffer_load_dwordx4 v52, s[52:55], s44 offen nt lds
  s_mov_b32 m0, 0x24000
  s_add_u32 s44, s56, 0x28800
  buffer_load_dwordx4 v52, s[48:51], s44 offen nt lds
  s_mov_b32 m0, 0x24400
  s_add_u32 s44, s56, 0x2f400
  buffer_load_dwordx4 v52, s[48:51], s44 offen nt lds
  s_mov_b32 m0, 0x24800
  s_add_u32 s44, s56, 0x28800
  buffer_load_dwordx4 v52, s[52:55], s44 offen nt lds
  s_mov_b32 m0, 0x24c00
  s_add_u32 s44, s56, 0x2f400
  buffer_load_dwordx4 v52, s[52:55], s44 offen nt lds
  s_mov_b32 m0, 0x25000
  s_add_u32 s44, s56, 0x36000
  buffer_load_dwordx4 v52, s[48:51], s44 offen nt lds
  s_mov_b32 m0, 0x25400
  s_add_u32 s44, s56, 0x3cc00
  buffer_load_dwordx4 v52, s[48:51], s44 offen nt lds
  s_mov_b32 m0, 0x25800
  s_add_u32 s44, s56, 0x36000
  buffer_load_dwordx4 v52, s[52:55], s44 offen nt lds
  s_mov_b32 m0, 0x25c00
  s_add_u32 s44, s56, 0x3cc00
  buffer_load_dwordx4 v52, s[52:55], s44 offen nt lds
  s_barrier
  s_mov_b32 s28, 0
  s_waitcnt vmcnt(20)
Lrec2:
  v_xor_b32 v46, v162, v39
  v_xor_b32 v47, v166, v39
  v_or_b32 v46, v46, v47
  v_xor_b32 v47, v170, v39
  v_or_b32 v46, v46, v47
  v_xor_b32 v47, v174, v39
  v_or_b32 v46, v46, v47
  v_xor_b32 v47, v178, v39
  v_or_b32 v46, v46, v47
  v_xor_b32 v47, v182, v39
  v_or_b32 v46, v46, v47
  v_xor_b32 v47, v186, v39
  v_or_b32 v46, v46, v47
  v_xor_b32 v47, v190, v39
  v_or_b32 v46, v46, v47
  v_cmp_ne_u32 vcc, 0, v46
  s_add_u32 s28, s28, 1
  s_nop 4
  s_cbranch_vccz Lrec2ok
  s_cmp_gt_u32 s28, 1000000
  s_cbranch_scc1 Lrec2ok
  s_sleep 8
  s_add_u32 s39, s35, 0
  buffer_load_dwordx3 v[160:162], v41, s[8:11], s39 offen offset:0 sc1
  buffer_load_dwordx3 v[164:166], v41, s[8:11], s39 offen offset:1024 sc1
  buffer_load_dwordx3 v[168:170], v41, s[8:11], s39 offen offset:2048 sc1
  buffer_load_dwordx3 v[172:174], v41, s[8:11], s39 offen offset:3072 sc1
  s_add_u32 s39, s35, 4096
  buffer_load_dwordx3 v[176:178], v41, s[8:11], s39 offen offset:0 sc1
  buffer_load_dwordx3 v[180:182], v41, s[8:11], s39 offen offset:1024 sc1
  buffer_load_dwordx3 v[184:186], v41, s[8:11], s39 offen offset:2048 sc1
  buffer_load_dwordx3 v[188:190], v41, s[8:11], s39 offen offset:3072 sc1
  s_waitcnt vmcnt(0)
  s_branch Lrec2
Lrec2ok:
  ds_write_b64 v44, v[160:161] offset:0
  ds_write_b64 v44, v[164:165] offset:128
  ds_write_b64 v44, v[168:169] offset:1024
  ds_write_b64 v44, v[172:173] offset:1152
  ds_write_b64 v45, v[176:177] offset:2048
  ds_write_b64 v45, v[180:181] offset:2176
  ds_write_b64 v45, v[184:185] offset:3072
  ds_write_b64 v45, v[188:189] offset:3200
  s_waitcnt lgkmcnt(0)
  s_barrier
  s_barrier
  s_branch LA_rw
LA_pl:
  buffer_load_dwordx4 v[96:99], v69, s[16:19], s37 offen
  s_add_u32 s37, s37, 15360
  buffer_load_dwordx4 v[100:103], v69, s[16:19], s37 offen
  s_add_u32 s37, s37, 15360
  buffer_load_dwordx4 v[104:107], v69, s[16:19], s37 offen
  s_add_u32 s37, s37, 15360
  buffer_load_dwordx4 v[108:111], v69, s[16:19], s37 offen
  s_add_u32 s37, s37, 15360
  buffer_load_dwordx4 v[112:115], v69, s[16:19], s37 offen
  s_add_u32 s37, s37, 15360
  buffer_load_dwordx4 v[116:119], v69, s[16:19], s37 offen
  s_add_u32 s37, s37, 15360
  buffer_load_dwordx4 v[120:123], v69, s[16:19], s37 offen
  s_add_u32 s37, s37, 15360
  buffer_load_dwordx4 v[124:127], v69, s[16:19], s37 offen
  s_add_u32 s37, s37, 15360
  buffer_load_dwordx4 v[128:131], v69, s[16:19], s37 offen
  s_add_u32 s37, s37, 15360
  buffer_load_dwordx4 v[132:135], v69, s[16:19], s37 offen
  s_add_u32 s37, s37, 15360
  v_and_b32 v70, 1, v1
  v_lshlrev_b32 v70, 4, v70
  v_mov_b32 v71, 0x3f80
  v_lshlrev_b32 v71, v70, v71
  v_bfe_u32 v70, v1, 1, 2
  s_lshl_b32 s45, s31, 4
  s_add_u32 s45, s45, s30
  s_lshl_b32 s45, s45, 10
  s_add_u32 s45, s45, 0xf60000
  v_cmp_eq_u32 vcc, 0, v70
  s_nop 1
  v_cndmask_b32 v28, 0, v71, vcc
  v_cmp_eq_u32 vcc, 1, v70
  s_nop 1
  v_cndmask_b32 v29, 0, v71, vcc
  v_cmp_eq_u32 vcc, 2, v70
  s_nop 1
  v_cndmask_b32 v30, 0, v71, vcc
  v_cmp_eq_u32 vcc, 3, v70
  s_nop 1
  v_cndmask_b32 v31, 0, v71, vcc
  s_waitcnt lgkmcnt(0)
  s_add_u32 s27, s27, 1
  v_mov_b32 v39, s27
  v_mov_b32 v34, s27
  v_mov_b32 v35, s27
  s_mov_b32 s79, 0x26000
  s_mov_b32 s50, 0xc8000
  s_mov_b32 s57, 0x1800000
  s_mov_b32 s59, 0x1e12000
  s_cmp_lt_u32 s34, 270
  s_cselect_b32 s48, s72, s64
  s_cselect_b32 s49, s73, s65
  s_cselect_b32 s50, 0x21c000, s50
  s_cselect_b32 s57, 0x1900000, s57
  s_cselect_b32 s59, 0x1e08000, s59
  s_cselect_b32 s58, 54, 20
  s_cselect_b32 s52, 0, 270
  s_cselect_b32 s53, 13, 12
  s_mov_b32 s51, 0x20000
  s_sub_u32 s52, s34, s52
  s_mul_i32 s54, s52, 205
  s_lshr_b32 s54, s54, 10
  s_mul_i32 s55, s54, 5
  s_sub_u32 s55, s52, s55
  s_mul_i32 s56, s54, 40960
  s_lshl_b32 s52, s55, 8
  s_add_u32 s56, s56, s52
  s_lshl_b32 s52, s55, s53
  s_add_u32 s59, s59, s52
  s_lshl_b32 s52, s54, 7
  s_add_u32 s59, s59, s52
  s_lshl_b32 s52, s55, 3
  s_mul_i32 s52, s52, s58
  s_add_u32 s52, s52, s54
  s_lshl_b32 s52, s52, 10
  s_add_u32 s57, s57, s52
  s_lshl_b32 s58, s58, 10
  v_mul_u32_u24 v52, 1280, v13
  v_lshl_add_u32 v52, v14, 4, v52
  v_lshlrev_b32 v53, 10, v60
  v_lshl_add_u32 v53, v61, 7, v53
  v_lshl_add_u32 v53, v62, 3, v53
  v_add_u32 v53, s79, v53
  s_lshl_b32 s35, s31, 14
  s_and_b32 s36, s26, 1
  s_lshl_b32 s39, s36, 13
  s_add_u32 s35, s35, s39
  s_add_u32 s35, s35, 0xf60000
  v_lshlrev_b32 v44, 8, v61
  v_lshl_add_u32 v44, v62, 4, v44
  v_lshl_add_u32 v44, v65, 6, v44
  v_and_b32 v45, 1, v60
  v_lshl_add_u32 v44, v45, 3, v44
  s_lshl_b32 s36, s36, 12
  s_add_u32 s36, s36, 0x14000
  v_add_u32 v44, s36, v44
  v_xor_b32 v45, 32, v44
  v_mov_b32 v39, s27
  s_barrier
  s_waitcnt vmcnt(9)
  v_mfma_f32_16x16x32_bf16 v[24:27], v[28:31], v[96:99], 0
  s_waitcnt vmcnt(8)
  v_mfma_f32_16x16x32_bf16 v[24:27], v[28:31], v[100:103], v[24:27]
  s_waitcnt vmcnt(7)
  v_mfma_f32_16x16x32_bf16 v[24:27], v[28:31], v[104:107], v[24:27]
  s_waitcnt vmcnt(6)
  v_mfma_f32_16x16x32_bf16 v[24:27], v[28:31], v[108:111], v[24:27]
  s_waitcnt vmcnt(5)
  v_mfma_f32_16x16x32_bf16 v[24:27], v[28:31], v[112:115], v[24:27]
  s_waitcnt vmcnt(4)
  v_mfma_f32_16x16x32_bf16 v[24:27], v[28:31], v[116:119], v[24:27]
  s_waitcnt vmcnt(3)
  v_mfma_f32_16x16x32_bf16 v[24:27], v[28:31], v[120:123], v[24:27]
  s_waitcnt vmcnt(2)
  v_mfma_f32_16x16x32_bf16 v[24:27], v[28:31], v[124:127], v[24:27]
  s_waitcnt vmcnt(1)
  v_mfma_f32_16x16x32_bf16 v[24:27], v[28:31], v[128:131], v[24:27]
  s_waitcnt vmcnt(0)
  v_mfma_f32_16x16x32_bf16 v[24:27], v[28:31], v[132:135], v[24:27]
  s_barrier
  v_cmp_gt_u32 vcc, 32, v1
  s_nop 5
  v_cvt_pk_bf16_f32 v32, v24, v25
  v_cvt_pk_bf16_f32 v33, v26, v27
  v_lshlrev_b32 v20, 16, v32
  v_lshlrev_b32 v22, 16, v33
  v_and_b32 v21, 0xffff0000, v32
  v_and_b32 v23, 0xffff0000, v33
  v_sub_f32 v20, v24, v20
  v_sub_f32 v22, v26, v22
  v_sub_f32 v21, v25, v21
  v_sub_f32 v23, v27, v23
  v_cvt_pk_bf16_f32 v20, v20, v21
  v_cvt_pk_bf16_f32 v22, v22, v23
  v_cndmask_b32 v32, v20, v32, vcc
  v_cndmask_b32 v33, v22, v33, vcc
  buffer_store_dwordx4 v[32:35], v41, s[8:11], s45 offen sc1
  s_barrier
  s_barrier
  s_barrier
  s_barrier
  s_add_u32 s39, s35, 0
  buffer_load_dwordx3 v[160:162], v41, s[8:11], s39 offen offset:0 sc1
  buffer_load_dwordx3 v[164:166], v41, s[8:11], s39 offen offset:1024 sc1
  buffer_load_dwordx3 v[168:170], v41, s[8:11], s39 offen offset:2048 sc1
  buffer_load_dwordx3 v[172:174], v41, s[8:11], s39 offen offset:3072 sc1
  s_barrier
  s_add_u32 s39, s35, 4096
  buffer_load_dwordx3 v[176:178], v41, s[8:11], s39 offen offset:0 sc1
  buffer_load_dwordx3 v[180:182], v41, s[8:11], s39 offen offset:1024 sc1
  buffer_load_dwordx3 v[184:186], v41, s[8:11], s39 offen offset:2048 sc1
  buffer_load_dwordx3 v[188:190], v41, s[8:11], s39 offen offset:3072 sc1
  s_barrier
  s_add_u32 m0, s79, 0
  s_add_u32 s52, s56, 0x0
  buffer_load_dwordx4 v52, s[48:51], s52 offen nt lds
  s_add_u32 m0, s79, 1024
  s_add_u32 s52, s56, 0x2800
  buffer_load_dwordx4 v52, s[48:51], s52 offen nt lds
  s_add_u32 m0, s79, 2048
  s_add_u32 s52, s56, 0x5000
  buffer_load_dwordx4 v52, s[48:51], s52 offen nt lds
  s_add_u32 m0, s79, 3072
  s_add_u32 s52, s56, 0x7800
  buffer_load_dwordx4 v52, s[48:51], s52 offen nt lds
  s_add_u32 m0, s79, 4096
  s_add_u32 s52, s56, 0x80
  buffer_load_dwordx4 v52, s[48:51], s52 offen nt lds
  s_add_u32 m0, s79, 5120
  s_add_u32 s52, s56, 0x2880
  buffer_load_dwordx4 v52, s[48:51], s52 offen nt lds
  s_add_u32 m0, s79, 6144
  s_add_u32 s52, s56, 0x5080
  buffer_load_dwordx4 v52, s[48:51], s52 offen nt lds
  s_add_u32 m0, s79, 7168
  s_add_u32 s52, s56, 0x7880
  buffer_load_dwordx4 v52, s[48:51], s52 offen nt lds
  s_barrier
  s_mov_b32 s28, 0
  s_waitcnt vmcnt(8)
Lrec3:
  v_xor_b32 v46, v162, v39
  v_xor_b32 v47, v166, v39
  v_or_b32 v46, v46, v47
  v_xor_b32 v47, v170, v39
  v_or_b32 v46, v46, v47
  v_xor_b32 v47, v174, v39
  v_or_b32 v46, v46, v47
  v_xor_b32 v47, v178, v39
  v_or_b32 v46, v46, v47
  v_xor_b32 v47, v182, v39
  v_or_b32 v46, v46, v47
  v_xor_b32 v47, v186, v39
  v_or_b32 v46, v46, v47
  v_xor_b32 v47, v190, v39
  v_or_b32 v46, v46, v47
  v_cmp_ne_u32 vcc, 0, v46
  s_add_u32 s28, s28, 1
  s_nop 4
  s_cbranch_vccz Lrec3ok
  s_cmp_gt_u32 s28, 1000000
  s_cbranch_scc1 Lrec3ok
  s_sleep 8
  s_add_u32 s39, s35, 0
  buffer_load_dwordx3 v[160:162], v41, s[8:11], s39 offen offset:0 sc1
  buffer_load_dwordx3 v[164:166], v41, s[8:11], s39 offen offset:1024 sc1
  buffer_load_dwordx3 v[168:170], v41, s[8:11], s39 offen offset:2048 sc1
  buffer_load_dwordx3 v[172:174], v41, s[8:11], s39 offen offset:3072 sc1
  s_add_u32 s39, s35, 4096
  buffer_load_dwordx3 v[176:178], v41, s[8:11], s39 offen offset:0 sc1
  buffer_load_dwordx3 v[180:182], v41, s[8:11], s39 offen offset:1024 sc1
  buffer_load_dwordx3 v[184:186], v41, s[8:11], s39 offen offset:2048 sc1
  buffer_load_dwordx3 v[188:190], v41, s[8:11], s39 offen offset:3072 sc1
  s_waitcnt vmcnt(0)
  s_branch Lrec3
Lrec3ok:
  ds_write_b64 v44, v[160:161] offset:0
  ds_write_b64 v44, v[164:165] offset:128
  ds_write_b64 v44, v[168:169] offset:1024
  ds_write_b64 v44, v[172:173] offset:1152
  ds_write_b64 v45, v[176:177] offset:2048
  ds_write_b64 v45, v[180:181] offset:2176
  ds_write_b64 v45, v[184:185] offset:3072
  ds_write_b64 v45, v[188:189] offset:3200
  s_waitcnt lgkmcnt(0)
  s_barrier
  s_barrier
LA_rw:
  s_waitcnt vmcnt(0) lgkmcnt(0)
  v_mov_b32 v46, 0x20404
  v_mov_b32 v47, 1
  s_mov_b64 exec, 1
  ds_add_u32 v46, v47
  s_mov_b64 exec, -1
LA_b11:
  s_mul_i32 s70, s30, 15
  s_add_u32 s70, s70, s31
  s_branch LA_done
LA_comp:
  v_and_b32 v66, 15, v1
  s_lshl_b32 s36, s30, 4
  s_add_u32 s36, s36, s31
  s_lshl_b32 s36, s36, 3
  s_lshl_b32 s37, s26, 2
  s_add_u32 s46, s36, s37
  s_mul_i32 s36, s46, 1280
  v_mul_u32_u24 v67, 1280, v65
  v_lshl_add_u32 v68, v64, 3, v67
  v_lshl_add_u32 v67, v64, 4, v67
  s_waitcnt lgkmcnt(0)
  s_mov_b32 s4, s60
  s_mov_b32 s5, s61
  s_mov_b32 s6, 0x280000
  s_mov_b32 s7, 0x20000
  s_mov_b32 s16, s62
  s_mov_b32 s17, s63
  s_mov_b32 s18, 0x258000
  s_mov_b32 s19, 0x20000
  s_mov_b32 s8, s22
  s_mov_b32 s9, s23
  s_mov_b32 s10, 0x2453000
  s_mov_b32 s11, 0x20000
  s_mov_b32 s12, s74
  s_mov_b32 s13, s75
  s_mov_b32 s14, 0x280000
  s_mov_b32 s15, 0x20000
  s_add_u32 s78, s22, 0xff0000
  s_addc_u32 s79, s23, 0
  s_load_dword s27, s[78:79], 0
  s_mov_b32 s50, 0x7f000000
  v_mov_b32 v126, 0
  s_cmp_lt_u32 s26, 2
  s_cbranch_scc0 LA_s1done
  buffer_load_dwordx4 v[128:131], v67, s[4:7], s36 offen offset:0
  buffer_load_dwordx4 v[132:135], v67, s[4:7], s36 offen offset:512
  buffer_load_dwordx2 v[136:137], v68, s[4:7], s36 offen offset:1024
  buffer_load_dwordx4 v[138:141], v67, s[4:7], s36 offen offset:2560
  buffer_load_dwordx4 v[142:145], v67, s[4:7], s36 offen offset:3072
  buffer_load_dwordx2 v[146:147], v68, s[4:7], s36 offen offset:3584
  s_mov_b32 s48, 0x3f803f80
  v_mov_b32 v16, 0
  v_mov_b32 v17, 0
  v_mov_b32 v18, 0
  v_mov_b32 v19, 0
  s_waitcnt vmcnt(5)
  v_dot2c_f32_bf16 v16, s48, v128
  v_dot2c_f32_bf16 v18, v128, v128
  s_waitcnt vmcnt(2)
  v_dot2c_f32_bf16 v17, s48, v138
  v_dot2c_f32_bf16 v19, v138, v138
  v_dot2c_f32_bf16 v16, s48, v129
  v_dot2c_f32_bf16 v18, v129, v129
  v_dot2c_f32_bf16 v17, s48, v139
  v_dot2c_f32_bf16 v19, v139, v139
  v_dot2c_f32_bf16 v16, s48, v130
  v_dot2c_f32_bf16 v18, v130, v130
  v_dot2c_f32_bf16 v17, s48, v140
  v_dot2c_f32_bf16 v19, v140, v140
  v_dot2c_f32_bf16 v16, s48, v131
  v_dot2c_f32_bf16 v18, v131, v131
  v_dot2c_f32_bf16 v17, s48, v141
  v_dot2c_f32_bf16 v19, v141, v141
  v_dot2c_f32_bf16 v16, s48, v132
  v_dot2c_f32_bf16 v18, v132, v132
  s_waitcnt vmcnt(1)
  v_dot2c_f32_bf16 v17, s48, v142
  v_dot2c_f32_bf16 v19, v142, v142
  v_dot2c_f32_bf16 v16, s48, v133
  v_dot2c_f32_bf16 v18, v133, v133
  v_dot2c_f32_bf16 v17, s48, v143
  v_dot2c_f32_bf16 v19, v143, v143
  v_dot2c_f32_bf16 v16, s48, v134
  v_dot2c_f32_bf16 v18, v134, v134
  v_dot2c_f32_bf16 v17, s48, v144
  v_dot2c_f32_bf16 v19, v144, v144
  v_dot2c_f32_bf16 v16, s48, v135
  v_dot2c_f32_bf16 v18, v135, v135
  v_dot2c_f32_bf16 v17, s48, v145
  v_dot2c_f32_bf16 v19, v145, v145
  v_dot2c_f32_bf16 v16, s48, v136
  v_dot2c_f32_bf16 v18, v136, v136
  s_waitcnt vmcnt(0)
  v_dot2c_f32_bf16 v17, s48, v146
  v_dot2c_f32_bf16 v19, v146, v146
  v_dot2c_f32_bf16 v16, s48, v137
  v_dot2c_f32_bf16 v18, v137, v137
  v_dot2c_f32_bf16 v17, s48, v147
  v_dot2c_f32_bf16 v19, v147, v147
  v_add_f32_dpp v16, v16, v16 quad_perm:[1,0,3,2] row_mask:0xf bank_mask:0xf
  s_nop 0
  v_add_f32_dpp v17, v17, v17 quad_perm:[1,0,3,2] row_mask:0xf bank_mask:0xf
  v_add_f32_dpp v18, v18, v18 quad_perm:[1,0,3,2] row_mask:0xf bank_mask:0xf
  v_add_f32_dpp v19, v19, v19 quad_perm:[1,0,3,2] row_mask:0xf bank_mask:0xf
  v_add_f32_dpp v16, v16, v16 quad_perm:[2,3,0,1] row_mask:0xf bank_mask:0xf
  v_add_f32_dpp v17, v17, v17 quad_perm:[2,3,0,1] row_mask:0xf bank_mask:0xf
  v_add_f32_dpp v18, v18, v18 quad_perm:[2,3,0,1] row_mask:0xf bank_mask:0xf
  v_add_f32_dpp v19, v19, v19 quad_perm:[2,3,0,1] row_mask:0xf bank_mask:0xf
  v_add_f32_dpp v16, v16, v16 row_half_mirror row_mask:0xf bank_mask:0xf
  v_add_f32_dpp v17, v17, v17 row_half_mirror row_mask:0xf bank_mask:0xf
  v_add_f32_dpp v18, v18, v18 row_half_mirror row_mask:0xf bank_mask:0xf
  v_add_f32_dpp v19, v19, v19 row_half_mirror row_mask:0xf bank_mask:0xf
  v_add_f32_dpp v16, v16, v16 row_mirror row_mask:0xf bank_mask:0xf
  v_add_f32_dpp v17, v17, v17 row_mirror row_mask:0xf bank_mask:0xf
  v_add_f32_dpp v18, v18, v18 row_mirror row_mask:0xf bank_mask:0xf
  v_add_f32_dpp v19, v19, v19 row_mirror row_mask:0xf bank_mask:0xf
  v_mov_b32 v20, v16
  v_mov_b32 v21, v17
  v_mov_b32 v22, v18
  v_mov_b32 v23, v19
  v_permlane16_swap_b32 v16, v20
  v_permlane16_swap_b32 v17, v21
  v_permlane16_swap_b32 v18, v22
  v_permlane16_swap_b32 v19, v23
  v_add_f32 v16, v16, v20
  v_add_f32 v17, v17, v21
  v_add_f32 v18, v18, v22
  v_add_f32 v19, v19, v23
  v_cmp_eq_u32 vcc, 1, v64
  s_nop 1
  v_cndmask_b32 v16, v16, v17, vcc
  v_cndmask_b32 v18, v18, v19, vcc
  v_mul_f32 v16, 0x3acccccd, v16
  v_mul_f32 v18, 0x3acccccd, v18
  v_fma_f32 v18, -v16, v16, v18
  v_max_f32 v18, 0, v18
  v_add_f32 v18, 0x3727c5ac, v18
  v_rsq_f32 v129, v18
  v_cvt_pk_bf16_f32 v128, -v16, -v16
  v_lshlrev_b32 v126, 5, v64
  v_lshl_add_u32 v126, v65, 4, v126
  v_mov_b32 v37, 0x7f000000
  v_cmp_gt_u32 vcc, 2, v64
  s_nop 1
  v_cndmask_b32 v126, v37, v126, vcc
  s_lshl_b32 s50, s46, 4
  s_add_u32 s50, s50, 0xf50000
LA_s1done:
  s_waitcnt lgkmcnt(0)
  s_add_u32 s27, s27, 1
  v_mov_b32 v130, s27
  v_mov_b32 v131, s27
  v_mov_b32 v117, s27
  v_mov_b32 v116, 0
  buffer_store_dwordx4 v[128:131], v126, s[8:11], s50 offen sc1
  s_cmp_eq_u32 s31, 15
  s_cbranch_scc0 LA_main
  s_lshl_b32 s34, s30, 3
  s_add_u32 s34, s34, s26
  s_lshl_b32 s79, s26, 13
  v_lshlrev_b32 v41, 4, v1
  s_waitcnt vmcnt(0)
LA_sp:
  s_cmp_lt_u32 s34, 100
  s_cselect_b32 s78, 270, 0
  s_cselect_b32 s77, 0, 140
  s_add_u32 s78, s78, s77
  s_add_u32 s78, s78, s34
  s_mov_b32 s50, 0xc8000
  s_mov_b32 s57, 0x1800000
  s_mov_b32 s59, 0x1e12000
  s_cmp_lt_u32 s78, 270
  s_cselect_b32 s48, s72, s64
  s_cselect_b32 s49, s73, s65
  s_cselect_b32 s50, 0x21c000, s50
  s_cselect_b32 s57, 0x1900000, s57
  s_cselect_b32 s59, 0x1e08000, s59
  s_cselect_b32 s58, 54, 20
  s_cselect_b32 s52, 0, 270
  s_cselect_b32 s53, 13, 12
  s_mov_b32 s51, 0x20000
  s_sub_u32 s52, s78, s52
  s_mul_i32 s54, s52, 205
  s_lshr_b32 s54, s54, 10
  s_mul_i32 s55, s54, 5
  s_sub_u32 s55, s52, s55
  s_mul_i32 s56, s54, 40960
  s_lshl_b32 s52, s55, 8
  s_add_u32 s56, s56, s52
  s_lshl_b32 s52, s55, s53
  s_add_u32 s59, s59, s52
  s_lshl_b32 s52, s54, 7
  s_add_u32 s59, s59, s52
  s_lshl_b32 s52, s55, 3
  s_mul_i32 s52, s52, s58
  s_add_u32 s52, s52, s54
  s_lshl_b32 s52, s52, 10
  s_add_u32 s57, s57, s52
  s_lshl_b32 s58, s58, 10
  v_mul_u32_u24 v52, 1280, v13
  v_lshl_add_u32 v52, v14, 4, v52
  v_lshlrev_b32 v53, 10, v60
  v_lshl_add_u32 v53, v61, 7, v53
  v_lshl_add_u32 v53, v62, 3, v53
  v_add_u32 v53, s79, v53
  s_add_u32 m0, s79, 0
  s_add_u32 s52, s56, 0x0
  buffer_load_dwordx4 v52, s[48:51], s52 offen nt lds
  s_add_u32 m0, s79, 1024
  s_add_u32 s52, s56, 0x2800
  buffer_load_dwordx4 v52, s[48:51], s52 offen nt lds
  s_add_u32 m0, s79, 2048
  s_add_u32 s52, s56, 0x5000
  buffer_load_dwordx4 v52, s[48:51], s52 offen nt lds
  s_add_u32 m0, s79, 3072
  s_add_u32 s52, s56, 0x7800
  buffer_load_dwordx4 v52, s[48:51], s52 offen nt lds
  s_add_u32 m0, s79, 4096
  s_add_u32 s52, s56, 0x80
  buffer_load_dwordx4 v52, s[48:51], s52 offen nt lds
  s_add_u32 m0, s79, 5120
  s_add_u32 s52, s56, 0x2880
  buffer_load_dwordx4 v52, s[48:51], s52 offen nt lds
  s_add_u32 m0, s79, 6144
  s_add_u32 s52, s56, 0x5080
  buffer_load_dwordx4 v52, s[48:51], s52 offen nt lds
  s_add_u32 m0, s79, 7168
  s_add_u32 s52, s56, 0x7880
  buffer_load_dwordx4 v52, s[48:51], s52 offen nt lds
  s_waitcnt vmcnt(0)
  ds_read_b64_tr_b16 v[160:161], v53 offset:0
  ds_read_b64_tr_b16 v[162:163], v53 offset:512
  ds_read_b64_tr_b16 v[164:165], v53 offset:32
  ds_read_b64_tr_b16 v[166:167], v53 offset:544
  ds_read_b64_tr_b16 v[168:169], v53 offset:64
  ds_read_b64_tr_b16 v[170:171], v53 offset:576
  ds_read_b64_tr_b16 v[172:173], v53 offset:96
  ds_read_b64_tr_b16 v[174:175], v53 offset:608
  ds_read_b64_tr_b16 v[176:177], v53 offset:4096
  ds_read_b64_tr_b16 v[178:179], v53 offset:4608
  ds_read_b64_tr_b16 v[180:181], v53 offset:4128
  ds_read_b64_tr_b16 v[182:183], v53 offset:4640
  ds_read_b64_tr_b16 v[184:185], v53 offset:4160
  ds_read_b64_tr_b16 v[186:187], v53 offset:4672
  ds_read_b64_tr_b16 v[188:189], v53 offset:4192
  s_waitcnt lgkmcnt(14)
  ds_read_b64_tr_b16 v[190:191], v53 offset:4704
  s_waitcnt lgkmcnt(14)
  buffer_store_dwordx4 v[160:163], v41, s[8:11], s57 offen sc1
  s_add_u32 s57, s57, s58
  s_waitcnt lgkmcnt(12)
  buffer_store_dwordx4 v[164:167], v41, s[8:11], s57 offen sc1
  s_add_u32 s57, s57, s58
  s_waitcnt lgkmcnt(10)
  buffer_store_dwordx4 v[168:171], v41, s[8:11], s57 offen sc1
  s_add_u32 s57, s57, s58
  s_waitcnt lgkmcnt(8)
  buffer_store_dwordx4 v[172:175], v41, s[8:11], s57 offen sc1
  s_add_u32 s57, s57, s58
  s_waitcnt lgkmcnt(6)
  buffer_store_dwordx4 v[176:179], v41, s[8:11], s57 offen sc1
  s_add_u32 s57, s57, s58
  s_waitcnt lgkmcnt(4)
  buffer_store_dwordx4 v[180:183], v41, s[8:11], s57 offen sc1
  s_add_u32 s57, s57, s58
  s_waitcnt lgkmcnt(2)
  buffer_store_dwordx4 v[184:187], v41, s[8:11], s57 offen sc1
  s_add_u32 s57, s57, s58
  s_waitcnt lgkmcnt(0)
  buffer_store_dwordx4 v[188:191], v41, s[8:11], s57 offen sc1
  s_add_u32 s57, s57, s58
  s_waitcnt vmcnt(0)
  s_mov_b64 exec, 1
  buffer_store_dword v117, v116, s[8:11], s59 offen offset:0 sc1
  s_mov_b64 exec, -1
  s_add_u32 s34, s34, 128
  s_cmp_lt_u32 s34, 130
  s_cbranch_scc1 LA_sp
  s_lshl_b32 s34, s30, 3
  s_add_u32 s34, s34, s26
  v_lshlrev_b32 v20, 7, v1
  s_lshr_b32 s52, s34, 1
  s_lshl_b32 s52, s52, 13
  s_and_b32 s53, s34, 1
  s_mul_i32 s53, s53, 2048
  s_add_u32 s52, s52, s53
  s_add_u32 s52, s52, 0x1d00000
  s_mov_b64 exec, 65535
  buffer_load_dword v240, v20, s[8:11], s52 offen sc1
  s_lshr_b32 s52, s34, 2
  s_lshl_b32 s52, s52, 13
  s_and_b32 s53, s34, 3
  s_mul_i32 s53, s53, 1024
  s_add_u32 s52, s52, s53
  s_add_u32 s52, s52, 0x1d80000
  s_mov_b64 exec, 255
  buffer_load_dword v241, v20, s[8:11], s52 offen sc1
  s_lshr_b32 s52, s34, 1
  s_lshl_b32 s52, s52, 13
  s_and_b32 s53, s34, 1
  s_mul_i32 s53, s53, 1024
  s_add_u32 s52, s52, s53
  s_add_u32 s52, s52, 0x1c00000
  s_mov_b64 exec, 255
  buffer_load_dword v242, v20, s[8:11], s52 offen sc1
  s_lshr_b32 s52, s34, 3
  s_lshl_b32 s52, s52, 13
  s_and_b32 s53, s34, 7
  s_mul_i32 s53, s53, 1024
  s_add_u32 s52, s52, s53
  s_add_u32 s52, s52, 0x1c80000
  s_mov_b64 exec, 255
  buffer_load_dword v243, v20, s[8:11], s52 offen sc1
  s_mul_i32 s52, s34, 640
  s_add_u32 s52, s52, 0x1e00000
  s_mov_b64 exec, 31
  buffer_load_dword v244, v20, s[8:11], s52 offen sc1
  s_mov_b64 exec, -1
  s_waitcnt vmcnt(0)
  s_mov_b32 s70, 0x7f000000
  s_mov_b32 s71, 0x7f000000
  s_mov_b32 s72, 0x7f000000
  s_mov_b32 s73, 0x7f000000
  s_mov_b32 s74, 0x7f000000
  s_mov_b32 s75, 0x7f000000
  s_mov_b32 s76, 0x7f000000
  s_barrier
  s_branch LA_done
LA_main:
  s_lshr_b32 s35, s26, 1
  s_and_b32 s36, s26, 1
  v_bfe_u32 v114, v1, 1, 3
  s_lshl_b32 s37, s35, 13
  v_lshlrev_b32 v115, 7, v66
  v_add_u32 v115, s37, v115
  v_xor_b32 v112, v60, v114
  v_lshl_add_u32 v2, v112, 4, v115
  v_xor_b32 v3, 64, v2
  v_lshlrev_b32 v4, 11, v60
  v_lshl_add_u32 v4, v61, 6, v4
  v_and_b32 v112, 1, v60
  v_lshl_add_u32 v4, v112, 5, v4
  v_lshl_add_u32 v4, v62, 3, v4
  s_lshl_b32 s37, s36, 9
  s_add_u32 s37, s37, 16384
  v_add_u32 v4, s37, v4
  v_xor_b32 v5, 32, v4
  v_add_u32 v7, 0x10000, v2
  v_add_u32 v8, 0x10000, v3
  v_add_u32 v9, 0x10000, v4
  v_add_u32 v10, 0x10000, v5
  v_lshlrev_b32 v12, 15, v65
  v_lshl_add_u32 v12, v64, 4, v12
  s_lshl_b32 s37, s35, 9
  v_lshlrev_b32 v13, 3, v66
  v_add_u32 v13, s37, v13
  v_add_u32 v13, 0x20000, v13
  s_lshl_b32 s38, s31, 19
  s_lshl_b32 s37, s36, 18
  s_add_u32 s38, s38, s37
  s_lshl_b32 s37, s30, 11
  s_add_u32 s38, s38, s37
  s_lshl_b32 s37, s35, 10
  s_add_u32 s38, s38, s37
  s_add_u32 s38, s38, 0x0
  s_mul_i32 s42, s31, 52
  s_lshr_b32 s42, s42, 8
  s_mul_i32 s43, s42, 5
  s_sub_u32 s43, s31, s43
  s_lshl_b32 s44, s43, 4
  s_mul_i32 s45, s44, 26
  s_lshr_b32 s45, s45, 8
  s_add_u32 s44, s44, 16
  v_lshrrev_b32 v118, 1, v1
  v_add_u32 v118, s45, v118
  v_and_b32 v119, 1, v1
  s_lshr_b32 s46, s30, 1
  v_add_u32 v120, s46, v119
  v_mul_u32_u24 v121, 10, v118
  v_lshrrev_b32 v122, 4, v121
  v_sub_u32 v122, s43, v122
  s_and_b32 s46, s30, 1
  s_add_u32 s46, s46, 2
  s_lshl_b32 s46, s46, 3
  s_lshl_b32 s47, s42, 1
  s_add_u32 s46, s46, s47
  v_add_u32 v122, s46, v122
  v_lshlrev_b32 v123, 4, v119
  v_sub_u32 v122, v122, v123
  v_lshl_add_u32 v123, v118, 3, v120
  v_lshlrev_b32 v123, 13, v123
  v_lshl_add_u32 v123, v122, 7, v123
  v_mov_b32 v124, 0x7f000000
  v_cmp_gt_u32 vcc, s44, v121
  s_nop 1
  v_cndmask_b32 v123, v124, v123, vcc
  v_cmp_gt_u32 vcc, 8, v120
  s_nop 1
  v_cndmask_b32 v123, v124, v123, vcc
  s_mov_b32 s42, 0x1d00000
  v_mov_b32 v124, 0x20400
  v_mov_b32 v125, 1
  s_barrier
  ds_read_b64_tr_b16 v[148:149], v4 offset:0
  ds_read_b64_tr_b16 v[150:151], v4 offset:1024
  ds_read_b128 v[132:135], v2 offset:0
  ds_read_b128 v[136:139], v2 offset:2048
  ds_read_b128 v[140:143], v2 offset:4096
  ds_read_b128 v[144:147], v2 offset:6144
  ds_read_b64_tr_b16 v[152:153], v5 offset:0
  ds_read_b64_tr_b16 v[154:155], v5 offset:1024
  ds_read_b64_tr_b16 v[156:157], v4 offset:256
  ds_read_b64_tr_b16 v[158:159], v4 offset:1280
  ds_read_b64_tr_b16 v[160:161], v5 offset:256
  ds_read_b64_tr_b16 v[162:163], v5 offset:1280
  s_waitcnt lgkmcnt(9)
  v_mfma_f32_16x16x32_bf16 v[16:19], v[148:151], v[132:135], 0
  ds_read_b64_tr_b16 v[180:181], v4 offset:8192
  s_waitcnt lgkmcnt(9)
  v_mfma_f32_16x16x32_bf16 v[20:23], v[148:151], v[136:139], 0
  ds_read_b64_tr_b16 v[182:183], v4 offset:9216
  s_waitcnt lgkmcnt(9)
  v_mfma_f32_16x16x32_bf16 v[24:27], v[148:151], v[140:143], 0
  ds_read_b128 v[164:167], v3 offset:0
  s_waitcnt lgkmcnt(9)
  v_mfma_f32_16x16x32_bf16 v[28:31], v[148:151], v[144:147], 0
  ds_read_b128 v[168:171], v3 offset:2048
  s_waitcnt lgkmcnt(8)
  v_mfma_f32_16x16x32_bf16 v[32:35], v[152:155], v[132:135], 0
  ds_read_b128 v[172:175], v3 offset:4096
  v_mfma_f32_16x16x32_bf16 v[36:39], v[152:155], v[136:139], 0
  ds_read_b128 v[176:179], v3 offset:6144
  v_mfma_f32_16x16x32_bf16 v[40:43], v[152:155], v[140:143], 0
  ds_read_b64_tr_b16 v[184:185], v5 offset:8192
  v_mfma_f32_16x16x32_bf16 v[44:47], v[152:155], v[144:147], 0
  ds_read_b64_tr_b16 v[186:187], v5 offset:9216
  s_waitcnt lgkmcnt(10)
  v_mfma_f32_16x16x32_bf16 v[48:51], v[156:159], v[132:135], 0
  ds_read_b64_tr_b16 v[188:189], v4 offset:8448
  v_mfma_f32_16x16x32_bf16 v[52:55], v[156:159], v[136:139], 0
  ds_read_b64_tr_b16 v[190:191], v4 offset:9472
  v_mfma_f32_16x16x32_bf16 v[56:59], v[156:159], v[140:143], 0
  ds_read_b64_tr_b16 v[192:193], v5 offset:8448
  v_mfma_f32_16x16x32_bf16 v[60:63], v[156:159], v[144:147], 0
  ds_read_b64_tr_b16 v[194:195], v5 offset:9472
  s_waitcnt lgkmcnt(12)
  v_mfma_f32_16x16x32_bf16 v[64:67], v[160:163], v[132:135], 0
  v_mfma_f32_16x16x32_bf16 v[68:71], v[160:163], v[136:139], 0
  v_mfma_f32_16x16x32_bf16 v[72:75], v[160:163], v[140:143], 0
  v_mfma_f32_16x16x32_bf16 v[76:79], v[160:163], v[144:147], 0
  s_waitcnt lgkmcnt(9)
  v_mfma_f32_16x16x32_bf16 v[16:19], v[180:183], v[164:167], v[16:19]
  s_waitcnt lgkmcnt(8)
  v_mfma_f32_16x16x32_bf16 v[20:23], v[180:183], v[168:171], v[20:23]
  s_waitcnt lgkmcnt(7)
  v_mfma_f32_16x16x32_bf16 v[24:27], v[180:183], v[172:175], v[24:27]
  s_waitcnt lgkmcnt(6)
  v_mfma_f32_16x16x32_bf16 v[28:31], v[180:183], v[176:179], v[28:31]
  s_waitcnt lgkmcnt(0)
  s_barrier
  v_mfma_f32_16x16x32_bf16 v[32:35], v[184:187], v[164:167], v[32:35]
  ds_read_b64_tr_b16 v[148:149], v4 offset:32768
  v_mfma_f32_16x16x32_bf16 v[36:39], v[184:187], v[168:171], v[36:39]
  ds_read_b64_tr_b16 v[150:151], v4 offset:33792
  v_mfma_f32_16x16x32_bf16 v[40:43], v[184:187], v[172:175], v[40:43]
  ds_read_b128 v[132:135], v2 offset:32768
  v_mfma_f32_16x16x32_bf16 v[44:47], v[184:187], v[176:179], v[44:47]
  ds_read_b128 v[136:139], v2 offset:34816
  v_mfma_f32_16x16x32_bf16 v[48:51], v[188:191], v[164:167], v[48:51]
  ds_read_b128 v[140:143], v2 offset:36864
  v_mfma_f32_16x16x32_bf16 v[52:55], v[188:191], v[168:171], v[52:55]
  ds_read_b128 v[144:147], v2 offset:38912
  v_mfma_f32_16x16x32_bf16 v[56:59], v[188:191], v[172:175], v[56:59]
  ds_read_b64_tr_b16 v[152:153], v5 offset:32768
  v_mfma_f32_16x16x32_bf16 v[60:63], v[188:191], v[176:179], v[60:63]
  ds_read_b64_tr_b16 v[154:155], v5 offset:33792
  v_mfma_f32_16x16x32_bf16 v[64:67], v[192:195], v[164:167], v[64:67]
  ds_read_b64_tr_b16 v[156:157], v4 offset:33024
  v_mfma_f32_16x16x32_bf16 v[68:71], v[192:195], v[168:171], v[68:71]
  ds_read_b64_tr_b16 v[158:159], v4 offset:34048
  v_mfma_f32_16x16x32_bf16 v[72:75], v[192:195], v[172:175], v[72:75]
  ds_read_b64_tr_b16 v[160:161], v5 offset:33024
  v_mfma_f32_16x16x32_bf16 v[76:79], v[192:195], v[176:179], v[76:79]
  ds_read_b64_tr_b16 v[162:163], v5 offset:34048
  s_waitcnt lgkmcnt(9)
  v_mfma_f32_16x16x32_bf16 v[16:19], v[148:151], v[132:135], v[16:19]
  ds_read_b64_tr_b16 v[180:181], v4 offset:40960
  s_waitcnt lgkmcnt(9)
  v_mfma_f32_16x16x32_bf16 v[20:23], v[148:151], v[136:139], v[20:23]
  ds_read_b64_tr_b16 v[182:183], v4 offset:41984
  s_waitcnt lgkmcnt(9)
  v_mfma_f32_16x16x32_bf16 v[24:27], v[148:151], v[140:143], v[24:27]
  ds_read_b128 v[164:167], v3 offset:32768
  s_waitcnt lgkmcnt(9)
  v_mfma_f32_16x16x32_bf16 v[28:31], v[148:151], v[144:147], v[28:31]
  ds_read_b128 v[168:171], v3 offset:34816
  s_waitcnt lgkmcnt(8)
  v_mfma_f32_16x16x32_bf16 v[32:35], v[152:155], v[132:135], v[32:35]
  ds_read_b128 v[172:175], v3 offset:36864
  v_mfma_f32_16x16x32_bf16 v[36:39], v[152:155], v[136:139], v[36:39]
  ds_read_b128 v[176:179], v3 offset:38912
  v_mfma_f32_16x16x32_bf16 v[40:43], v[152:155], v[140:143], v[40:43]
  ds_read_b64_tr_b16 v[184:185], v5 offset:40960
  v_mfma_f32_16x16x32_bf16 v[44:47], v[152:155], v[144:147], v[44:47]
  ds_read_b64_tr_b16 v[186:187], v5 offset:41984
  s_waitcnt lgkmcnt(10)
  v_mfma_f32_16x16x32_bf16 v[48:51], v[156:159], v[132:135], v[48:51]
  ds_read_b64_tr_b16 v[188:189], v4 offset:41216
  v_mfma_f32_16x16x32_bf16 v[52:55], v[156:159], v[136:139], v[52:55]
  ds_read_b64_tr_b16 v[190:191], v4 offset:42240
  v_mfma_f32_16x16x32_bf16 v[56:59], v[156:159], v[140:143], v[56:59]
  ds_read_b64_tr_b16 v[192:193], v5 offset:41216
  v_mfma_f32_16x16x32_bf16 v[60:63], v[156:159], v[144:147], v[60:63]
  ds_read_b64_tr_b16 v[194:195], v5 offset:42240
  s_waitcnt lgkmcnt(12)
  v_mfma_f32_16x16x32_bf16 v[64:67], v[160:163], v[132:135], v[64:67]
  v_mfma_f32_16x16x32_bf16 v[68:71], v[160:163], v[136:139], v[68:71]
  v_mfma_f32_16x16x32_bf16 v[72:75], v[160:163], v[140:143], v[72:75]
  v_mfma_f32_16x16x32_bf16 v[76:79], v[160:163], v[144:147], v[76:79]
  s_waitcnt lgkmcnt(9)
  v_mfma_f32_16x16x32_bf16 v[16:19], v[180:183], v[164:167], v[16:19]
  s_waitcnt lgkmcnt(8)
  v_mfma_f32_16x16x32_bf16 v[20:23], v[180:183], v[168:171], v[20:23]
  s_waitcnt lgkmcnt(7)
  v_mfma_f32_16x16x32_bf16 v[24:27], v[180:183], v[172:175], v[24:27]
  s_waitcnt lgkmcnt(6)
  v_mfma_f32_16x16x32_bf16 v[28:31], v[180:183], v[176:179], v[28:31]
  s_waitcnt lgkmcnt(0)
  s_barrier
  v_mfma_f32_16x16x32_bf16 v[32:35], v[184:187], v[164:167], v[32:35]
  ds_read_b64_tr_b16 v[148:149], v9 offset:0
  v_mfma_f32_16x16x32_bf16 v[36:39], v[184:187], v[168:171], v[36:39]
  ds_read_b64_tr_b16 v[150:151], v9 offset:1024
  v_mfma_f32_16x16x32_bf16 v[40:43], v[184:187], v[172:175], v[40:43]
  ds_read_b128 v[132:135], v7 offset:0
  v_mfma_f32_16x16x32_bf16 v[44:47], v[184:187], v[176:179], v[44:47]
  ds_read_b128 v[136:139], v7 offset:2048
  v_mfma_f32_16x16x32_bf16 v[48:51], v[188:191], v[164:167], v[48:51]
  ds_read_b128 v[140:143], v7 offset:4096
  v_mfma_f32_16x16x32_bf16 v[52:55], v[188:191], v[168:171], v[52:55]
  ds_read_b128 v[144:147], v7 offset:6144
  v_mfma_f32_16x16x32_bf16 v[56:59], v[188:191], v[172:175], v[56:59]
  ds_read_b64_tr_b16 v[152:153], v10 offset:0
  v_mfma_f32_16x16x32_bf16 v[60:63], v[188:191], v[176:179], v[60:63]
  ds_read_b64_tr_b16 v[154:155], v10 offset:1024
  v_mfma_f32_16x16x32_bf16 v[64:67], v[192:195], v[164:167], v[64:67]
  ds_read_b64_tr_b16 v[156:157], v9 offset:256
  v_mfma_f32_16x16x32_bf16 v[68:71], v[192:195], v[168:171], v[68:71]
  ds_read_b64_tr_b16 v[158:159], v9 offset:1280
  v_mfma_f32_16x16x32_bf16 v[72:75], v[192:195], v[172:175], v[72:75]
  ds_read_b64_tr_b16 v[160:161], v10 offset:256
  v_mfma_f32_16x16x32_bf16 v[76:79], v[192:195], v[176:179], v[76:79]
  ds_read_b64_tr_b16 v[162:163], v10 offset:1280
  s_waitcnt lgkmcnt(9)
  v_mfma_f32_16x16x32_bf16 v[16:19], v[148:151], v[132:135], v[16:19]
  ds_read_b64_tr_b16 v[180:181], v9 offset:8192
  s_waitcnt lgkmcnt(9)
  v_mfma_f32_16x16x32_bf16 v[20:23], v[148:151], v[136:139], v[20:23]
  ds_read_b64_tr_b16 v[182:183], v9 offset:9216
  s_waitcnt lgkmcnt(9)
  v_mfma_f32_16x16x32_bf16 v[24:27], v[148:151], v[140:143], v[24:27]
  ds_read_b128 v[164:167], v8 offset:0
  s_waitcnt lgkmcnt(9)
  v_mfma_f32_16x16x32_bf16 v[28:31], v[148:151], v[144:147], v[28:31]
  ds_read_b128 v[168:171], v8 offset:2048
  s_waitcnt lgkmcnt(8)
  v_mfma_f32_16x16x32_bf16 v[32:35], v[152:155], v[132:135], v[32:35]
  ds_read_b128 v[172:175], v8 offset:4096
  v_mfma_f32_16x16x32_bf16 v[36:39], v[152:155], v[136:139], v[36:39]
  ds_read_b128 v[176:179], v8 offset:6144
  v_mfma_f32_16x16x32_bf16 v[40:43], v[152:155], v[140:143], v[40:43]
  ds_read_b64_tr_b16 v[184:185], v10 offset:8192
  v_mfma_f32_16x16x32_bf16 v[44:47], v[152:155], v[144:147], v[44:47]
  ds_read_b64_tr_b16 v[186:187], v10 offset:9216
  s_waitcnt lgkmcnt(10)
  v_mfma_f32_16x16x32_bf16 v[48:51], v[156:159], v[132:135], v[48:51]
  ds_read_b64_tr_b16 v[188:189], v9 offset:8448
  v_mfma_f32_16x16x32_bf16 v[52:55], v[156:159], v[136:139], v[52:55]
  ds_read_b64_tr_b16 v[190:191], v9 offset:9472
  v_mfma_f32_16x16x32_bf16 v[56:59], v[156:159], v[140:143], v[56:59]
  ds_read_b64_tr_b16 v[192:193], v10 offset:8448
  v_mfma_f32_16x16x32_bf16 v[60:63], v[156:159], v[144:147], v[60:63]
  ds_read_b64_tr_b16 v[194:195], v10 offset:9472
  s_waitcnt lgkmcnt(12)
  v_mfma_f32_16x16x32_bf16 v[64:67], v[160:163], v[132:135], v[64:67]
  v_mfma_f32_16x16x32_bf16 v[68:71], v[160:163], v[136:139], v[68:71]
  v_mfma_f32_16x16x32_bf16 v[72:75], v[160:163], v[140:143], v[72:75]
  v_mfma_f32_16x16x32_bf16 v[76:79], v[160:163], v[144:147], v[76:79]
  s_waitcnt lgkmcnt(9)
  v_mfma_f32_16x16x32_bf16 v[16:19], v[180:183], v[164:167], v[16:19]
  s_waitcnt lgkmcnt(8)
  v_mfma_f32_16x16x32_bf16 v[20:23], v[180:183], v[168:171], v[20:23]
  s_waitcnt lgkmcnt(7)
  v_mfma_f32_16x16x32_bf16 v[24:27], v[180:183], v[172:175], v[24:27]
  s_waitcnt lgkmcnt(6)
  v_mfma_f32_16x16x32_bf16 v[28:31], v[180:183], v[176:179], v[28:31]
  s_waitcnt lgkmcnt(0)
  s_barrier
  v_mfma_f32_16x16x32_bf16 v[32:35], v[184:187], v[164:167], v[32:35]
  ds_read_b64_tr_b16 v[148:149], v9 offset:32768
  v_mfma_f32_16x16x32_bf16 v[36:39], v[184:187], v[168:171], v[36:39]
  ds_read_b64_tr_b16 v[150:151], v9 offset:33792
  v_mfma_f32_16x16x32_bf16 v[40:43], v[184:187], v[172:175], v[40:43]
  ds_read_b128 v[132:135], v7 offset:32768
  v_mfma_f32_16x16x32_bf16 v[44:47], v[184:187], v[176:179], v[44:47]
  ds_read_b128 v[136:139], v7 offset:34816
  v_mfma_f32_16x16x32_bf16 v[48:51], v[188:191], v[164:167], v[48:51]
  ds_read_b128 v[140:143], v7 offset:36864
  v_mfma_f32_16x16x32_bf16 v[52:55], v[188:191], v[168:171], v[52:55]
  ds_read_b128 v[144:147], v7 offset:38912
  v_mfma_f32_16x16x32_bf16 v[56:59], v[188:191], v[172:175], v[56:59]
  ds_read_b64_tr_b16 v[152:153], v10 offset:32768
  v_mfma_f32_16x16x32_bf16 v[60:63], v[188:191], v[176:179], v[60:63]
  ds_read_b64_tr_b16 v[154:155], v10 offset:33792
  v_mfma_f32_16x16x32_bf16 v[64:67], v[192:195], v[164:167], v[64:67]
  ds_read_b64_tr_b16 v[156:157], v9 offset:33024
  v_mfma_f32_16x16x32_bf16 v[68:71], v[192:195], v[168:171], v[68:71]
  ds_read_b64_tr_b16 v[158:159], v9 offset:34048
  v_mfma_f32_16x16x32_bf16 v[72:75], v[192:195], v[172:175], v[72:75]
  ds_read_b64_tr_b16 v[160:161], v10 offset:33024
  v_mfma_f32_16x16x32_bf16 v[76:79], v[192:195], v[176:179], v[76:79]
  ds_read_b64_tr_b16 v[162:163], v10 offset:34048
  s_waitcnt lgkmcnt(9)
  v_mfma_f32_16x16x32_bf16 v[16:19], v[148:151], v[132:135], v[16:19]
  ds_read_b64_tr_b16 v[180:181], v9 offset:40960
  s_waitcnt lgkmcnt(9)
  v_mfma_f32_16x16x32_bf16 v[20:23], v[148:151], v[136:139], v[20:23]
  ds_read_b64_tr_b16 v[182:183], v9 offset:41984
  s_waitcnt lgkmcnt(9)
  v_mfma_f32_16x16x32_bf16 v[24:27], v[148:151], v[140:143], v[24:27]
  ds_read_b128 v[164:167], v8 offset:32768
  s_waitcnt lgkmcnt(9)
  v_mfma_f32_16x16x32_bf16 v[28:31], v[148:151], v[144:147], v[28:31]
  ds_read_b128 v[168:171], v8 offset:34816
  s_waitcnt lgkmcnt(8)
  v_mfma_f32_16x16x32_bf16 v[32:35], v[152:155], v[132:135], v[32:35]
  ds_read_b128 v[172:175], v8 offset:36864
  v_mfma_f32_16x16x32_bf16 v[36:39], v[152:155], v[136:139], v[36:39]
  ds_read_b128 v[176:179], v8 offset:38912
  v_mfma_f32_16x16x32_bf16 v[40:43], v[152:155], v[140:143], v[40:43]
  ds_read_b64_tr_b16 v[184:185], v10 offset:40960
  v_mfma_f32_16x16x32_bf16 v[44:47], v[152:155], v[144:147], v[44:47]
  ds_read_b64_tr_b16 v[186:187], v10 offset:41984
  s_waitcnt lgkmcnt(10)
  v_mfma_f32_16x16x32_bf16 v[48:51], v[156:159], v[132:135], v[48:51]
  ds_read_b64_tr_b16 v[188:189], v9 offset:41216
  v_mfma_f32_16x16x32_bf16 v[52:55], v[156:159], v[136:139], v[52:55]
  ds_read_b64_tr_b16 v[190:191], v9 offset:42240
  v_mfma_f32_16x16x32_bf16 v[56:59], v[156:159], v[140:143], v[56:59]
  ds_read_b64_tr_b16 v[192:193], v10 offset:41216
  v_mfma_f32_16x16x32_bf16 v[60:63], v[156:159], v[144:147], v[60:63]
  ds_read_b64_tr_b16 v[194:195], v10 offset:42240
  s_waitcnt lgkmcnt(12)
  v_mfma_f32_16x16x32_bf16 v[64:67], v[160:163], v[132:135], v[64:67]
  v_mfma_f32_16x16x32_bf16 v[68:71], v[160:163], v[136:139], v[68:71]
  v_mfma_f32_16x16x32_bf16 v[72:75], v[160:163], v[140:143], v[72:75]
  v_mfma_f32_16x16x32_bf16 v[76:79], v[160:163], v[144:147], v[76:79]
  s_waitcnt lgkmcnt(9)
  v_mfma_f32_16x16x32_bf16 v[16:19], v[180:183], v[164:167], v[16:19]
  s_waitcnt lgkmcnt(8)
  v_mfma_f32_16x16x32_bf16 v[20:23], v[180:183], v[168:171], v[20:23]
  s_waitcnt lgkmcnt(7)
  v_mfma_f32_16x16x32_bf16 v[24:27], v[180:183], v[172:175], v[24:27]
  s_waitcnt lgkmcnt(6)
  v_mfma_f32_16x16x32_bf16 v[28:31], v[180:183], v[176:179], v[28:31]
  s_waitcnt lgkmcnt(0)
  s_barrier
  v_mfma_f32_16x16x32_bf16 v[32:35], v[184:187], v[164:167], v[32:35]
  ds_read_b64_tr_b16 v[148:149], v4 offset:0
  v_mfma_f32_16x16x32_bf16 v[36:39], v[184:187], v[168:171], v[36:39]
  ds_read_b64_tr_b16 v[150:151], v4 offset:1024
  v_mfma_f32_16x16x32_bf16 v[40:43], v[184:187], v[172:175], v[40:43]
  ds_read_b128 v[132:135], v2 offset:0
  v_mfma_f32_16x16x32_bf16 v[44:47], v[184:187], v[176:179], v[44:47]
  ds_read_b128 v[136:139], v2 offset:2048
  v_mfma_f32_16x16x32_bf16 v[48:51], v[188:191], v[164:167], v[48:51]
  ds_read_b128 v[140:143], v2 offset:4096
  v_mfma_f32_16x16x32_bf16 v[52:55], v[188:191], v[168:171], v[52:55]
  ds_read_b128 v[144:147], v2 offset:6144
  v_mfma_f32_16x16x32_bf16 v[56:59], v[188:191], v[172:175], v[56:59]
  ds_read_b64_tr_b16 v[152:153], v5 offset:0
  v_mfma_f32_16x16x32_bf16 v[60:63], v[188:191], v[176:179], v[60:63]
  ds_read_b64_tr_b16 v[154:155], v5 offset:1024
  v_mfma_f32_16x16x32_bf16 v[64:67], v[192:195], v[164:167], v[64:67]
  ds_read_b64_tr_b16 v[156:157], v4 offset:256
  v_mfma_f32_16x16x32_bf16 v[68:71], v[192:195], v[168:171], v[68:71]
  ds_read_b64_tr_b16 v[158:159], v4 offset:1280
  v_mfma_f32_16x16x32_bf16 v[72:75], v[192:195], v[172:175], v[72:75]
  ds_read_b64_tr_b16 v[160:161], v5 offset:256
  v_mfma_f32_16x16x32_bf16 v[76:79], v[192:195], v[176:179], v[76:79]
  ds_read_b64_tr_b16 v[162:163], v5 offset:1280
  s_waitcnt lgkmcnt(9)
  v_mfma_f32_16x16x32_bf16 v[16:19], v[148:151], v[132:135], v[16:19]
  ds_read_b64_tr_b16 v[180:181], v4 offset:8192
  s_waitcnt lgkmcnt(9)
  v_mfma_f32_16x16x32_bf16 v[20:23], v[148:151], v[136:139], v[20:23]
  ds_read_b64_tr_b16 v[182:183], v4 offset:9216
  s_waitcnt lgkmcnt(9)
  v_mfma_f32_16x16x32_bf16 v[24:27], v[148:151], v[140:143], v[24:27]
  ds_read_b128 v[164:167], v3 offset:0
  s_waitcnt lgkmcnt(9)
  v_mfma_f32_16x16x32_bf16 v[28:31], v[148:151], v[144:147], v[28:31]
  ds_read_b128 v[168:171], v3 offset:2048
  s_waitcnt lgkmcnt(8)
  v_mfma_f32_16x16x32_bf16 v[32:35], v[152:155], v[132:135], v[32:35]
  ds_read_b128 v[172:175], v3 offset:4096
  v_mfma_f32_16x16x32_bf16 v[36:39], v[152:155], v[136:139], v[36:39]
  ds_read_b128 v[176:179], v3 offset:6144
  v_mfma_f32_16x16x32_bf16 v[40:43], v[152:155], v[140:143], v[40:43]
  ds_read_b64_tr_b16 v[184:185], v5 offset:8192
  v_mfma_f32_16x16x32_bf16 v[44:47], v[152:155], v[144:147], v[44:47]
  ds_read_b64_tr_b16 v[186:187], v5 offset:9216
  s_waitcnt lgkmcnt(10)
  v_mfma_f32_16x16x32_bf16 v[48:51], v[156:159], v[132:135], v[48:51]
  ds_read_b64_tr_b16 v[188:189], v4 offset:8448
  v_mfma_f32_16x16x32_bf16 v[52:55], v[156:159], v[136:139], v[52:55]
  ds_read_b64_tr_b16 v[190:191], v4 offset:9472
  v_mfma_f32_16x16x32_bf16 v[56:59], v[156:159], v[140:143], v[56:59]
  ds_read_b64_tr_b16 v[192:193], v5 offset:8448
  v_mfma_f32_16x16x32_bf16 v[60:63], v[156:159], v[144:147], v[60:63]
  ds_read_b64_tr_b16 v[194:195], v5 offset:9472
  s_waitcnt lgkmcnt(12)
  v_mfma_f32_16x16x32_bf16 v[64:67], v[160:163], v[132:135], v[64:67]
  v_mfma_f32_16x16x32_bf16 v[68:71], v[160:163], v[136:139], v[68:71]
  v_mfma_f32_16x16x32_bf16 v[72:75], v[160:163], v[140:143], v[72:75]
  v_mfma_f32_16x16x32_bf16 v[76:79], v[160:163], v[144:147], v[76:79]
  s_waitcnt lgkmcnt(9)
  v_mfma_f32_16x16x32_bf16 v[16:19], v[180:183], v[164:167], v[16:19]
  s_waitcnt lgkmcnt(8)
  v_mfma_f32_16x16x32_bf16 v[20:23], v[180:183], v[168:171], v[20:23]
  s_waitcnt lgkmcnt(7)
  v_mfma_f32_16x16x32_bf16 v[24:27], v[180:183], v[172:175], v[24:27]
  s_waitcnt lgkmcnt(6)
  v_mfma_f32_16x16x32_bf16 v[28:31], v[180:183], v[176:179], v[28:31]
  s_waitcnt lgkmcnt(0)
  s_barrier
  v_mfma_f32_16x16x32_bf16 v[32:35], v[184:187], v[164:167], v[32:35]
  ds_read_b64_tr_b16 v[148:149], v4 offset:32768
  v_mfma_f32_16x16x32_bf16 v[36:39], v[184:187], v[168:171], v[36:39]
  ds_read_b64_tr_b16 v[150:151], v4 offset:33792
  v_mfma_f32_16x16x32_bf16 v[40:43], v[184:187], v[172:175], v[40:43]
  ds_read_b128 v[132:135], v2 offset:32768
  v_mfma_f32_16x16x32_bf16 v[44:47], v[184:187], v[176:179], v[44:47]
  ds_read_b128 v[136:139], v2 offset:34816
  v_mfma_f32_16x16x32_bf16 v[48:51], v[188:191], v[164:167], v[48:51]
  ds_read_b128 v[140:143], v2 offset:36864
  v_mfma_f32_16x16x32_bf16 v[52:55], v[188:191], v[168:171], v[52:55]
  ds_read_b128 v[144:147], v2 offset:38912
  v_mfma_f32_16x16x32_bf16 v[56:59], v[188:191], v[172:175], v[56:59]
  ds_read_b64_tr_b16 v[152:153], v5 offset:32768
  v_mfma_f32_16x16x32_bf16 v[60:63], v[188:191], v[176:179], v[60:63]
  ds_read_b64_tr_b16 v[154:155], v5 offset:33792
  v_mfma_f32_16x16x32_bf16 v[64:67], v[192:195], v[164:167], v[64:67]
  ds_read_b64_tr_b16 v[156:157], v4 offset:33024
  v_mfma_f32_16x16x32_bf16 v[68:71], v[192:195], v[168:171], v[68:71]
  ds_read_b64_tr_b16 v[158:159], v4 offset:34048
  v_mfma_f32_16x16x32_bf16 v[72:75], v[192:195], v[172:175], v[72:75]
  ds_read_b64_tr_b16 v[160:161], v5 offset:33024
  v_mfma_f32_16x16x32_bf16 v[76:79], v[192:195], v[176:179], v[76:79]
  ds_read_b64_tr_b16 v[162:163], v5 offset:34048
  s_waitcnt lgkmcnt(9)
  v_mfma_f32_16x16x32_bf16 v[16:19], v[148:151], v[132:135], v[16:19]
  ds_read_b64_tr_b16 v[180:181], v4 offset:40960
  s_waitcnt lgkmcnt(9)
  v_mfma_f32_16x16x32_bf16 v[20:23], v[148:151], v[136:139], v[20:23]
  ds_read_b64_tr_b16 v[182:183], v4 offset:41984
  s_waitcnt lgkmcnt(9)
  v_mfma_f32_16x16x32_bf16 v[24:27], v[148:151], v[140:143], v[24:27]
  ds_read_b128 v[164:167], v3 offset:32768
  s_waitcnt lgkmcnt(9)
  v_mfma_f32_16x16x32_bf16 v[28:31], v[148:151], v[144:147], v[28:31]
  ds_read_b128 v[168:171], v3 offset:34816
  s_waitcnt lgkmcnt(8)
  v_mfma_f32_16x16x32_bf16 v[32:35], v[152:155], v[132:135], v[32:35]
  ds_read_b128 v[172:175], v3 offset:36864
  v_mfma_f32_16x16x32_bf16 v[36:39], v[152:155], v[136:139], v[36:39]
  ds_read_b128 v[176:179], v3 offset:38912
  v_mfma_f32_16x16x32_bf16 v[40:43], v[152:155], v[140:143], v[40:43]
  ds_read_b64_tr_b16 v[184:185], v5 offset:40960
  v_mfma_f32_16x16x32_bf16 v[44:47], v[152:155], v[144:147], v[44:47]
  ds_read_b64_tr_b16 v[186:187], v5 offset:41984
  s_waitcnt lgkmcnt(10)
  v_mfma_f32_16x16x32_bf16 v[48:51], v[156:159], v[132:135], v[48:51]
  ds_read_b64_tr_b16 v[188:189], v4 offset:41216
  v_mfma_f32_16x16x32_bf16 v[52:55], v[156:159], v[136:139], v[52:55]
  ds_read_b64_tr_b16 v[190:191], v4 offset:42240
  v_mfma_f32_16x16x32_bf16 v[56:59], v[156:159], v[140:143], v[56:59]
  ds_read_b64_tr_b16 v[192:193], v5 offset:41216
  v_mfma_f32_16x16x32_bf16 v[60:63], v[156:159], v[144:147], v[60:63]
  ds_read_b64_tr_b16 v[194:195], v5 offset:42240
  s_waitcnt lgkmcnt(12)
  v_mfma_f32_16x16x32_bf16 v[64:67], v[160:163], v[132:135], v[64:67]
  v_mfma_f32_16x16x32_bf16 v[68:71], v[160:163], v[136:139], v[68:71]
  v_mfma_f32_16x16x32_bf16 v[72:75], v[160:163], v[140:143], v[72:75]
  v_mfma_f32_16x16x32_bf16 v[76:79], v[160:163], v[144:147], v[76:79]
  s_waitcnt lgkmcnt(9)
  v_mfma_f32_16x16x32_bf16 v[16:19], v[180:183], v[164:167], v[16:19]
  s_waitcnt lgkmcnt(8)
  v_mfma_f32_16x16x32_bf16 v[20:23], v[180:183], v[168:171], v[20:23]
  s_waitcnt lgkmcnt(7)
  v_mfma_f32_16x16x32_bf16 v[24:27], v[180:183], v[172:175], v[24:27]
  s_waitcnt lgkmcnt(6)
  v_mfma_f32_16x16x32_bf16 v[28:31], v[180:183], v[176:179], v[28:31]
  s_waitcnt lgkmcnt(0)
  s_barrier
  v_mfma_f32_16x16x32_bf16 v[32:35], v[184:187], v[164:167], v[32:35]
  ds_read_b64_tr_b16 v[148:149], v9 offset:0
  v_mfma_f32_16x16x32_bf16 v[36:39], v[184:187], v[168:171], v[36:39]
  ds_read_b64_tr_b16 v[150:151], v9 offset:1024
  v_mfma_f32_16x16x32_bf16 v[40:43], v[184:187], v[172:175], v[40:43]
  ds_read_b128 v[132:135], v7 offset:0
  v_mfma_f32_16x16x32_bf16 v[44:47], v[184:187], v[176:179], v[44:47]
  ds_read_b128 v[136:139], v7 offset:2048
  v_mfma_f32_16x16x32_bf16 v[48:51], v[188:191], v[164:167], v[48:51]
  ds_read_b128 v[140:143], v7 offset:4096
  v_mfma_f32_16x16x32_bf16 v[52:55], v[188:191], v[168:171], v[52:55]
  ds_read_b128 v[144:147], v7 offset:6144
  v_mfma_f32_16x16x32_bf16 v[56:59], v[188:191], v[172:175], v[56:59]
  ds_read_b64_tr_b16 v[152:153], v10 offset:0
  v_mfma_f32_16x16x32_bf16 v[60:63], v[188:191], v[176:179], v[60:63]
  ds_read_b64_tr_b16 v[154:155], v10 offset:1024
  v_mfma_f32_16x16x32_bf16 v[64:67], v[192:195], v[164:167], v[64:67]
  ds_read_b64_tr_b16 v[156:157], v9 offset:256
  v_mfma_f32_16x16x32_bf16 v[68:71], v[192:195], v[168:171], v[68:71]
  ds_read_b64_tr_b16 v[158:159], v9 offset:1280
  v_mfma_f32_16x16x32_bf16 v[72:75], v[192:195], v[172:175], v[72:75]
  ds_read_b64_tr_b16 v[160:161], v10 offset:256
  v_mfma_f32_16x16x32_bf16 v[76:79], v[192:195], v[176:179], v[76:79]
  ds_read_b64_tr_b16 v[162:163], v10 offset:1280
  s_waitcnt lgkmcnt(9)
  v_mfma_f32_16x16x32_bf16 v[16:19], v[148:151], v[132:135], v[16:19]
  ds_read_b64_tr_b16 v[180:181], v9 offset:8192
  s_waitcnt lgkmcnt(9)
  v_mfma_f32_16x16x32_bf16 v[20:23], v[148:151], v[136:139], v[20:23]
  ds_read_b64_tr_b16 v[182:183], v9 offset:9216
  s_waitcnt lgkmcnt(9)
  v_mfma_f32_16x16x32_bf16 v[24:27], v[148:151], v[140:143], v[24:27]
  ds_read_b128 v[164:167], v8 offset:0
  s_waitcnt lgkmcnt(9)
  v_mfma_f32_16x16x32_bf16 v[28:31], v[148:151], v[144:147], v[28:31]
  ds_read_b128 v[168:171], v8 offset:2048
  s_waitcnt lgkmcnt(8)
  v_mfma_f32_16x16x32_bf16 v[32:35], v[152:155], v[132:135], v[32:35]
  ds_read_b128 v[172:175], v8 offset:4096
  v_mfma_f32_16x16x32_bf16 v[36:39], v[152:155], v[136:139], v[36:39]
  ds_read_b128 v[176:179], v8 offset:6144
  v_mfma_f32_16x16x32_bf16 v[40:43], v[152:155], v[140:143], v[40:43]
  ds_read_b64_tr_b16 v[184:185], v10 offset:8192
  v_mfma_f32_16x16x32_bf16 v[44:47], v[152:155], v[144:147], v[44:47]
  ds_read_b64_tr_b16 v[186:187], v10 offset:9216
  s_waitcnt lgkmcnt(10)
  v_mfma_f32_16x16x32_bf16 v[48:51], v[156:159], v[132:135], v[48:51]
  ds_read_b64_tr_b16 v[188:189], v9 offset:8448
  v_mfma_f32_16x16x32_bf16 v[52:55], v[156:159], v[136:139], v[52:55]
  ds_read_b64_tr_b16 v[190:191], v9 offset:9472
  v_mfma_f32_16x16x32_bf16 v[56:59], v[156:159], v[140:143], v[56:59]
  ds_read_b64_tr_b16 v[192:193], v10 offset:8448
  v_mfma_f32_16x16x32_bf16 v[60:63], v[156:159], v[144:147], v[60:63]
  ds_read_b64_tr_b16 v[194:195], v10 offset:9472
  s_waitcnt lgkmcnt(12)
  v_mfma_f32_16x16x32_bf16 v[64:67], v[160:163], v[132:135], v[64:67]
  v_mfma_f32_16x16x32_bf16 v[68:71], v[160:163], v[136:139], v[68:71]
  v_mfma_f32_16x16x32_bf16 v[72:75], v[160:163], v[140:143], v[72:75]
  v_mfma_f32_16x16x32_bf16 v[76:79], v[160:163], v[144:147], v[76:79]
  s_waitcnt lgkmcnt(9)
  v_mfma_f32_16x16x32_bf16 v[16:19], v[180:183], v[164:167], v[16:19]
  s_waitcnt lgkmcnt(8)
  v_mfma_f32_16x16x32_bf16 v[20:23], v[180:183], v[168:171], v[20:23]
  s_waitcnt lgkmcnt(7)
  v_mfma_f32_16x16x32_bf16 v[24:27], v[180:183], v[172:175], v[24:27]
  s_waitcnt lgkmcnt(6)
  v_mfma_f32_16x16x32_bf16 v[28:31], v[180:183], v[176:179], v[28:31]
  s_waitcnt lgkmcnt(0)
  s_barrier
  v_mfma_f32_16x16x32_bf16 v[32:35], v[184:187], v[164:167], v[32:35]
  ds_read_b64_tr_b16 v[148:149], v9 offset:32768
  v_mfma_f32_16x16x32_bf16 v[36:39], v[184:187], v[168:171], v[36:39]
  ds_read_b64_tr_b16 v[150:151], v9 offset:33792
  v_mfma_f32_16x16x32_bf16 v[40:43], v[184:187], v[172:175], v[40:43]
  ds_read_b128 v[132:135], v7 offset:32768
  v_mfma_f32_16x16x32_bf16 v[44:47], v[184:187], v[176:179], v[44:47]
  ds_read_b128 v[136:139], v7 offset:34816
  v_mfma_f32_16x16x32_bf16 v[48:51], v[188:191], v[164:167], v[48:51]
  ds_read_b128 v[140:143], v7 offset:36864
  v_mfma_f32_16x16x32_bf16 v[52:55], v[188:191], v[168:171], v[52:55]
  ds_read_b128 v[144:147], v7 offset:38912
  v_mfma_f32_16x16x32_bf16 v[56:59], v[188:191], v[172:175], v[56:59]
  ds_read_b64_tr_b16 v[152:153], v10 offset:32768
  v_mfma_f32_16x16x32_bf16 v[60:63], v[188:191], v[176:179], v[60:63]
  ds_read_b64_tr_b16 v[154:155], v10 offset:33792
  v_mfma_f32_16x16x32_bf16 v[64:67], v[192:195], v[164:167], v[64:67]
  ds_read_b64_tr_b16 v[156:157], v9 offset:33024
  v_mfma_f32_16x16x32_bf16 v[68:71], v[192:195], v[168:171], v[68:71]
  ds_read_b64_tr_b16 v[158:159], v9 offset:34048
  v_mfma_f32_16x16x32_bf16 v[72:75], v[192:195], v[172:175], v[72:75]
  ds_read_b64_tr_b16 v[160:161], v10 offset:33024
  v_mfma_f32_16x16x32_bf16 v[76:79], v[192:195], v[176:179], v[76:79]
  ds_read_b64_tr_b16 v[162:163], v10 offset:34048
  s_waitcnt lgkmcnt(9)
  v_mfma_f32_16x16x32_bf16 v[16:19], v[148:151], v[132:135], v[16:19]
  ds_read_b64_tr_b16 v[180:181], v9 offset:40960
  s_waitcnt lgkmcnt(9)
  v_mfma_f32_16x16x32_bf16 v[20:23], v[148:151], v[136:139], v[20:23]
  ds_read_b64_tr_b16 v[182:183], v9 offset:41984
  s_waitcnt lgkmcnt(9)
  v_mfma_f32_16x16x32_bf16 v[24:27], v[148:151], v[140:143], v[24:27]
  ds_read_b128 v[164:167], v8 offset:32768
  s_waitcnt lgkmcnt(9)
  v_mfma_f32_16x16x32_bf16 v[28:31], v[148:151], v[144:147], v[28:31]
  ds_read_b128 v[168:171], v8 offset:34816
  s_waitcnt lgkmcnt(8)
  v_mfma_f32_16x16x32_bf16 v[32:35], v[152:155], v[132:135], v[32:35]
  ds_read_b128 v[172:175], v8 offset:36864
  v_mfma_f32_16x16x32_bf16 v[36:39], v[152:155], v[136:139], v[36:39]
  ds_read_b128 v[176:179], v8 offset:38912
  v_mfma_f32_16x16x32_bf16 v[40:43], v[152:155], v[140:143], v[40:43]
  ds_read_b64_tr_b16 v[184:185], v10 offset:40960
  v_mfma_f32_16x16x32_bf16 v[44:47], v[152:155], v[144:147], v[44:47]
  ds_read_b64_tr_b16 v[186:187], v10 offset:41984
  s_waitcnt lgkmcnt(10)
  v_mfma_f32_16x16x32_bf16 v[48:51], v[156:159], v[132:135], v[48:51]
  ds_read_b64_tr_b16 v[188:189], v9 offset:41216
  v_mfma_f32_16x16x32_bf16 v[52:55], v[156:159], v[136:139], v[52:55]
  ds_read_b64_tr_b16 v[190:191], v9 offset:42240
  v_mfma_f32_16x16x32_bf16 v[56:59], v[156:159], v[140:143], v[56:59]
  ds_read_b64_tr_b16 v[192:193], v10 offset:41216
  v_mfma_f32_16x16x32_bf16 v[60:63], v[156:159], v[144:147], v[60:63]
  ds_read_b64_tr_b16 v[194:195], v10 offset:42240
  s_waitcnt lgkmcnt(12)
  v_mfma_f32_16x16x32_bf16 v[64:67], v[160:163], v[132:135], v[64:67]
  v_mfma_f32_16x16x32_bf16 v[68:71], v[160:163], v[136:139], v[68:71]
  v_mfma_f32_16x16x32_bf16 v[72:75], v[160:163], v[140:143], v[72:75]
  v_mfma_f32_16x16x32_bf16 v[76:79], v[160:163], v[144:147], v[76:79]
  s_waitcnt lgkmcnt(9)
  v_mfma_f32_16x16x32_bf16 v[16:19], v[180:183], v[164:167], v[16:19]
  s_waitcnt lgkmcnt(8)
  v_mfma_f32_16x16x32_bf16 v[20:23], v[180:183], v[168:171], v[20:23]
  s_waitcnt lgkmcnt(7)
  v_mfma_f32_16x16x32_bf16 v[24:27], v[180:183], v[172:175], v[24:27]
  s_waitcnt lgkmcnt(6)
  v_mfma_f32_16x16x32_bf16 v[28:31], v[180:183], v[176:179], v[28:31]
  s_waitcnt lgkmcnt(0)
  s_barrier
  v_mfma_f32_16x16x32_bf16 v[32:35], v[184:187], v[164:167], v[32:35]
  ds_read_b64_tr_b16 v[148:149], v4 offset:0
  v_mfma_f32_16x16x32_bf16 v[36:39], v[184:187], v[168:171], v[36:39]
  ds_read_b64_tr_b16 v[150:151], v4 offset:1024
  v_mfma_f32_16x16x32_bf16 v[40:43], v[184:187], v[172:175], v[40:43]
  ds_read_b128 v[132:135], v2 offset:0
  v_mfma_f32_16x16x32_bf16 v[44:47], v[184:187], v[176:179], v[44:47]
  ds_read_b128 v[136:139], v2 offset:2048
  v_mfma_f32_16x16x32_bf16 v[48:51], v[188:191], v[164:167], v[48:51]
  ds_read_b128 v[140:143], v2 offset:4096
  v_mfma_f32_16x16x32_bf16 v[52:55], v[188:191], v[168:171], v[52:55]
  ds_read_b128 v[144:147], v2 offset:6144
  v_mfma_f32_16x16x32_bf16 v[56:59], v[188:191], v[172:175], v[56:59]
  ds_read_b64_tr_b16 v[152:153], v5 offset:0
  v_mfma_f32_16x16x32_bf16 v[60:63], v[188:191], v[176:179], v[60:63]
  ds_read_b64_tr_b16 v[154:155], v5 offset:1024
  v_mfma_f32_16x16x32_bf16 v[64:67], v[192:195], v[164:167], v[64:67]
  ds_read_b64_tr_b16 v[156:157], v4 offset:256
  v_mfma_f32_16x16x32_bf16 v[68:71], v[192:195], v[168:171], v[68:71]
  ds_read_b64_tr_b16 v[158:159], v4 offset:1280
  v_mfma_f32_16x16x32_bf16 v[72:75], v[192:195], v[172:175], v[72:75]
  ds_read_b64_tr_b16 v[160:161], v5 offset:256
  v_mfma_f32_16x16x32_bf16 v[76:79], v[192:195], v[176:179], v[76:79]
  ds_read_b64_tr_b16 v[162:163], v5 offset:1280
  s_waitcnt lgkmcnt(9)
  v_mfma_f32_16x16x32_bf16 v[16:19], v[148:151], v[132:135], v[16:19]
  ds_read_b64_tr_b16 v[180:181], v4 offset:8192
  s_waitcnt lgkmcnt(9)
  v_mfma_f32_16x16x32_bf16 v[20:23], v[148:151], v[136:139], v[20:23]
  ds_read_b64_tr_b16 v[182:183], v4 offset:9216
  s_waitcnt lgkmcnt(9)
  v_mfma_f32_16x16x32_bf16 v[24:27], v[148:151], v[140:143], v[24:27]
  ds_read_b128 v[164:167], v3 offset:0
  s_waitcnt lgkmcnt(9)
  v_mfma_f32_16x16x32_bf16 v[28:31], v[148:151], v[144:147], v[28:31]
  ds_read_b128 v[168:171], v3 offset:2048
  s_waitcnt lgkmcnt(8)
  v_mfma_f32_16x16x32_bf16 v[32:35], v[152:155], v[132:135], v[32:35]
  ds_read_b128 v[172:175], v3 offset:4096
  v_mfma_f32_16x16x32_bf16 v[36:39], v[152:155], v[136:139], v[36:39]
  ds_read_b128 v[176:179], v3 offset:6144
  v_mfma_f32_16x16x32_bf16 v[40:43], v[152:155], v[140:143], v[40:43]
  ds_read_b64_tr_b16 v[184:185], v5 offset:8192
  v_mfma_f32_16x16x32_bf16 v[44:47], v[152:155], v[144:147], v[44:47]
  ds_read_b64_tr_b16 v[186:187], v5 offset:9216
  s_waitcnt lgkmcnt(10)
  v_mfma_f32_16x16x32_bf16 v[48:51], v[156:159], v[132:135], v[48:51]
  ds_read_b64_tr_b16 v[188:189], v4 offset:8448
  v_mfma_f32_16x16x32_bf16 v[52:55], v[156:159], v[136:139], v[52:55]
  ds_read_b64_tr_b16 v[190:191], v4 offset:9472
  v_mfma_f32_16x16x32_bf16 v[56:59], v[156:159], v[140:143], v[56:59]
  ds_read_b64_tr_b16 v[192:193], v5 offset:8448
  v_mfma_f32_16x16x32_bf16 v[60:63], v[156:159], v[144:147], v[60:63]
  ds_read_b64_tr_b16 v[194:195], v5 offset:9472
  s_waitcnt lgkmcnt(12)
  v_mfma_f32_16x16x32_bf16 v[64:67], v[160:163], v[132:135], v[64:67]
  v_mfma_f32_16x16x32_bf16 v[68:71], v[160:163], v[136:139], v[68:71]
  v_mfma_f32_16x16x32_bf16 v[72:75], v[160:163], v[140:143], v[72:75]
  v_mfma_f32_16x16x32_bf16 v[76:79], v[160:163], v[144:147], v[76:79]
  s_waitcnt lgkmcnt(9)
  v_mfma_f32_16x16x32_bf16 v[16:19], v[180:183], v[164:167], v[16:19]
  s_waitcnt lgkmcnt(8)
  v_mfma_f32_16x16x32_bf16 v[20:23], v[180:183], v[168:171], v[20:23]
  s_waitcnt lgkmcnt(7)
  v_mfma_f32_16x16x32_bf16 v[24:27], v[180:183], v[172:175], v[24:27]
  s_waitcnt lgkmcnt(6)
  v_mfma_f32_16x16x32_bf16 v[28:31], v[180:183], v[176:179], v[28:31]
  s_waitcnt lgkmcnt(0)
  s_barrier
  v_mfma_f32_16x16x32_bf16 v[32:35], v[184:187], v[164:167], v[32:35]
  ds_read_b64_tr_b16 v[196:197], v4 offset:32768
  ds_read_b64_tr_b16 v[198:199], v4 offset:33792
  v_mfma_f32_16x16x32_bf16 v[36:39], v[184:187], v[168:171], v[36:39]
  ds_read_b128 v[132:135], v2 offset:32768
  ds_read_b128 v[136:139], v2 offset:34816
  v_mfma_f32_16x16x32_bf16 v[40:43], v[184:187], v[172:175], v[40:43]
  ds_read_b128 v[140:143], v2 offset:36864
  ds_read_b128 v[144:147], v2 offset:38912
  v_mfma_f32_16x16x32_bf16 v[44:47], v[184:187], v[176:179], v[44:47]
  ds_read_b64 v[244:245], v13 offset:0
  ds_read_b64 v[246:247], v13 offset:128
  v_mfma_f32_16x16x32_bf16 v[48:51], v[188:191], v[164:167], v[48:51]
  ds_read_b64 v[248:249], v13 offset:256
  ds_read_b64 v[250:251], v13 offset:384
  v_mfma_f32_16x16x32_bf16 v[52:55], v[188:191], v[168:171], v[52:55]
  ds_read_b64_tr_b16 v[200:201], v4 offset:40960
  ds_read_b64_tr_b16 v[202:203], v4 offset:41984
  v_mfma_f32_16x16x32_bf16 v[56:59], v[188:191], v[172:175], v[56:59]
  ds_read_b128 v[148:151], v3 offset:32768
  v_mfma_f32_16x16x32_bf16 v[60:63], v[188:191], v[176:179], v[60:63]
  ds_read_b128 v[152:155], v3 offset:34816
  v_mfma_f32_16x16x32_bf16 v[64:67], v[192:195], v[164:167], v[64:67]
  ds_read_b128 v[156:159], v3 offset:36864
  v_mfma_f32_16x16x32_bf16 v[68:71], v[192:195], v[168:171], v[68:71]
  s_waitcnt lgkmcnt(14)
  ds_read_b128 v[160:163], v3 offset:38912
  v_mfma_f32_16x16x32_bf16 v[72:75], v[192:195], v[172:175], v[72:75]
  s_waitcnt lgkmcnt(14)
  ds_read_b64_tr_b16 v[204:205], v9 offset:0
  v_mfma_f32_16x16x32_bf16 v[76:79], v[192:195], v[176:179], v[76:79]
  s_waitcnt lgkmcnt(14)
  ds_read_b64_tr_b16 v[206:207], v9 offset:1024
  v_mfma_f32_16x16x32_bf16 v[16:19], v[196:199], v[132:135], v[16:19]
  s_waitcnt lgkmcnt(14)
  ds_read_b64_tr_b16 v[208:209], v5 offset:32768
  s_waitcnt lgkmcnt(12)
  v_mov_b32 v164, v244
  v_mov_b32 v165, v244
  v_mov_b32 v166, v244
  v_mfma_f32_16x16x32_bf16 v[20:23], v[196:199], v[136:139], v[20:23]
  ds_read_b64_tr_b16 v[210:211], v5 offset:33792
  v_mov_b32 v167, v244
  s_waitcnt lgkmcnt(12)
  v_mov_b32 v168, v246
  v_mov_b32 v169, v246
  v_mfma_f32_16x16x32_bf16 v[24:27], v[196:199], v[140:143], v[24:27]
  ds_read_b64_tr_b16 v[212:213], v5 offset:40960
  v_mov_b32 v170, v246
  v_mov_b32 v171, v246
  s_waitcnt lgkmcnt(12)
  v_mov_b32 v172, v248
  v_mfma_f32_16x16x32_bf16 v[28:31], v[196:199], v[144:147], v[28:31]
  ds_read_b64_tr_b16 v[214:215], v5 offset:41984
  v_mov_b32 v173, v248
  v_mov_b32 v174, v248
  v_mov_b32 v175, v248
  s_waitcnt lgkmcnt(9)
  v_mfma_f32_16x16x32_bf16 v[16:19], v[200:203], v[148:151], v[16:19]
  ds_read_b64_tr_b16 v[216:217], v10 offset:0
  v_mov_b32 v176, v250
  v_mov_b32 v177, v250
  v_mov_b32 v178, v250
  s_waitcnt lgkmcnt(9)
  v_mfma_f32_16x16x32_bf16 v[20:23], v[200:203], v[152:155], v[20:23]
  ds_read_b64_tr_b16 v[218:219], v10 offset:1024
  v_mov_b32 v179, v250
  s_waitcnt lgkmcnt(9)
  v_mfma_f32_16x16x32_bf16 v[24:27], v[200:203], v[156:159], v[24:27]
  ds_read_b64_tr_b16 v[220:221], v4 offset:33024
  s_waitcnt lgkmcnt(9)
  v_mfma_f32_16x16x32_bf16 v[28:31], v[200:203], v[160:163], v[28:31]
  ds_read_b64_tr_b16 v[222:223], v4 offset:34048
  s_waitcnt lgkmcnt(8)
  v_mfma_f32_16x16x32_bf16 v[16:19], v[204:207], v[164:167], v[16:19]
  ds_read_b64_tr_b16 v[224:225], v4 offset:41216
  v_mfma_f32_16x16x32_bf16 v[20:23], v[204:207], v[168:171], v[20:23]
  ds_read_b64_tr_b16 v[226:227], v4 offset:42240
  v_mfma_f32_16x16x32_bf16 v[24:27], v[204:207], v[172:175], v[24:27]
  ds_read_b64_tr_b16 v[228:229], v9 offset:256
  v_mfma_f32_16x16x32_bf16 v[28:31], v[204:207], v[176:179], v[28:31]
  ds_read_b64_tr_b16 v[230:231], v9 offset:1280
  s_waitcnt lgkmcnt(10)
  v_mfma_f32_16x16x32_bf16 v[32:35], v[208:211], v[132:135], v[32:35]
  ds_read_b64_tr_b16 v[232:233], v5 offset:33024
  v_mfma_f32_16x16x32_bf16 v[36:39], v[208:211], v[136:139], v[36:39]
  ds_read_b64_tr_b16 v[234:235], v5 offset:34048
  v_mul_f32 v16, v245, v16
  v_mul_f32 v17, v245, v17
  v_mul_f32 v18, v245, v18
  v_mfma_f32_16x16x32_bf16 v[40:43], v[208:211], v[140:143], v[40:43]
  ds_read_b64_tr_b16 v[236:237], v5 offset:41216
  v_mul_f32 v19, v245, v19
  v_mul_f32 v20, v247, v20
  v_mul_f32 v21, v247, v21
  v_mfma_f32_16x16x32_bf16 v[44:47], v[208:211], v[144:147], v[44:47]
  ds_read_b64_tr_b16 v[238:239], v5 offset:42240
  v_mul_f32 v22, v247, v22
  v_mul_f32 v23, v247, v23
  v_cvt_pk_bf16_f32 v80, v16, v17
  s_waitcnt lgkmcnt(12)
  v_mfma_f32_16x16x32_bf16 v[32:35], v[212:215], v[148:151], v[32:35]
  ds_read_b64_tr_b16 v[240:241], v10 offset:256
  v_cvt_pk_bf16_f32 v81, v18, v19
  v_cvt_pk_bf16_f32 v82, v20, v21
  v_cvt_pk_bf16_f32 v83, v22, v23
  v_mfma_f32_16x16x32_bf16 v[36:39], v[212:215], v[152:155], v[36:39]
  ds_read_b64_tr_b16 v[242:243], v10 offset:1280
  v_mul_f32 v24, v249, v24
  v_mul_f32 v25, v249, v25
  v_mul_f32 v26, v249, v26
  v_mfma_f32_16x16x32_bf16 v[40:43], v[212:215], v[156:159], v[40:43]
  v_mul_f32 v27, v249, v27
  v_mul_f32 v28, v251, v28
  v_mul_f32 v29, v251, v29
  v_mfma_f32_16x16x32_bf16 v[44:47], v[212:215], v[160:163], v[44:47]
  v_mul_f32 v30, v251, v30
  v_mul_f32 v31, v251, v31
  v_cvt_pk_bf16_f32 v84, v24, v25
  s_waitcnt lgkmcnt(12)
  v_mfma_f32_16x16x32_bf16 v[32:35], v[216:219], v[164:167], v[32:35]
  v_cvt_pk_bf16_f32 v85, v26, v27
  v_cvt_pk_bf16_f32 v86, v28, v29
  v_cvt_pk_bf16_f32 v87, v30, v31
  v_mfma_f32_16x16x32_bf16 v[36:39], v[216:219], v[168:171], v[36:39]
  v_permlane16_swap_b32 v80, v82
  v_permlane16_swap_b32 v81, v83
  s_add_u32 s39, s38, 0x0
  buffer_store_dwordx4 v[80:83], v12, s[8:11], s39 offen sc1
  v_mfma_f32_16x16x32_bf16 v[40:43], v[216:219], v[172:175], v[40:43]
  v_permlane16_swap_b32 v84, v86
  v_permlane16_swap_b32 v85, v87
  s_add_u32 s39, s38, 0x200
  buffer_store_dwordx4 v[84:87], v12, s[8:11], s39 offen sc1
  v_mfma_f32_16x16x32_bf16 v[44:47], v[216:219], v[176:179], v[44:47]
  s_waitcnt lgkmcnt(0)
  s_barrier
  v_mfma_f32_16x16x32_bf16 v[48:51], v[220:223], v[132:135], v[48:51]
  v_mfma_f32_16x16x32_bf16 v[52:55], v[220:223], v[136:139], v[52:55]
  v_mul_f32 v32, v245, v32
  v_mul_f32 v33, v245, v33
  v_mul_f32 v34, v245, v34
  v_mfma_f32_16x16x32_bf16 v[56:59], v[220:223], v[140:143], v[56:59]
  v_mul_f32 v35, v245, v35
  v_mul_f32 v36, v247, v36
  v_mul_f32 v37, v247, v37
  v_mfma_f32_16x16x32_bf16 v[60:63], v[220:223], v[144:147], v[60:63]
  v_mul_f32 v38, v247, v38
  v_mul_f32 v39, v247, v39
  v_cvt_pk_bf16_f32 v88, v32, v33
  v_mfma_f32_16x16x32_bf16 v[48:51], v[224:227], v[148:151], v[48:51]
  v_cvt_pk_bf16_f32 v89, v34, v35
  v_cvt_pk_bf16_f32 v90, v36, v37
  v_cvt_pk_bf16_f32 v91, v38, v39
  v_mfma_f32_16x16x32_bf16 v[52:55], v[224:227], v[152:155], v[52:55]
  v_mul_f32 v40, v249, v40
  v_mul_f32 v41, v249, v41
  v_mul_f32 v42, v249, v42
  v_mfma_f32_16x16x32_bf16 v[56:59], v[224:227], v[156:159], v[56:59]
  v_mul_f32 v43, v249, v43
  v_mul_f32 v44, v251, v44
  v_mul_f32 v45, v251, v45
  v_mfma_f32_16x16x32_bf16 v[60:63], v[224:227], v[160:163], v[60:63]
  v_mul_f32 v46, v251, v46
  v_mul_f32 v47, v251, v47
  v_cvt_pk_bf16_f32 v92, v40, v41
  v_mfma_f32_16x16x32_bf16 v[48:51], v[228:231], v[164:167], v[48:51]
  v_cvt_pk_bf16_f32 v93, v42, v43
  v_cvt_pk_bf16_f32 v94, v44, v45
  v_cvt_pk_bf16_f32 v95, v46, v47
  v_mfma_f32_16x16x32_bf16 v[52:55], v[228:231], v[168:171], v[52:55]
  v_permlane16_swap_b32 v88, v90
  v_permlane16_swap_b32 v89, v91
  s_add_u32 s39, s38, 0x10000
  buffer_store_dwordx4 v[88:91], v12, s[8:11], s39 offen sc1
  v_mfma_f32_16x16x32_bf16 v[56:59], v[228:231], v[172:175], v[56:59]
  v_permlane16_swap_b32 v92, v94
  v_permlane16_swap_b32 v93, v95
  s_add_u32 s39, s38, 0x10200
  buffer_store_dwordx4 v[92:95], v12, s[8:11], s39 offen sc1
  v_mfma_f32_16x16x32_bf16 v[60:63], v[228:231], v[176:179], v[60:63]
  v_mfma_f32_16x16x32_bf16 v[64:67], v[232:235], v[132:135], v[64:67]
  v_mfma_f32_16x16x32_bf16 v[68:71], v[232:235], v[136:139], v[68:71]
  v_mul_f32 v48, v245, v48
  v_mul_f32 v49, v245, v49
  v_mul_f32 v50, v245, v50
  v_mfma_f32_16x16x32_bf16 v[72:75], v[232:235], v[140:143], v[72:75]
  v_mul_f32 v51, v245, v51
  v_mul_f32 v52, v247, v52
  v_mul_f32 v53, v247, v53
  v_mfma_f32_16x16x32_bf16 v[76:79], v[232:235], v[144:147], v[76:79]
  v_mul_f32 v54, v247, v54
  v_mul_f32 v55, v247, v55
  v_cvt_pk_bf16_f32 v96, v48, v49
  v_mfma_f32_16x16x32_bf16 v[64:67], v[236:239], v[148:151], v[64:67]
  v_cvt_pk_bf16_f32 v97, v50, v51
  v_cvt_pk_bf16_f32 v98, v52, v53
  v_cvt_pk_bf16_f32 v99, v54, v55
  v_mfma_f32_16x16x32_bf16 v[68:71], v[236:239], v[152:155], v[68:71]
  v_mul_f32 v56, v249, v56
  v_mul_f32 v57, v249, v57
  v_mul_f32 v58, v249, v58
  v_mfma_f32_16x16x32_bf16 v[72:75], v[236:239], v[156:159], v[72:75]
  v_mul_f32 v59, v249, v59
  v_mul_f32 v60, v251, v60
  v_mul_f32 v61, v251, v61
  v_mfma_f32_16x16x32_bf16 v[76:79], v[236:239], v[160:163], v[76:79]
  v_mul_f32 v62, v251, v62
  v_mul_f32 v63, v251, v63
  v_cvt_pk_bf16_f32 v100, v56, v57
  v_mfma_f32_16x16x32_bf16 v[64:67], v[240:243], v[164:167], v[64:67]
  v_cvt_pk_bf16_f32 v101, v58, v59
  v_cvt_pk_bf16_f32 v102, v60, v61
  v_cvt_pk_bf16_f32 v103, v62, v63
  v_mfma_f32_16x16x32_bf16 v[68:71], v[240:243], v[168:171], v[68:71]
  v_permlane16_swap_b32 v96, v98
  v_permlane16_swap_b32 v97, v99
  s_add_u32 s39, s38, 0x20000
  buffer_store_dwordx4 v[96:99], v12, s[8:11], s39 offen sc1
  v_mfma_f32_16x16x32_bf16 v[72:75], v[240:243], v[172:175], v[72:75]
  v_permlane16_swap_b32 v100, v102
  v_permlane16_swap_b32 v101, v103
  s_add_u32 s39, s38, 0x20200
  buffer_store_dwordx4 v[100:103], v12, s[8:11], s39 offen sc1
  v_mfma_f32_16x16x32_bf16 v[76:79], v[240:243], v[176:179], v[76:79]
  v_mul_f32 v64, v245, v64
  v_mul_f32 v65, v245, v65
  v_mul_f32 v66, v245, v66
  v_mul_f32 v67, v245, v67
  v_mul_f32 v68, v247, v68
  v_mul_f32 v69, v247, v69
  v_mul_f32 v70, v247, v70
  v_mul_f32 v71, v247, v71
  v_cvt_pk_bf16_f32 v104, v64, v65
  v_cvt_pk_bf16_f32 v105, v66, v67
  v_cvt_pk_bf16_f32 v106, v68, v69
  v_cvt_pk_bf16_f32 v107, v70, v71
  v_mul_f32 v72, v249, v72
  v_mul_f32 v73, v249, v73
  v_mul_f32 v74, v249, v74
  v_mul_f32 v75, v249, v75
  v_mul_f32 v76, v251, v76
  v_mul_f32 v77, v251, v77
  v_mul_f32 v78, v251, v78
  v_mul_f32 v79, v251, v79
  v_cvt_pk_bf16_f32 v108, v72, v73
  v_cvt_pk_bf16_f32 v109, v74, v75
  v_cvt_pk_bf16_f32 v110, v76, v77
  v_cvt_pk_bf16_f32 v111, v78, v79
  v_permlane16_swap_b32 v104, v106
  v_permlane16_swap_b32 v105, v107
  s_add_u32 s39, s38, 0x30000
  buffer_store_dwordx4 v[104:107], v12, s[8:11], s39 offen sc1
  v_permlane16_swap_b32 v108, v110
  v_permlane16_swap_b32 v109, v111
  s_add_u32 s39, s38, 0x30200
  buffer_store_dwordx4 v[108:111], v12, s[8:11], s39 offen sc1
  s_mov_b32 s70, 0x7f000000
LA_done:
  s_lshl_b32 s30, s24, 2
  s_and_b32 s33, s25, 3
  s_add_u32 s30, s30, s33
  s_lshr_b32 s31, s25, 2
  s_lshr_b32 s34, s30, 1
  s_and_b32 s35, s30, 1
  s_mul_i32 s36, s34, 5
  s_lshl_b32 s38, s35, 1
  s_add_u32 s38, s38, s36
  s_mul_i32 s37, s35, 3
  s_add_u32 s37, s37, s36
  s_add_u32 s36, s36, 2
  s_lshl_b32 s36, s36, 15
  s_lshl_b32 s37, s37, 15
  s_and_b32 s77, s26, 3
  s_lshl_b32 s39, s31, 1
  s_add_u32 s41, s39, s77
  s_sub_u32 s41, s41, 2
  s_cselect_b32 s42, 0x7f000000, 0
  s_lshl_b32 s77, s77, 11
  s_mul_i32 s43, s24, 10
  s_add_u32 s44, s43, 9
  s_lshr_b32 s43, s43, 4
  s_lshr_b32 s44, s44, 4
  s_mov_b32 s45, 0x15151414
  s_cmp_lg_u32 s43, s44
  s_cselect_b32 s44, 0x3f3f3c3c, s45
  s_cmp_eq_u32 s31, 0
  s_cselect_b32 s45, 0xffff0000, -1
  s_and_b32 s34, s44, s45
  s_mov_b32 s45, 0
  v_lshlrev_b32 v3, 7, v1
  s_lshl_b32 s43, s24, 3
  s_add_u32 s43, s43, s31
  s_lshl_b32 s43, s43, 8
  s_lshl_b32 s43, s43, 5
  s_add_u32 s43, s43, 0x1d00000
  s_lshl_b32 s38, s31, 12
  s_lshl_b32 s39, s26, 10
  s_add_u32 s40, s38, s77
  s_add_u32 s40, s40, 0x27f000
  s_add_u32 s40, s40, s42
  s_add_u32 s46, s40, s37
  s_add_u32 s47, s46, 32768
  s_add_u32 s48, s40, s36
  v_lshlrev_b32 v2, 4, v1
  v_and_b32 v5, 31, v1
  v_lshrrev_b32 v6, 5, v1
  v_lshlrev_b32 v7, 4, v5
  v_lshl_add_u32 v8, v6, 15, v7
  v_lshl_add_u32 v9, v6, 3, v7
  v_cmp_eq_u32 vcc, s35, v6
  v_mov_b32 v10, 0x7f000000
  s_nop 0
  v_cndmask_b32 v10, v10, v9, vcc
  s_lshl_b32 s49, s26, 9
  s_add_u32 s50, s49, s38
  s_add_u32 s50, s50, 0x0
  s_add_u32 s51, s50, s37
  s_add_u32 s52, s50, s36
  v_lshl_add_u32 v22, v6, 13, v7
  v_add_u32 v22, s49, v22
  v_add_u32 v23, 0x4000, v9
  v_add_u32 v23, s49, v23
  v_lshlrev_b32 v24, 6, v6
  v_bfe_u32 v25, v1, 2, 2
  v_lshl_add_u32 v24, v25, 4, v24
  v_add_u32 v24, s49, v24
  v_and_b32 v25, 1, v1
  v_mul_u32_u24 v25, 8256, v25
  v_bfe_u32 v26, v1, 1, 1
  v_lshl_add_u32 v25, v26, 3, v25
  v_add_u32 v25, 0x6000, v25
  s_lshl_b32 s53, s35, 3
  s_xor_b32 s54, s53, 8
  s_add_u32 s55, s53, 0xa080
  s_add_u32 s56, s54, 0xa080
  v_mov_b32 v26, s56
  v_mov_b32 v27, s55
  v_and_b32 v28, 3, v1
  v_cmp_eq_u32 vcc, 0, v28
  s_nop 1
  v_cndmask_b32 v26, v26, v27, vcc
  v_and_b32 v28, 16, v1
  v_cmp_eq_u32 vcc, 0, v28
  s_nop 1
  v_cndmask_b32 v25, v26, v25, vcc
  v_add_u32 v24, v24, v25
  s_add_u32 s55, s77, s54
  v_add_u32 v25, s55, v2
  v_mov_b32 v26, 0x3f803f80
  v_mov_b32 v27, 0x3f803f80
  s_cmp_lg_u32 s42, 0
  s_cselect_b32 s55, 0xf149, 0
  v_mov_b32 v28, s55
  v_mov_b32 v29, 0
  v_lshlrev_b32 v30, 2, v6
  v_sub_u32 v30, v5, v30
  v_mov_b32 v31, 0xffff
  v_mov_b32 v56, 0xffff0000
  v_cmp_le_i32 s[16:17], 0, v30
  v_cmp_le_i32 s[18:19], 1, v30
  v_cmp_le_i32 s[32:33], 2, v30
  v_cmp_le_i32 s[58:59], 3, v30
  v_cmp_le_i32 s[60:61], 8, v30
  v_cmp_le_i32 s[62:63], 9, v30
  v_cmp_le_i32 s[64:65], 10, v30
  v_cmp_le_i32 s[66:67], 11, v30
  v_cmp_le_i32 s[68:69], 16, v30
  v_cmp_le_i32 s[78:79], 17, v30
  v_cmp_le_i32 s[96:97], 18, v30
  v_cmp_le_i32 s[98:99], 19, v30
  v_cmp_le_i32 s[40:41], 24, v30
  v_cmp_le_i32 s[54:55], 25, v30
  v_cmp_le_i32 s[100:101], 26, v30
  v_cmp_le_i32 s[20:21], 27, v30
  v_cndmask_b32 v48, 0, v31, s[16:17]
  v_cndmask_b32 v57, 0, v56, s[18:19]
  v_or_b32 v48, v48, v57
  v_cndmask_b32 v49, 0, v31, s[32:33]
  v_cndmask_b32 v57, 0, v56, s[58:59]
  v_or_b32 v49, v49, v57
  v_cndmask_b32 v50, 0, v31, s[60:61]
  v_cndmask_b32 v57, 0, v56, s[62:63]
  v_or_b32 v50, v50, v57
  v_cndmask_b32 v51, 0, v31, s[64:65]
  v_cndmask_b32 v57, 0, v56, s[66:67]
  v_or_b32 v51, v51, v57
  v_cndmask_b32 v52, 0, v31, s[68:69]
  v_cndmask_b32 v57, 0, v56, s[78:79]
  v_or_b32 v52, v52, v57
  v_cndmask_b32 v53, 0, v31, s[96:97]
  v_cndmask_b32 v57, 0, v56, s[98:99]
  v_or_b32 v53, v53, v57
  v_cndmask_b32 v54, 0, v31, s[40:41]
  v_cndmask_b32 v57, 0, v56, s[54:55]
  v_or_b32 v54, v54, v57
  v_cndmask_b32 v55, 0, v31, s[100:101]
  v_cndmask_b32 v57, 0, v56, s[20:21]
  v_or_b32 v55, v55, v57
  v_cmp_eq_u32 vcc, 0, v6
  s_nop 1
  v_cndmask_b32 v58, 0, v26, vcc
  v_mov_b32 v57, 0x3f80
  v_cndmask_b32 v59, 0, v57, vcc
  v_mov_b32 v20, 0
  v_mov_b32 v21, s27
  s_lshr_b32 s49, s25, 2
  s_mul_i32 s49, s49, 102400
  s_add_u32 s49, s49, s39
  s_add_u32 s49, s49, 0x17ff000
  s_add_u32 s50, s39, 0xe000
  s_cmp_ge_u32 s26, 4
  s_cbranch_scc1 LB_y
  s_and_b32 s56, s2, 0xe1
  s_cmp_eq_u32 s56, 0xe1
  s_cbranch_scc1 LB_q
  s_mov_b64 exec, 1
  s_waitcnt vmcnt(0)
  ds_add_rtn_u32 v126, v124, v125
  s_waitcnt lgkmcnt(0)
  v_readfirstlane_b32 s56, v126
  s_mov_b32 s57, 0x1d00000
  s_cmp_eq_u32 s56, 3
  s_cselect_b32 s57, s57, 0x7f000000
  s_mov_b64 exec, 63
  buffer_store_dword v21, v123, s[8:11], s57 offen sc1
  s_mov_b64 exec, -1
  s_branch LB_q
LB_y:
  s_cmp_lg_u32 s26, 4
  s_cbranch_scc1 LB_np
  s_mov_b32 s38, 0x1e00000
  s_mov_b32 s56, 0xfffff
  s_mov_b32 s57, 0xfffff
  s_add_u32 s29, s38, 0x12000
  s_mov_b64 exec, s[56:57]
  buffer_load_dword v73, v3, s[8:11], s29 offen offset:0 sc1
  s_mov_b64 exec, -1
  s_add_u32 s29, s38, 0x14000
  s_mov_b64 exec, s[56:57]
  buffer_load_dword v74, v3, s[8:11], s29 offen offset:0 sc1
  s_mov_b64 exec, -1
  s_add_u32 s29, s38, 0x16000
  s_mov_b64 exec, 0xfffff
  buffer_load_dword v75, v3, s[8:11], s29 offen offset:0 sc1
  s_mov_b64 exec, -1
  s_add_u32 s29, s38, 0x12000
  s_mov_b64 exec, s[56:57]
  s_waitcnt vmcnt(2)
  v_cmp_ne_u32 vcc, s27, v73
  s_nop 4
  s_cbranch_vccz Lchk4x
  s_mov_b32 s28, 0
Lchk4:
  s_sleep 16
  buffer_load_dword v73, v3, s[8:11], s29 offen offset:0 sc1
  s_add_u32 s28, s28, 1
  s_waitcnt vmcnt(0)
  s_cmp_gt_u32 s28, 1000000
  s_cbranch_scc1 Lchk4x
  v_cmp_ne_u32 vcc, s27, v73
  s_nop 4
  s_cbranch_vccnz Lchk4
Lchk4x:
  s_mov_b64 exec, -1
  s_add_u32 s29, s38, 0x14000
  s_mov_b64 exec, s[56:57]
  s_waitcnt vmcnt(1)
  v_cmp_ne_u32 vcc, s27, v74
  s_nop 4
  s_cbranch_vccz Lchk5x
  s_mov_b32 s28, 0
Lchk5:
  s_sleep 16
  buffer_load_dword v74, v3, s[8:11], s29 offen offset:0 sc1
  s_add_u32 s28, s28, 1
  s_waitcnt vmcnt(0)
  s_cmp_gt_u32 s28, 1000000
  s_cbranch_scc1 Lchk5x
  v_cmp_ne_u32 vcc, s27, v74
  s_nop 4
  s_cbranch_vccnz Lchk5
Lchk5x:
  s_mov_b64 exec, -1
  s_add_u32 s29, s38, 0x16000
  s_mov_b64 exec, 0xfffff
  s_waitcnt vmcnt(0)
  v_cmp_ne_u32 vcc, s27, v75
  s_nop 4
  s_cbranch_vccz Lchk6x
  s_mov_b32 s28, 0
Lchk6:
  s_sleep 16
  buffer_load_dword v75, v3, s[8:11], s29 offen offset:0 sc1
  s_add_u32 s28, s28, 1
  s_waitcnt vmcnt(0)
  s_cmp_gt_u32 s28, 1000000
  s_cbranch_scc1 Lchk6x
  v_cmp_ne_u32 vcc, s27, v75
  s_nop 4
  s_cbranch_vccnz Lchk6
Lchk6x:
  s_mov_b64 exec, -1
LB_np:
LB_q:
  s_cmp_ge_u32 s26, 4
  s_cselect_b32 s44, 0x0c, 0x30
  s_cselect_b32 s38, 0, 0x280000
  s_cselect_b32 s56, 0, 24576
  s_cselect_b32 s57, 0, 64
  s_lshr_b32 s29, s77, 8
  s_lshl_b32 s44, s44, s29
  s_lshr_b32 s29, s26, 2
  s_lshl_b32 s29, s29, 3
  s_lshl_b32 s29, 0x30000, s29
  s_or_b32 s44, s44, s29
  s_and_b32 s44, s44, s34
  s_add_u32 s56, s56, s77
  s_mov_b64 exec, s[44:45]
  s_mov_b32 s28, 0
Lpoll7:
  buffer_load_dword v4, v3, s[8:11], s43 offen offset:0 sc1
  s_add_u32 s28, s28, 1
  s_cmp_gt_u32 s28, 1000000
  s_cbranch_scc1 Lpoll7x
  s_waitcnt vmcnt(0)
  v_cmp_ne_u32 vcc, s27, v4
  s_nop 4
  s_cbranch_vccz Lpoll7x
  s_sleep 1
  s_branch Lpoll7
Lpoll7x:
  s_waitcnt vmcnt(0)
  s_mov_b64 exec, -1
  s_add_u32 s29, s46, s38
  s_add_u32 m0, s56, 0
  s_nop 0
  buffer_load_dwordx4 v2, s[8:11], s29 offen offset:0 sc1 lds
  buffer_load_dwordx4 v2, s[8:11], s29 offen offset:1024 sc1 lds
  s_add_u32 s56, s56, s57
  s_add_u32 s29, s47, s38
  s_add_u32 m0, s56, 8192
  s_nop 0
  buffer_load_dwordx4 v2, s[8:11], s29 offen offset:0 sc1 lds
  buffer_load_dwordx4 v2, s[8:11], s29 offen offset:1024 sc1 lds
  s_add_u32 s56, s56, s57
  s_add_u32 s29, s48, s38
  s_add_u32 m0, s56, 16384
  s_nop 0
  buffer_load_dwordx4 v2, s[8:11], s29 offen offset:0 sc1 lds
  buffer_load_dwordx4 v2, s[8:11], s29 offen offset:1024 sc1 lds
  s_add_u32 s56, s56, s57
  buffer_load_dwordx4 v[12:15], v8, s[8:11], s51 offen sc1
  buffer_load_dwordx2 v[16:17], v10, s[8:11], s52 offen sc1
  s_cmp_eq_u32 s70, 0x7f000000
  s_cbranch_scc1 LB_nlp
  v_mov_b32 v46, 0x20404
  s_mov_b32 s34, s70
  s_mov_b32 s28, 0
LA_sw:
  ds_read_b32 v47, v46
  s_add_u32 s28, s28, 1
  s_waitcnt lgkmcnt(0)
  v_readfirstlane_b32 s75, v47
  s_cmp_gt_u32 s28, 10000000
  s_cbranch_scc1 LA_swx
  s_cmp_ge_u32 s75, 2
  s_cbranch_scc1 LA_swx
  s_sleep 1
  s_branch LA_sw
LA_swx:
  s_and_b32 s77, s26, 3
  s_lshl_b32 s73, s77, 5
  s_add_u32 s73, s73, 0x21000
  v_and_b32 v129, 1, v60
  v_lshlrev_b32 v130, 11, v129
  v_lshl_add_u32 v130, v65, 10, v130
  v_lshl_add_u32 v130, v61, 7, v130
  v_and_b32 v131, 1, v1
  v_lshl_add_u32 v130, v131, 4, v130
  v_bfe_u32 v131, v1, 1, 1
  v_lshl_add_u32 v130, v131, 3, v130
  v_add_u32 v130, s73, v130
  v_lshlrev_b32 v131, 10, v60
  v_lshl_add_u32 v131, v61, 7, v131
  v_lshl_add_u32 v131, v62, 3, v131
  v_add_u32 v131, s73, v131
  ds_read_b64_tr_b16 v[96:97], v130 offset:0
  ds_read_b64_tr_b16 v[98:99], v130 offset:512
  ds_read_b64_tr_b16 v[100:101], v130 offset:4096
  ds_read_b64_tr_b16 v[102:103], v130 offset:4608
  ds_read_b64_tr_b16 v[104:105], v130 offset:8192
  ds_read_b64_tr_b16 v[106:107], v130 offset:8704
  ds_read_b64_tr_b16 v[108:109], v130 offset:12288
  ds_read_b64_tr_b16 v[110:111], v130 offset:12800
  ds_read_b64_tr_b16 v[112:113], v130 offset:16384
  ds_read_b64_tr_b16 v[114:115], v130 offset:16896
  ds_read_b64_tr_b16 v[116:117], v131 offset:20480
  ds_read_b64_tr_b16 v[118:119], v131 offset:20992
  ds_read_b64_tr_b16 v[120:121], v131 offset:24576
  ds_read_b64_tr_b16 v[122:123], v131 offset:25088
  v_and_b32 v128, 1, v61
  v_cmp_eq_u32 vcc, v128, v129
  v_mov_b32 v128, 0x3f803f80
  s_nop 0
  v_cndmask_b32 v132, 0, v128, vcc
  v_mov_b32 v133, v132
  v_mov_b32 v134, v132
  v_mov_b32 v135, v132
  s_lshr_b32 s72, s34, 3
  s_lshl_b32 s72, s72, 2
  s_add_u32 s72, s72, s77
  s_mul_i32 s72, s72, 41984
  s_add_u32 s72, s72, 0x2000000
  s_and_b32 s73, s34, 7
  s_lshl_b32 s74, s73, 7
  s_add_u32 s74, s74, s72
  s_add_u32 s74, s74, 40960
  s_mul_i32 s73, s73, 5120
  s_add_u32 s72, s72, s73
  s_add_u32 s73, s72, 4096
  s_waitcnt lgkmcnt(12)
  v_mfma_f32_16x16x32_bf16 v[136:139], v[132:135], v[96:99], 0
  s_waitcnt lgkmcnt(10)
  v_mfma_f32_16x16x32_bf16 v[136:139], v[132:135], v[100:103], v[136:139]
  s_waitcnt lgkmcnt(8)
  v_mfma_f32_16x16x32_bf16 v[136:139], v[132:135], v[104:107], v[136:139]
  s_waitcnt lgkmcnt(6)
  v_mfma_f32_16x16x32_bf16 v[136:139], v[132:135], v[108:111], v[136:139]
  s_waitcnt lgkmcnt(4)
  v_mfma_f32_16x16x32_bf16 v[136:139], v[132:135], v[112:115], v[136:139]
  s_mul_i32 s76, s34, 205
  s_lshr_b32 s76, s76, 10
  s_mul_i32 s75, s76, 5
  s_sub_u32 s75, s34, s75
  s_lshl_b32 s71, s75, 6
  s_add_u32 s71, s71, s76
  s_lshl_b32 s71, s71, 7
  s_add_u32 s71, s71, 0x1e08000
  s_lshl_b32 s75, s75, 3
  s_add_u32 s75, s75, s77
  s_mul_i32 s75, s75, 54
  s_add_u32 s75, s75, s76
  s_lshl_b32 s75, s75, 10
  s_add_u32 s75, s75, 0x1900000
  s_add_u32 s76, s75, 221184
  s_lshl_b32 s70, s34, 7
  s_add_u32 s70, s70, 0x1e00000
  v_mov_b32 v128, 0xffff
  v_cvt_pk_bf16_f32 v137, v136, v136
  v_and_b32 v138, 0xffff0000, v137
  v_sub_f32 v136, v136, v138
  v_cvt_pk_bf16_f32 v136, v136, v136
  v_bfi_b32 v136, v128, v137, v136
  s_waitcnt lgkmcnt(0)
LB_nlp:
  s_waitcnt vmcnt(2)
  s_cmp_lt_u32 s26, 4
  s_cbranch_scc1 LB_pv
  ds_write_b64 v25, v[28:29] offset:16384
  ds_write_b64 v25, v[28:29] offset:17408
  s_branch LB_npt
LB_pv:
  ds_write_b64 v25, v[26:27] offset:41088
  ds_write_b64 v25, v[26:27] offset:42112
LB_npt:
  s_waitcnt lgkmcnt(0)
  s_barrier
  v_cmp_ne_u32 vcc, s35, v6
  s_waitcnt vmcnt(0)
  s_nop 0
  v_cndmask_b32 v16, v16, v57, vcc
  s_cmp_lg_u32 s26, 5
  s_cbranch_scc1 LB_nrt
  s_getpc_b64 s[56:57]
Lrt8:
  v_lshlrev_b32 v250, 5, v1
  v_add_u32 v250, s25, v250
  v_lshlrev_b32 v250, 7, v250
  v_min_u32 v250, Lk_endcode-Lrt8-4, v250
  s_mov_b64 exec, 0x3ff
  global_load_dword v251, v250, s[56:57]
  s_mov_b64 exec, -1
LB_nrt:
  s_cmp_lt_u32 s26, 4
  s_cbranch_scc1 LB_nwo
  s_add_u32 m0, s50, 0
  s_add_u32 s45, s49, 0
  buffer_load_dwordx4 v2, s[8:11], s45 offen sc1 lds
  s_add_u32 m0, s50, 4096
  s_add_u32 s45, s49, 4096
  buffer_load_dwordx4 v2, s[8:11], s45 offen sc1 lds
  s_add_u32 m0, s50, 8192
  s_add_u32 s45, s49, 8192
  buffer_load_dwordx4 v2, s[8:11], s45 offen sc1 lds
  s_add_u32 m0, s50, 12288
  s_add_u32 s45, s49, 12288
  buffer_load_dwordx4 v2, s[8:11], s45 offen sc1 lds
  s_add_u32 m0, s50, 16384
  s_add_u32 s45, s49, 16384
  buffer_load_dwordx4 v2, s[8:11], s45 offen sc1 lds
  s_add_u32 m0, s50, 20480
  s_add_u32 s45, s49, 20480
  buffer_load_dwordx4 v2, s[8:11], s45 offen sc1 lds
  s_add_u32 m0, s50, 24576
  s_add_u32 s45, s49, 24576
  buffer_load_dwordx4 v2, s[8:11], s45 offen sc1 lds
  s_add_u32 m0, s50, 28672
  s_add_u32 s45, s49, 28672
  buffer_load_dwordx4 v2, s[8:11], s45 offen sc1 lds
  s_add_u32 m0, s50, 32768
  s_add_u32 s45, s49, 32768
  buffer_load_dwordx4 v2, s[8:11], s45 offen sc1 lds
  s_add_u32 m0, s50, 36864
  s_add_u32 s45, s49, 36864
  buffer_load_dwordx4 v2, s[8:11], s45 offen sc1 lds
  s_add_u32 m0, s50, 40960
  s_add_u32 s45, s49, 40960
  buffer_load_dwordx4 v2, s[8:11], s45 offen sc1 lds
  s_add_u32 m0, s50, 45056
  s_add_u32 s45, s49, 45056
  buffer_load_dwordx4 v2, s[8:11], s45 offen sc1 lds
  s_add_u32 m0, s50, 49152
  s_add_u32 s45, s49, 49152
  buffer_load_dwordx4 v2, s[8:11], s45 offen sc1 lds
  s_add_u32 m0, s50, 53248
  s_add_u32 s45, s49, 53248
  buffer_load_dwordx4 v2, s[8:11], s45 offen sc1 lds
  s_add_u32 m0, s50, 57344
  s_add_u32 s45, s49, 57344
  buffer_load_dwordx4 v2, s[8:11], s45 offen sc1 lds
  s_add_u32 m0, s50, 61440
  s_add_u32 s45, s49, 61440
  buffer_load_dwordx4 v2, s[8:11], s45 offen sc1 lds
  s_add_u32 m0, s50, 65536
  s_add_u32 s45, s49, 65536
  buffer_load_dwordx4 v2, s[8:11], s45 offen sc1 lds
  s_add_u32 m0, s50, 69632
  s_add_u32 s45, s49, 69632
  buffer_load_dwordx4 v2, s[8:11], s45 offen sc1 lds
  s_add_u32 m0, s50, 73728
  s_add_u32 s45, s49, 73728
  buffer_load_dwordx4 v2, s[8:11], s45 offen sc1 lds
  s_add_u32 m0, s50, 77824
  s_add_u32 s45, s49, 77824
  buffer_load_dwordx4 v2, s[8:11], s45 offen sc1 lds
  s_add_u32 m0, s50, 81920
  s_add_u32 s45, s49, 81920
  buffer_load_dwordx4 v2, s[8:11], s45 offen sc1 lds
  s_add_u32 m0, s50, 86016
  s_add_u32 s45, s49, 86016
  buffer_load_dwordx4 v2, s[8:11], s45 offen sc1 lds
  s_add_u32 m0, s50, 90112
  s_add_u32 s45, s49, 90112
  buffer_load_dwordx4 v2, s[8:11], s45 offen sc1 lds
  s_add_u32 m0, s50, 94208
  s_add_u32 s45, s49, 94208
  buffer_load_dwordx4 v2, s[8:11], s45 offen sc1 lds
  s_add_u32 m0, s50, 98304
  s_add_u32 s45, s49, 98304
  buffer_load_dwordx4 v2, s[8:11], s45 offen sc1 lds
LB_nwo:
  s_cmp_eq_u32 s70, 0x7f000000
  s_cbranch_scc1 LB_npk
  buffer_store_dwordx4 v[96:99], v2, s[8:11], s72 offen offset:0 sc1
  buffer_store_dwordx4 v[100:103], v2, s[8:11], s72 offen offset:1024 sc1
  buffer_store_dwordx4 v[104:107], v2, s[8:11], s72 offen offset:2048 sc1
  buffer_store_dwordx4 v[108:111], v2, s[8:11], s72 offen offset:3072 sc1
  buffer_store_dwordx4 v[112:115], v2, s[8:11], s73 offen sc1
  buffer_store_dwordx4 v[116:119], v2, s[8:11], s75 offen sc1
  buffer_store_dwordx4 v[120:123], v2, s[8:11], s76 offen sc1
  v_lshrrev_b32 v128, 2, v7
  buffer_store_dword v136, v128, s[8:11], s74 offen sc1
LB_npk:
  s_setprio 1
  ds_read_b128 v[208:211], v22 offset:0
  ds_read_b64 v[212:213], v23 offset:0
  ds_read_b128 v[214:217], v22 offset:4096
  ds_read_b64 v[218:219], v23 offset:4096
  ds_read_b128 v[220:223], v22 offset:512
  ds_read_b64 v[224:225], v23 offset:512
  s_waitcnt lgkmcnt(5)
  v_mfma_f32_32x32x16_bf16 v[64:79], v[208:211], v[12:15], 0
  s_waitcnt lgkmcnt(4)
  v_mfma_f32_32x32x8_bf16 v[64:79], v[212:213], v[16:17], v[64:79]
  ds_read_b128 v[208:211], v22 offset:1024
  ds_read_b64 v[212:213], v23 offset:1024
  s_waitcnt lgkmcnt(5)
  v_mfma_f32_32x32x16_bf16 v[192:207], v[214:217], v[12:15], 0
  s_waitcnt lgkmcnt(4)
  v_mfma_f32_32x32x8_bf16 v[192:207], v[218:219], v[16:17], v[192:207]
  ds_read_b128 v[214:217], v22 offset:1536
  ds_read_b64 v[218:219], v23 offset:1536
  s_waitcnt lgkmcnt(5)
  v_mfma_f32_32x32x16_bf16 v[80:95], v[220:223], v[12:15], 0
  s_waitcnt lgkmcnt(4)
  v_mfma_f32_32x32x8_bf16 v[80:95], v[224:225], v[16:17], v[80:95]
  ds_read_b128 v[220:223], v22 offset:2048
  ds_read_b64 v[224:225], v23 offset:2048
  s_waitcnt lgkmcnt(5)
  v_mfma_f32_32x32x16_bf16 v[96:111], v[208:211], v[12:15], 0
  s_nop 1
  v_cndmask_b32 v64, v64, v192, s[16:17]
  v_cndmask_b32 v65, v65, v193, s[18:19]
  v_cndmask_b32 v66, v66, v194, s[32:33]
  v_cndmask_b32 v67, v67, v195, s[58:59]
  v_cndmask_b32 v68, v68, v196, s[60:61]
  v_cndmask_b32 v69, v69, v197, s[62:63]
  s_waitcnt lgkmcnt(4)
  v_mfma_f32_32x32x8_bf16 v[96:111], v[212:213], v[16:17], v[96:111]
  v_cndmask_b32 v70, v70, v198, s[64:65]
  v_cndmask_b32 v71, v71, v199, s[66:67]
  v_cndmask_b32 v72, v72, v200, s[68:69]
  v_cndmask_b32 v73, v73, v201, s[78:79]
  v_cndmask_b32 v74, v74, v202, s[96:97]
  v_cndmask_b32 v75, v75, v203, s[98:99]
  ds_read_b128 v[208:211], v22 offset:2560
  ds_read_b64 v[212:213], v23 offset:2560
  s_waitcnt lgkmcnt(5)
  v_mfma_f32_32x32x16_bf16 v[112:127], v[214:217], v[12:15], 0
  v_cndmask_b32 v76, v76, v204, s[40:41]
  v_cndmask_b32 v77, v77, v205, s[54:55]
  v_cndmask_b32 v78, v78, v206, s[100:101]
  v_cndmask_b32 v79, v79, v207, s[20:21]
  v_max_f32 v60, v64, v65
  v_max_f32 v61, v66, v67
  s_waitcnt lgkmcnt(4)
  v_mfma_f32_32x32x8_bf16 v[112:127], v[218:219], v[16:17], v[112:127]
  v_max3_f32 v60, v68, v69, v60
  v_max3_f32 v61, v70, v71, v61
  v_max3_f32 v60, v72, v73, v60
  v_max3_f32 v61, v74, v75, v61
  v_max3_f32 v60, v76, v77, v60
  v_max3_f32 v61, v78, v79, v61
  ds_read_b128 v[214:217], v22 offset:3072
  ds_read_b64 v[218:219], v23 offset:3072
  s_waitcnt lgkmcnt(5)
  v_mfma_f32_32x32x16_bf16 v[128:143], v[220:223], v[12:15], 0
  v_max3_f32 v60, v80, v81, v60
  v_max3_f32 v61, v82, v83, v61
  v_max3_f32 v60, v84, v85, v60
  v_max3_f32 v61, v86, v87, v61
  v_max3_f32 v60, v88, v89, v60
  v_max3_f32 v61, v90, v91, v61
  s_waitcnt lgkmcnt(4)
  v_mfma_f32_32x32x8_bf16 v[128:143], v[224:225], v[16:17], v[128:143]
  v_max3_f32 v60, v92, v93, v60
  v_max3_f32 v61, v94, v95, v61
  v_max3_f32 v60, v96, v97, v60
  v_max3_f32 v61, v98, v99, v61
  v_max3_f32 v60, v100, v101, v60
  v_max3_f32 v61, v102, v103, v61
  ds_read_b128 v[220:223], v22 offset:3584
  ds_read_b64 v[224:225], v23 offset:3584
  s_waitcnt lgkmcnt(5)
  v_mfma_f32_32x32x16_bf16 v[144:159], v[208:211], v[12:15], 0
  v_max3_f32 v60, v104, v105, v60
  v_max3_f32 v61, v106, v107, v61
  v_max3_f32 v60, v108, v109, v60
  v_max3_f32 v61, v110, v111, v61
  v_max3_f32 v60, v112, v113, v60
  v_max3_f32 v61, v114, v115, v61
  s_waitcnt lgkmcnt(4)
  v_mfma_f32_32x32x8_bf16 v[144:159], v[212:213], v[16:17], v[144:159]
  v_max3_f32 v60, v116, v117, v60
  v_max3_f32 v61, v118, v119, v61
  v_max3_f32 v60, v120, v121, v60
  v_max3_f32 v61, v122, v123, v61
  v_max3_f32 v60, v124, v125, v60
  v_max3_f32 v61, v126, v127, v61
  s_waitcnt lgkmcnt(3)
  v_mfma_f32_32x32x16_bf16 v[160:175], v[214:217], v[12:15], 0
  v_max3_f32 v60, v128, v129, v60
  v_max3_f32 v61, v130, v131, v61
  v_max3_f32 v60, v132, v133, v60
  v_max3_f32 v61, v134, v135, v61
  v_max3_f32 v60, v136, v137, v60
  v_max3_f32 v61, v138, v139, v61
  s_waitcnt lgkmcnt(2)
  v_mfma_f32_32x32x8_bf16 v[160:175], v[218:219], v[16:17], v[160:175]
  v_max3_f32 v60, v140, v141, v60
  v_max3_f32 v61, v142, v143, v61
  s_waitcnt lgkmcnt(1)
  v_mfma_f32_32x32x16_bf16 v[176:191], v[220:223], v[12:15], 0
  v_max3_f32 v60, v144, v145, v60
  v_max3_f32 v61, v146, v147, v61
  v_max3_f32 v60, v148, v149, v60
  v_max3_f32 v61, v150, v151, v61
  v_max3_f32 v60, v152, v153, v60
  v_max3_f32 v61, v154, v155, v61
  s_waitcnt lgkmcnt(0)
  v_mfma_f32_32x32x8_bf16 v[176:191], v[224:225], v[16:17], v[176:191]
  v_max3_f32 v60, v156, v157, v60
  v_max3_f32 v61, v158, v159, v61
  ds_read_b64_tr_b16 v[226:227], v24 offset:0
  ds_read_b64_tr_b16 v[228:229], v24 offset:128
  ds_read_b64_tr_b16 v[230:231], v24 offset:4096
  ds_read_b64_tr_b16 v[232:233], v24 offset:4224
  ds_read_b64_tr_b16 v[234:235], v24 offset:256
  ds_read_b64_tr_b16 v[236:237], v24 offset:384
  ds_read_b64_tr_b16 v[238:239], v24 offset:4352
  ds_read_b64_tr_b16 v[240:241], v24 offset:4480
  v_max3_f32 v60, v160, v161, v60
  v_max3_f32 v61, v162, v163, v61
  v_max3_f32 v60, v164, v165, v60
  v_max3_f32 v61, v166, v167, v61
  v_max3_f32 v60, v168, v169, v60
  v_max3_f32 v61, v170, v171, v61
  v_max3_f32 v60, v172, v173, v60
  v_max3_f32 v61, v174, v175, v61
  v_max3_f32 v60, v176, v177, v60
  v_max3_f32 v61, v178, v179, v61
  v_max3_f32 v60, v180, v181, v60
  v_max3_f32 v61, v182, v183, v61
  v_max3_f32 v60, v184, v185, v60
  v_max3_f32 v61, v186, v187, v61
  v_max3_f32 v60, v188, v189, v60
  v_max3_f32 v61, v190, v191, v61
  v_max_f32 v60, v60, v61
  v_mov_b32 v61, v60
  s_nop 1
  v_permlane32_swap_b32 v60, v61
  v_max_f32 v60, v60, v61
  v_cvt_pk_bf16_f32 v62, -v60, -v60
  v_and_b32 v61, v56, v62
  v_add_f32 v60, v60, v61
  v_cvt_pk_bf16_f32 v63, -v60, -v60
  v_bfi_b32 v62, v31, v62, v63
  v_and_b32 v61, v56, v63
  v_add_f32 v60, v60, v61
  v_cvt_pk_bf16_f32 v63, -v60, -v60
  s_nop 1
  v_mfma_f32_32x32x8_bf16 v[64:79], v[58:59], v[62:63], v[64:79]
  v_mfma_f32_32x32x8_bf16 v[80:95], v[58:59], v[62:63], v[80:95]
  s_mov_b32 s76, s70
  s_mov_b32 s77, s71
  v_mov_b32 v22, 0x7f000000
  v_cmp_eq_u32 vcc, 0, v6
  s_nop 1
  v_cndmask_b32 v18, v22, v7, vcc
  s_add_u32 s52, s52, s53
  s_setprio 0
  s_nop 1
  v_exp_f32 v64, v64
  v_exp_f32 v65, v65
  v_exp_f32 v66, v66
  v_exp_f32 v67, v67
  v_exp_f32 v68, v68
  v_exp_f32 v69, v69
  v_exp_f32 v70, v70
  v_mfma_f32_32x32x8_bf16 v[96:111], v[58:59], v[62:63], v[96:111]
  v_exp_f32 v71, v71
  v_cvt_pk_bf16_f32 v64, v64, v65
  v_cvt_pk_bf16_f32 v65, v66, v67
  v_cvt_pk_bf16_f32 v66, v68, v69
  v_cvt_pk_bf16_f32 v67, v70, v71
  v_and_b32 v192, v48, v64
  v_and_b32 v193, v49, v65
  v_and_b32 v194, v50, v66
  v_and_b32 v195, v51, v67
  v_xor_b32 v64, v192, v64
  v_xor_b32 v65, v193, v65
  v_xor_b32 v66, v194, v66
  v_xor_b32 v67, v195, v67
  v_exp_f32 v72, v72
  v_exp_f32 v73, v73
  s_waitcnt lgkmcnt(6)
  v_mfma_f32_32x32x16_bf16 v[32:47], v[226:229], v[64:67], 0
  ds_read_b64_tr_b16 v[242:243], v24 offset:512
  ds_read_b64_tr_b16 v[244:245], v24 offset:640
  v_exp_f32 v74, v74
  v_exp_f32 v75, v75
  v_exp_f32 v76, v76
  v_exp_f32 v77, v77
  v_exp_f32 v78, v78
  s_waitcnt lgkmcnt(6)
  v_mfma_f32_32x32x16_bf16 v[32:47], v[230:233], v[192:195], v[32:47]
  ds_read_b64_tr_b16 v[246:247], v24 offset:768
  ds_read_b64_tr_b16 v[248:249], v24 offset:896
  v_exp_f32 v79, v79
  v_cvt_pk_bf16_f32 v68, v72, v73
  v_cvt_pk_bf16_f32 v69, v74, v75
  v_cvt_pk_bf16_f32 v70, v76, v77
  v_cvt_pk_bf16_f32 v71, v78, v79
  v_and_b32 v196, v52, v68
  v_and_b32 v197, v53, v69
  v_and_b32 v198, v54, v70
  v_and_b32 v199, v55, v71
  v_xor_b32 v68, v196, v68
  v_xor_b32 v69, v197, v69
  v_xor_b32 v70, v198, v70
  v_xor_b32 v71, v199, v71
  v_exp_f32 v80, v80
  v_exp_f32 v81, v81
  s_waitcnt lgkmcnt(6)
  v_mfma_f32_32x32x16_bf16 v[32:47], v[234:237], v[68:71], v[32:47]
  ds_read_b64_tr_b16 v[226:227], v24 offset:1024
  ds_read_b64_tr_b16 v[228:229], v24 offset:1152
  v_exp_f32 v82, v82
  v_exp_f32 v83, v83
  v_exp_f32 v84, v84
  v_exp_f32 v85, v85
  v_exp_f32 v86, v86
  v_mfma_f32_32x32x8_bf16 v[112:127], v[58:59], v[62:63], v[112:127]
  v_exp_f32 v87, v87
  v_cvt_pk_bf16_f32 v80, v80, v81
  v_cvt_pk_bf16_f32 v81, v82, v83
  v_cvt_pk_bf16_f32 v82, v84, v85
  v_cvt_pk_bf16_f32 v83, v86, v87
  v_exp_f32 v88, v88
  v_exp_f32 v89, v89
  s_waitcnt lgkmcnt(6)
  v_mfma_f32_32x32x16_bf16 v[32:47], v[238:241], v[196:199], v[32:47]
  ds_read_b64_tr_b16 v[230:231], v24 offset:1280
  ds_read_b64_tr_b16 v[232:233], v24 offset:1408
  v_exp_f32 v90, v90
  v_exp_f32 v91, v91
  v_exp_f32 v92, v92
  v_exp_f32 v93, v93
  v_exp_f32 v94, v94
  s_waitcnt lgkmcnt(6)
  v_mfma_f32_32x32x16_bf16 v[32:47], v[242:245], v[80:83], v[32:47]
  ds_read_b64_tr_b16 v[234:235], v24 offset:1536
  ds_read_b64_tr_b16 v[236:237], v24 offset:1664
  v_exp_f32 v95, v95
  v_cvt_pk_bf16_f32 v84, v88, v89
  v_cvt_pk_bf16_f32 v85, v90, v91
  v_cvt_pk_bf16_f32 v86, v92, v93
  v_cvt_pk_bf16_f32 v87, v94, v95
  v_exp_f32 v96, v96
  v_exp_f32 v97, v97
  s_waitcnt lgkmcnt(6)
  v_mfma_f32_32x32x16_bf16 v[32:47], v[246:249], v[84:87], v[32:47]
  ds_read_b64_tr_b16 v[238:239], v24 offset:1792
  ds_read_b64_tr_b16 v[240:241], v24 offset:1920
  v_exp_f32 v98, v98
  v_exp_f32 v99, v99
  v_exp_f32 v100, v100
  v_exp_f32 v101, v101
  v_exp_f32 v102, v102
  v_mfma_f32_32x32x8_bf16 v[128:143], v[58:59], v[62:63], v[128:143]
  v_exp_f32 v103, v103
  v_cvt_pk_bf16_f32 v96, v96, v97
  v_cvt_pk_bf16_f32 v97, v98, v99
  v_cvt_pk_bf16_f32 v98, v100, v101
  v_cvt_pk_bf16_f32 v99, v102, v103
  v_exp_f32 v104, v104
  v_exp_f32 v105, v105
  s_waitcnt lgkmcnt(6)
  v_mfma_f32_32x32x16_bf16 v[32:47], v[226:229], v[96:99], v[32:47]
  ds_read_b64_tr_b16 v[242:243], v24 offset:2048
  ds_read_b64_tr_b16 v[244:245], v24 offset:2176
  v_exp_f32 v106, v106
  v_exp_f32 v107, v107
  v_exp_f32 v108, v108
  v_exp_f32 v109, v109
  v_exp_f32 v110, v110
  v_exp_f32 v111, v111
  v_cvt_pk_bf16_f32 v100, v104, v105
  v_cvt_pk_bf16_f32 v101, v106, v107
  v_cvt_pk_bf16_f32 v102, v108, v109
  v_cvt_pk_bf16_f32 v103, v110, v111
  v_exp_f32 v112, v112
  v_exp_f32 v113, v113
  s_waitcnt lgkmcnt(6)
  v_mfma_f32_32x32x16_bf16 v[32:47], v[230:233], v[100:103], v[32:47]
  ds_read_b64_tr_b16 v[246:247], v24 offset:2304
  ds_read_b64_tr_b16 v[248:249], v24 offset:2432
  v_exp_f32 v114, v114
  v_exp_f32 v115, v115
  v_exp_f32 v116, v116
  v_exp_f32 v117, v117
  v_exp_f32 v118, v118
  v_mfma_f32_32x32x8_bf16 v[144:159], v[58:59], v[62:63], v[144:159]
  v_exp_f32 v119, v119
  v_cvt_pk_bf16_f32 v112, v112, v113
  v_cvt_pk_bf16_f32 v113, v114, v115
  v_cvt_pk_bf16_f32 v114, v116, v117
  v_cvt_pk_bf16_f32 v115, v118, v119
  v_exp_f32 v120, v120
  v_exp_f32 v121, v121
  s_waitcnt lgkmcnt(6)
  v_mfma_f32_32x32x16_bf16 v[32:47], v[234:237], v[112:115], v[32:47]
  ds_read_b64_tr_b16 v[226:227], v24 offset:2560
  ds_read_b64_tr_b16 v[228:229], v24 offset:2688
  v_exp_f32 v122, v122
  v_exp_f32 v123, v123
  v_exp_f32 v124, v124
  v_exp_f32 v125, v125
  v_exp_f32 v126, v126
  v_exp_f32 v127, v127
  v_cvt_pk_bf16_f32 v116, v120, v121
  v_cvt_pk_bf16_f32 v117, v122, v123
  v_cvt_pk_bf16_f32 v118, v124, v125
  v_cvt_pk_bf16_f32 v119, v126, v127
  v_exp_f32 v128, v128
  v_exp_f32 v129, v129
  s_waitcnt lgkmcnt(6)
  v_mfma_f32_32x32x16_bf16 v[32:47], v[238:241], v[116:119], v[32:47]
  ds_read_b64_tr_b16 v[230:231], v24 offset:2816
  ds_read_b64_tr_b16 v[232:233], v24 offset:2944
  v_exp_f32 v130, v130
  v_exp_f32 v131, v131
  v_exp_f32 v132, v132
  v_exp_f32 v133, v133
  v_exp_f32 v134, v134
  v_mfma_f32_32x32x8_bf16 v[160:175], v[58:59], v[62:63], v[160:175]
  v_exp_f32 v135, v135
  v_cvt_pk_bf16_f32 v128, v128, v129
  v_cvt_pk_bf16_f32 v129, v130, v131
  v_cvt_pk_bf16_f32 v130, v132, v133
  v_cvt_pk_bf16_f32 v131, v134, v135
  v_exp_f32 v136, v136
  v_exp_f32 v137, v137
  s_waitcnt lgkmcnt(6)
  v_mfma_f32_32x32x16_bf16 v[32:47], v[242:245], v[128:131], v[32:47]
  ds_read_b64_tr_b16 v[234:235], v24 offset:3072
  ds_read_b64_tr_b16 v[236:237], v24 offset:3200
  v_exp_f32 v138, v138
  v_exp_f32 v139, v139
  v_exp_f32 v140, v140
  v_exp_f32 v141, v141
  v_exp_f32 v142, v142
  v_exp_f32 v143, v143
  v_cvt_pk_bf16_f32 v132, v136, v137
  v_cvt_pk_bf16_f32 v133, v138, v139
  v_cvt_pk_bf16_f32 v134, v140, v141
  v_cvt_pk_bf16_f32 v135, v142, v143
  v_exp_f32 v144, v144
  v_exp_f32 v145, v145
  s_waitcnt lgkmcnt(6)
  v_mfma_f32_32x32x16_bf16 v[32:47], v[246:249], v[132:135], v[32:47]
  ds_read_b64_tr_b16 v[238:239], v24 offset:3328
  ds_read_b64_tr_b16 v[240:241], v24 offset:3456
  v_exp_f32 v146, v146
  v_exp_f32 v147, v147
  v_exp_f32 v148, v148
  v_exp_f32 v149, v149
  v_exp_f32 v150, v150
  v_mfma_f32_32x32x8_bf16 v[176:191], v[58:59], v[62:63], v[176:191]
  v_exp_f32 v151, v151
  v_cvt_pk_bf16_f32 v144, v144, v145
  v_cvt_pk_bf16_f32 v145, v146, v147
  v_cvt_pk_bf16_f32 v146, v148, v149
  v_cvt_pk_bf16_f32 v147, v150, v151
  v_exp_f32 v152, v152
  v_exp_f32 v153, v153
  s_waitcnt lgkmcnt(6)
  v_mfma_f32_32x32x16_bf16 v[32:47], v[226:229], v[144:147], v[32:47]
  ds_read_b64_tr_b16 v[242:243], v24 offset:3584
  ds_read_b64_tr_b16 v[244:245], v24 offset:3712
  v_exp_f32 v154, v154
  v_exp_f32 v155, v155
  v_exp_f32 v156, v156
  v_exp_f32 v157, v157
  v_exp_f32 v158, v158
  v_exp_f32 v159, v159
  v_cvt_pk_bf16_f32 v148, v152, v153
  v_cvt_pk_bf16_f32 v149, v154, v155
  v_cvt_pk_bf16_f32 v150, v156, v157
  v_cvt_pk_bf16_f32 v151, v158, v159
  v_exp_f32 v160, v160
  v_exp_f32 v161, v161
  s_waitcnt lgkmcnt(6)
  v_mfma_f32_32x32x16_bf16 v[32:47], v[230:233], v[148:151], v[32:47]
  ds_read_b64_tr_b16 v[246:247], v24 offset:3840
  ds_read_b64_tr_b16 v[248:249], v24 offset:3968
  v_exp_f32 v162, v162
  v_exp_f32 v163, v163
  v_exp_f32 v164, v164
  v_exp_f32 v165, v165
  v_exp_f32 v166, v166
  v_exp_f32 v167, v167
  v_cvt_pk_bf16_f32 v160, v160, v161
  v_cvt_pk_bf16_f32 v161, v162, v163
  v_cvt_pk_bf16_f32 v162, v164, v165
  v_cvt_pk_bf16_f32 v163, v166, v167
  v_exp_f32 v168, v168
  v_exp_f32 v169, v169
  s_waitcnt lgkmcnt(6)
  v_mfma_f32_32x32x16_bf16 v[32:47], v[234:237], v[160:163], v[32:47]
  v_exp_f32 v170, v170
  v_exp_f32 v171, v171
  v_exp_f32 v172, v172
  v_exp_f32 v173, v173
  v_exp_f32 v174, v174
  v_exp_f32 v175, v175
  v_cvt_pk_bf16_f32 v164, v168, v169
  v_cvt_pk_bf16_f32 v165, v170, v171
  v_cvt_pk_bf16_f32 v166, v172, v173
  v_cvt_pk_bf16_f32 v167, v174, v175
  v_exp_f32 v176, v176
  v_exp_f32 v177, v177
  s_waitcnt lgkmcnt(4)
  v_mfma_f32_32x32x16_bf16 v[32:47], v[238:241], v[164:167], v[32:47]
  v_exp_f32 v178, v178
  v_exp_f32 v179, v179
  v_exp_f32 v180, v180
  v_exp_f32 v181, v181
  v_exp_f32 v182, v182
  v_exp_f32 v183, v183
  v_cvt_pk_bf16_f32 v176, v176, v177
  v_cvt_pk_bf16_f32 v177, v178, v179
  v_cvt_pk_bf16_f32 v178, v180, v181
  v_cvt_pk_bf16_f32 v179, v182, v183
  v_exp_f32 v184, v184
  v_exp_f32 v185, v185
  s_waitcnt lgkmcnt(2)
  v_mfma_f32_32x32x16_bf16 v[32:47], v[242:245], v[176:179], v[32:47]
  v_exp_f32 v186, v186
  v_exp_f32 v187, v187
  v_exp_f32 v188, v188
  v_exp_f32 v189, v189
  v_exp_f32 v190, v190
  v_exp_f32 v191, v191
  v_cvt_pk_bf16_f32 v180, v184, v185
  v_cvt_pk_bf16_f32 v181, v186, v187
  v_cvt_pk_bf16_f32 v182, v188, v189
  v_cvt_pk_bf16_f32 v183, v190, v191
  s_waitcnt lgkmcnt(0)
  s_nop 0
  v_mfma_f32_32x32x16_bf16 v[32:47], v[246:249], v[180:183], v[32:47]
  s_nop 11
  v_rcp_f32 v60, v44
  s_nop 0
  v_mul_f32 v32, v60, v32
  v_mul_f32 v33, v60, v33
  v_mul_f32 v34, v60, v34
  v_mul_f32 v35, v60, v35
  v_mul_f32 v36, v60, v36
  v_mul_f32 v37, v60, v37
  v_mul_f32 v38, v60, v38
  v_mul_f32 v39, v60, v39
  v_mul_f32 v40, v60, v40
  v_mul_f32 v41, v60, v41
  v_mul_f32 v42, v60, v42
  v_mul_f32 v43, v60, v43
  v_cvt_pk_bf16_f32 v48, v32, v33
  v_cvt_pk_bf16_f32 v49, v34, v35
  v_cvt_pk_bf16_f32 v50, v36, v37
  v_cvt_pk_bf16_f32 v51, v38, v39
  v_cvt_pk_bf16_f32 v52, v40, v41
  v_cvt_pk_bf16_f32 v53, v42, v43
  buffer_store_dwordx4 v[48:51], v8, s[8:11], s51 offen sc1
  buffer_store_dwordx2 v[52:53], v18, s[8:11], s52 offen sc1
  s_lshl_b32 s40, s31, 10
  s_lshl_b32 s44, s30, 2
  s_add_u32 s40, s40, s44
  s_lshl_b32 s40, s40, 5
  s_add_u32 s40, s40, 0x1d80000
  s_and_b32 s56, s24, 1
  s_lshl_b32 s56, s56, 3
  s_and_b32 s57, s25, 7
  s_add_u32 s56, s56, s57
  s_lshr_b32 s57, s24, 1
  s_lshl_b32 s57, s57, 2
  s_lshr_b32 s58, s25, 3
  s_add_u32 s57, s57, s58
  s_mul_i32 s58, s57, 7
  s_add_u32 s58, s58, s26
  s_cmp_lt_u32 s26, 7
  s_cselect_b32 s58, s58, 108
  s_mul_i32 s59, s58, 41984
  s_add_u32 s59, s59, 0x2000000
  s_min_u32 s74, s58, 107
  s_lshr_b32 s74, s74, 2
  s_lshl_b32 s74, s74, 5
  s_lshl_b32 s74, s74, 5
  s_add_u32 s74, s74, 0x1e00000
  v_and_b32 v11, 7, v1
  v_lshlrev_b32 v11, 7, v11
  s_lshr_b32 s20, s25, 3
  s_add_u32 s20, s20, s25
  s_add_u32 s16, s20, 0
  s_and_b32 s16, s16, 3
  s_mul_i32 s16, s16, 10240
  s_add_u32 s17, s20, 1
  s_and_b32 s17, s17, 3
  s_mul_i32 s17, s17, 10240
  s_add_u32 s18, s20, 2
  s_and_b32 s18, s18, 3
  s_mul_i32 s18, s18, 10240
  s_add_u32 s19, s20, 3
  s_and_b32 s19, s19, 3
  s_mul_i32 s19, s19, 10240
  s_lshl_b32 s30, s24, 2
  s_and_b32 s33, s25, 3
  s_add_u32 s30, s30, s33
  s_lshr_b32 s31, s25, 2
  s_and_b32 s34, s26, 3
  s_lshr_b32 s35, s26, 2
  s_lshl_b32 s36, s30, 2
  s_lshl_b32 s37, s35, 1
  s_add_u32 s36, s36, s37
  s_lshl_b32 s41, s36, 8
  s_mul_i32 s38, s34, 655360
  s_add_u32 s41, s41, s38
  s_add_u32 s41, s41, 0x0
  s_mul_i32 s38, s34, 5120
  v_lshrrev_b32 v0, 4, v1
  v_lshlrev_b32 v0, 15, v0
  v_and_b32 v4, 15, v1
  v_lshl_add_u32 v0, v4, 4, v0
  s_lshl_b32 s43, s30, 13
  s_add_u32 s43, s43, 0x1d80000
  v_and_b32 v7, 15, v1
  v_lshrrev_b32 v8, 4, v1
  s_lshr_b32 s49, s34, 1
  s_add_u32 s50, s36, s49
  s_and_b32 s51, s34, 1
  s_lshl_b32 s52, s50, 4
  v_add_u32 v9, s52, v7
  v_mul_u32_u24 v5, 1280, v9
  v_lshl_add_u32 v5, v8, 3, v5
  s_mul_i32 s53, s31, 160
  s_mul_i32 s54, s51, 96
  s_add_u32 s53, s53, s54
  buffer_load_dwordx2 v[252:253], v5, s[4:7], s53 offen offset:0
  buffer_load_dwordx2 v[254:255], v5, s[4:7], s53 offen offset:32
  buffer_load_dwordx2 v[12:13], v5, s[4:7], s53 offen offset:64
  v_and_b32 v10, 31, v9
  v_lshlrev_b32 v6, 4, v10
  v_lshrrev_b32 v10, 1, v8
  v_lshl_add_u32 v6, v10, 9, v6
  v_and_b32 v10, 1, v8
  v_lshl_add_u32 v6, v10, 3, v6
  s_lshr_b32 s54, s50, 1
  s_mul_i32 s54, s54, 40
  s_mul_i32 s55, s31, 5
  s_add_u32 s54, s54, s55
  s_mul_i32 s55, s51, 3
  s_add_u32 s54, s54, s55
  s_lshl_b32 s54, s54, 10
  s_add_u32 s54, s54, 0xb00000
  s_add_u32 s38, s38, 0xf000
  v_add_u32 v14, s38, v2
  v_add_u32 v15, 0x10000, v14
  s_mul_i32 s61, s35, 30720
  v_lshlrev_b32 v20, 13, v1
  s_sub_u32 s44, s34, 1
  s_and_b32 s44, s44, 3
  s_lshl_b32 s44, s44, 10
  s_add_u32 s44, s44, s61
  v_add_u32 v5, s44, v2
  s_cmp_lg_u32 s34, 0
  s_cselect_b64 s[62:63], -1, 0
  s_sub_u32 s44, s34, 2
  s_and_b32 s44, s44, 3
  s_lshl_b32 s44, s44, 10
  s_add_u32 s44, s44, s61
  v_add_u32 v8, s44, v2
  s_cmp_lg_u32 s34, 1
  s_cselect_b64 s[64:65], -1, 0
  s_sub_u32 s44, s34, 3
  s_and_b32 s44, s44, 3
  s_lshl_b32 s44, s44, 10
  s_add_u32 s44, s44, s61
  v_add_u32 v9, s44, v2
  s_cmp_lg_u32 s34, 2
  s_cselect_b64 s[66:67], -1, 0
  s_sub_u32 s44, s34, 4
  s_and_b32 s44, s44, 3
  s_lshl_b32 s44, s44, 10
  s_add_u32 s44, s44, s61
  v_add_u32 v10, s44, v2
  s_cmp_lg_u32 s34, 3
  s_cselect_b64 s[68:69], -1, 0
  s_waitcnt vmcnt(3)
LC_ob3:
  s_barrier
  s_cmp_eq_u32 s26, 7
  s_cbranch_scc0 LC_y2
  s_setprio 3
  s_mov_b64 exec, 15
  buffer_store_dword v21, v20, s[8:11], s40 offen sc1
  s_mov_b64 exec, -1
  s_branch LC_y1
LC_y2:
  s_cmp_eq_u32 s26, 4
  s_cbranch_scc0 LC_y1
  s_mov_b64 exec, 1
  buffer_store_dword v21, v20, s[8:11], s76 offen sc1
  s_mov_b64 exec, -1
  s_mov_b64 exec, 1
  buffer_store_dword v21, v20, s[8:11], s77 offen sc1
  s_mov_b64 exec, -1
LC_y1:
  ds_read_b128 v[232:235], v14 offset:0
  ds_read_b128 v[236:239], v14 offset:20480
  ds_read_b128 v[240:243], v14 offset:40960
  ds_read_b128 v[244:247], v14 offset:61440
  ds_read_b128 v[248:251], v15 offset:16384
  s_lshl_b32 s44, s34, 3
  s_lshl_b32 s44, 0xff, s44
  s_mov_b32 s45, 0
  s_mov_b64 exec, s[44:45]
  s_mov_b32 s28, 0
Lpoll9:
  buffer_load_dword v4, v3, s[8:11], s43 offen offset:0 sc1
  s_add_u32 s28, s28, 1
  s_cmp_gt_u32 s28, 1000000
  s_cbranch_scc1 Lpoll9x
  s_waitcnt vmcnt(0)
  v_cmp_ne_u32 vcc, s27, v4
  s_nop 4
  s_cbranch_vccz Lpoll9x
  s_sleep 1
  s_branch Lpoll9
Lpoll9x:
  s_waitcnt vmcnt(0)
  s_mov_b64 exec, -1
  s_add_u32 s42, s41, 0x0
  buffer_load_dwordx4 v[56:59], v0, s[8:11], s42 offen offset:0 sc1
  buffer_load_dwordx4 v[60:63], v0, s[8:11], s42 offen offset:256 sc1
  s_add_u32 s42, s41, 0x20000
  buffer_load_dwordx4 v[64:67], v0, s[8:11], s42 offen offset:0 sc1
  buffer_load_dwordx4 v[68:71], v0, s[8:11], s42 offen offset:256 sc1
  s_add_u32 s42, s41, 0x40000
  buffer_load_dwordx4 v[72:75], v0, s[8:11], s42 offen offset:0 sc1
  buffer_load_dwordx4 v[76:79], v0, s[8:11], s42 offen offset:256 sc1
  s_add_u32 s42, s41, 0x60000
  buffer_load_dwordx4 v[80:83], v0, s[8:11], s42 offen offset:0 sc1
  buffer_load_dwordx4 v[84:87], v0, s[8:11], s42 offen offset:256 sc1
  s_add_u32 s42, s41, 0x80000
  buffer_load_dwordx4 v[88:91], v0, s[8:11], s42 offen offset:0 sc1
  buffer_load_dwordx4 v[228:231], v0, s[8:11], s42 offen offset:256 sc1
  s_mov_b64 exec, 0xff
  buffer_load_dword v4, v11, s[8:11], s74 offen offset:0 sc1
  s_mov_b64 exec, -1
  s_waitcnt vmcnt(10)
  s_waitcnt lgkmcnt(4)
  v_mfma_f32_16x16x32_bf16 v[16:19], v[232:235], v[56:59], 0
  s_waitcnt vmcnt(9)
  v_mfma_f32_16x16x32_bf16 v[36:39], v[232:235], v[60:63], 0
  ds_read_b128 v[232:235], v14 offset:1024
  s_waitcnt lgkmcnt(4)
  v_mfma_f32_16x16x32_bf16 v[20:23], v[236:239], v[56:59], 0
  v_mfma_f32_16x16x32_bf16 v[40:43], v[236:239], v[60:63], 0
  ds_read_b128 v[236:239], v14 offset:21504
  s_waitcnt lgkmcnt(4)
  v_mfma_f32_16x16x32_bf16 v[24:27], v[240:243], v[56:59], 0
  v_mfma_f32_16x16x32_bf16 v[44:47], v[240:243], v[60:63], 0
  ds_read_b128 v[240:243], v14 offset:41984
  s_waitcnt lgkmcnt(4)
  v_mfma_f32_16x16x32_bf16 v[28:31], v[244:247], v[56:59], 0
  v_mfma_f32_16x16x32_bf16 v[48:51], v[244:247], v[60:63], 0
  ds_read_b128 v[244:247], v14 offset:62464
  s_waitcnt lgkmcnt(4)
  v_mfma_f32_16x16x32_bf16 v[32:35], v[248:251], v[56:59], 0
  v_mfma_f32_16x16x32_bf16 v[52:55], v[248:251], v[60:63], 0
  ds_read_b128 v[248:251], v15 offset:17408
  s_waitcnt vmcnt(8)
  s_waitcnt lgkmcnt(4)
  v_mfma_f32_16x16x32_bf16 v[16:19], v[232:235], v[64:67], v[16:19]
  s_waitcnt vmcnt(7)
  v_mfma_f32_16x16x32_bf16 v[36:39], v[232:235], v[68:71], v[36:39]
  ds_read_b128 v[232:235], v14 offset:2048
  s_waitcnt lgkmcnt(4)
  v_mfma_f32_16x16x32_bf16 v[20:23], v[236:239], v[64:67], v[20:23]
  v_mfma_f32_16x16x32_bf16 v[40:43], v[236:239], v[68:71], v[40:43]
  ds_read_b128 v[236:239], v14 offset:22528
  s_waitcnt lgkmcnt(4)
  v_mfma_f32_16x16x32_bf16 v[24:27], v[240:243], v[64:67], v[24:27]
  v_mfma_f32_16x16x32_bf16 v[44:47], v[240:243], v[68:71], v[44:47]
  ds_read_b128 v[240:243], v14 offset:43008
  s_waitcnt lgkmcnt(4)
  v_mfma_f32_16x16x32_bf16 v[28:31], v[244:247], v[64:67], v[28:31]
  v_mfma_f32_16x16x32_bf16 v[48:51], v[244:247], v[68:71], v[48:51]
  ds_read_b128 v[244:247], v14 offset:63488
  s_waitcnt lgkmcnt(4)
  v_mfma_f32_16x16x32_bf16 v[32:35], v[248:251], v[64:67], v[32:35]
  v_mfma_f32_16x16x32_bf16 v[52:55], v[248:251], v[68:71], v[52:55]
  ds_read_b128 v[248:251], v15 offset:18432
  s_waitcnt vmcnt(6)
  s_waitcnt lgkmcnt(4)
  v_mfma_f32_16x16x32_bf16 v[16:19], v[232:235], v[72:75], v[16:19]
  s_waitcnt vmcnt(5)
  v_mfma_f32_16x16x32_bf16 v[36:39], v[232:235], v[76:79], v[36:39]
  ds_read_b128 v[232:235], v14 offset:3072
  s_waitcnt lgkmcnt(4)
  v_mfma_f32_16x16x32_bf16 v[20:23], v[236:239], v[72:75], v[20:23]
  v_mfma_f32_16x16x32_bf16 v[40:43], v[236:239], v[76:79], v[40:43]
  ds_read_b128 v[236:239], v14 offset:4096
  s_waitcnt lgkmcnt(4)
  v_mfma_f32_16x16x32_bf16 v[24:27], v[240:243], v[72:75], v[24:27]
  v_mfma_f32_16x16x32_bf16 v[44:47], v[240:243], v[76:79], v[44:47]
  ds_read_b128 v[240:243], v14 offset:23552
  s_waitcnt lgkmcnt(4)
  v_mfma_f32_16x16x32_bf16 v[28:31], v[244:247], v[72:75], v[28:31]
  v_mfma_f32_16x16x32_bf16 v[48:51], v[244:247], v[76:79], v[48:51]
  ds_read_b128 v[244:247], v14 offset:24576
  s_waitcnt lgkmcnt(4)
  v_mfma_f32_16x16x32_bf16 v[32:35], v[248:251], v[72:75], v[32:35]
  v_mfma_f32_16x16x32_bf16 v[52:55], v[248:251], v[76:79], v[52:55]
  ds_read_b128 v[248:251], v14 offset:44032
  s_waitcnt vmcnt(4)
  s_waitcnt lgkmcnt(4)
  v_mfma_f32_16x16x32_bf16 v[16:19], v[232:235], v[80:83], v[16:19]
  s_waitcnt vmcnt(3)
  v_mfma_f32_16x16x32_bf16 v[36:39], v[232:235], v[84:87], v[36:39]
  ds_read_b128 v[232:235], v14 offset:45056
  s_waitcnt vmcnt(2)
  s_waitcnt lgkmcnt(4)
  v_mfma_f32_16x16x32_bf16 v[16:19], v[236:239], v[88:91], v[16:19]
  s_waitcnt vmcnt(1)
  v_mfma_f32_16x16x32_bf16 v[36:39], v[236:239], v[228:231], v[36:39]
  ds_read_b128 v[236:239], v14 offset:64512
  s_waitcnt lgkmcnt(4)
  v_mfma_f32_16x16x32_bf16 v[20:23], v[240:243], v[80:83], v[20:23]
  v_mfma_f32_16x16x32_bf16 v[40:43], v[240:243], v[84:87], v[40:43]
  ds_read_b128 v[240:243], v15 offset:0
  s_waitcnt lgkmcnt(4)
  v_mfma_f32_16x16x32_bf16 v[20:23], v[244:247], v[88:91], v[20:23]
  v_mfma_f32_16x16x32_bf16 v[40:43], v[244:247], v[228:231], v[40:43]
  ds_read_b128 v[244:247], v15 offset:19456
  s_mov_b64 exec, s[62:63]
  ds_write_b128 v5, v[16:19] offset:0
  s_mov_b64 exec, -1
  s_mov_b64 exec, s[66:67]
  ds_write_b128 v9, v[36:39] offset:15360
  s_mov_b64 exec, -1
  s_waitcnt lgkmcnt(6)
  v_mfma_f32_16x16x32_bf16 v[24:27], v[248:251], v[80:83], v[24:27]
  v_mfma_f32_16x16x32_bf16 v[44:47], v[248:251], v[84:87], v[44:47]
  ds_read_b128 v[248:251], v15 offset:20480
  s_mov_b64 exec, 0xff
  s_waitcnt vmcnt(0)
  v_cmp_ne_u32 vcc, s27, v4
  s_nop 4
  s_cbranch_vccz Lchk10x
  s_mov_b32 s28, 0
Lchk10:
  s_sleep 4
  buffer_load_dword v4, v11, s[8:11], s74 offen offset:0 sc1
  s_add_u32 s28, s28, 1
  s_waitcnt vmcnt(0)
  s_cmp_gt_u32 s28, 1000000
  s_cbranch_scc1 Lchk10x
  v_cmp_ne_u32 vcc, s27, v4
  s_nop 4
  s_cbranch_vccnz Lchk10
Lchk10x:
  s_mov_b64 exec, -1
  s_add_u32 s60, s59, s16
  buffer_load_dwordx4 v[92:95], v2, s[8:11], s60 offen offset:0 sc1
  s_waitcnt lgkmcnt(6)
  v_mfma_f32_16x16x32_bf16 v[24:27], v[232:235], v[88:91], v[24:27]
  v_mfma_f32_16x16x32_bf16 v[44:47], v[232:235], v[228:231], v[44:47]
  s_mov_b64 exec, s[62:63]
  ds_write_b128 v5, v[20:23] offset:3072
  s_mov_b64 exec, -1
  s_mov_b64 exec, s[66:67]
  ds_write_b128 v9, v[40:43] offset:18432
  s_mov_b64 exec, -1
  s_add_u32 s60, s59, s16
  buffer_load_dwordx4 v[96:99], v2, s[8:11], s60 offen offset:1024 sc1
  s_waitcnt lgkmcnt(7)
  v_mfma_f32_16x16x32_bf16 v[28:31], v[236:239], v[80:83], v[28:31]
  v_mfma_f32_16x16x32_bf16 v[48:51], v[236:239], v[84:87], v[48:51]
  s_add_u32 s60, s59, s16
  buffer_load_dwordx4 v[100:103], v2, s[8:11], s60 offen offset:2048 sc1
  s_waitcnt lgkmcnt(6)
  v_mfma_f32_16x16x32_bf16 v[28:31], v[240:243], v[88:91], v[28:31]
  v_mfma_f32_16x16x32_bf16 v[48:51], v[240:243], v[228:231], v[48:51]
  s_mov_b64 exec, s[62:63]
  ds_write_b128 v5, v[24:27] offset:6144
  s_mov_b64 exec, -1
  s_mov_b64 exec, s[66:67]
  ds_write_b128 v9, v[44:47] offset:21504
  s_mov_b64 exec, -1
  s_add_u32 s60, s59, s16
  buffer_load_dwordx4 v[104:107], v2, s[8:11], s60 offen offset:3072 sc1
  s_waitcnt lgkmcnt(7)
  v_mfma_f32_16x16x32_bf16 v[32:35], v[244:247], v[80:83], v[32:35]
  v_mfma_f32_16x16x32_bf16 v[52:55], v[244:247], v[84:87], v[52:55]
  s_add_u32 s60, s59, s16
  s_add_u32 s60, s60, 4096
  buffer_load_dwordx4 v[108:111], v2, s[8:11], s60 offen offset:0 sc1
  s_waitcnt lgkmcnt(4)
  v_mfma_f32_16x16x32_bf16 v[32:35], v[248:251], v[88:91], v[32:35]
  v_mfma_f32_16x16x32_bf16 v[52:55], v[248:251], v[228:231], v[52:55]
  s_mov_b64 exec, s[64:65]
  ds_write_b128 v8, v[28:31] offset:9216
  s_mov_b64 exec, -1
  s_mov_b64 exec, s[68:69]
  ds_write_b128 v10, v[48:51] offset:24576
  s_mov_b64 exec, -1
  s_add_u32 s60, s59, s16
  s_add_u32 s60, s60, 4096
  buffer_load_dwordx4 v[112:115], v2, s[8:11], s60 offen offset:1024 sc1
  s_mov_b64 exec, s[64:65]
  ds_write_b128 v8, v[32:35] offset:12288
  s_mov_b64 exec, -1
  s_mov_b64 exec, s[68:69]
  ds_write_b128 v10, v[52:55] offset:27648
  s_mov_b64 exec, -1
  s_add_u32 s60, s59, s16
  s_add_u32 s60, s60, 4096
  buffer_load_dwordx4 v[116:119], v2, s[8:11], s60 offen offset:2048 sc1
  s_add_u32 s60, s59, s16
  s_add_u32 s60, s60, 4096
  buffer_load_dwordx4 v[120:123], v2, s[8:11], s60 offen offset:3072 sc1
  s_add_u32 s60, s59, s16
  s_add_u32 s60, s60, 8192
  buffer_load_dwordx4 v[124:127], v2, s[8:11], s60 offen offset:0 sc1
  s_add_u32 s60, s59, s16
  s_add_u32 s60, s60, 8192
  buffer_load_dwordx4 v[128:131], v2, s[8:11], s60 offen offset:1024 sc1
  s_add_u32 s60, s59, s17
  buffer_load_dwordx4 v[132:135], v2, s[8:11], s60 offen offset:0 sc1
  s_add_u32 s60, s59, s17
  buffer_load_dwordx4 v[136:139], v2, s[8:11], s60 offen offset:1024 sc1
  v_add_u32 v3, s61, v2
  s_cmp_lg_u32 s34, 0
  s_cbranch_scc1 LC_r1
  v_mov_b32 v56, v16
  v_mov_b32 v57, v17
  v_mov_b32 v58, v18
  v_mov_b32 v59, v19
  v_mov_b32 v60, v20
  v_mov_b32 v61, v21
  v_mov_b32 v62, v22
  v_mov_b32 v63, v23
  v_mov_b32 v64, v24
  v_mov_b32 v65, v25
  v_mov_b32 v66, v26
  v_mov_b32 v67, v27
  s_waitcnt lgkmcnt(0)
  s_branch LC_rd
LC_r1:
  s_cmp_lg_u32 s34, 1
  s_cbranch_scc1 LC_r2
  v_mov_b32 v56, v28
  v_mov_b32 v57, v29
  v_mov_b32 v58, v30
  v_mov_b32 v59, v31
  v_mov_b32 v60, v32
  v_mov_b32 v61, v33
  v_mov_b32 v62, v34
  v_mov_b32 v63, v35
  s_waitcnt lgkmcnt(0)
  s_branch LC_rd
LC_r2:
  s_cmp_lg_u32 s34, 2
  s_cbranch_scc1 LC_r3
  v_mov_b32 v56, v36
  v_mov_b32 v57, v37
  v_mov_b32 v58, v38
  v_mov_b32 v59, v39
  v_mov_b32 v60, v40
  v_mov_b32 v61, v41
  v_mov_b32 v62, v42
  v_mov_b32 v63, v43
  v_mov_b32 v64, v44
  v_mov_b32 v65, v45
  v_mov_b32 v66, v46
  v_mov_b32 v67, v47
  s_waitcnt lgkmcnt(0)
  s_branch LC_rd
LC_r3:
  v_mov_b32 v56, v48
  v_mov_b32 v57, v49
  v_mov_b32 v58, v50
  v_mov_b32 v59, v51
  v_mov_b32 v60, v52
  v_mov_b32 v61, v53
  v_mov_b32 v62, v54
  v_mov_b32 v63, v55
  s_waitcnt lgkmcnt(0)
LC_rd:
  s_barrier
  s_mul_i32 s62, s49, 5
  s_add_u32 s62, s62, s55
  s_mul_i32 s62, s62, 3072
  v_add_u32 v3, s62, v3
  ds_read_b128 v[16:19], v3 offset:0
  ds_read_b128 v[20:23], v3 offset:1024
  ds_read_b128 v[24:27], v3 offset:2048
  ds_read_b128 v[28:31], v3 offset:3072
  ds_read_b128 v[32:35], v3 offset:4096
  ds_read_b128 v[36:39], v3 offset:5120
  ds_read_b128 v[40:43], v3 offset:6144
  ds_read_b128 v[44:47], v3 offset:7168
  ds_read_b128 v[48:51], v3 offset:8192
  s_mov_b32 s63, 0xffff0000
  s_mov_b32 s64, 0x3f803f80
  s_cmp_eq_u32 s51, 0
  s_cselect_b32 s65, s54, 0x7f000000
  s_cselect_b32 s66, -1, 0
  v_mov_b32 v10, 0
  v_mov_b32 v11, 0
  v_lshlrev_b32 v9, 3, v7
  s_lshl_b32 s67, s31, 1
  s_add_u32 s67, s67, s51
  s_lshl_b32 s68, s50, 4
  s_add_u32 s68, s68, s67
  s_lshl_b32 s68, s68, 7
  s_add_u32 s68, s68, 0xe00000
  s_lshr_b32 s69, s30, 1
  s_lshl_b32 s69, s69, 10
  s_and_b32 s67, s30, 1
  s_lshl_b32 s67, s67, 3
  s_add_u32 s67, s67, s31
  s_lshl_b32 s67, s67, 2
  s_add_u32 s69, s69, s67
  s_lshl_b32 s69, s69, 5
  s_add_u32 s69, s69, 0x1c00000
  v_lshlrev_b32 v68, 16, v252
  v_and_b32 v69, s63, v252
  v_lshlrev_b32 v70, 16, v253
  v_and_b32 v71, s63, v253
  v_pk_add_f32 v[56:57], v[56:57], v[68:69]
  v_pk_add_f32 v[58:59], v[58:59], v[70:71]
  s_waitcnt lgkmcnt(8)
  v_pk_add_f32 v[56:57], v[56:57], v[16:17]
  v_pk_add_f32 v[58:59], v[58:59], v[18:19]
  s_waitcnt lgkmcnt(7)
  v_pk_add_f32 v[56:57], v[56:57], v[20:21]
  v_pk_add_f32 v[58:59], v[58:59], v[22:23]
  s_waitcnt lgkmcnt(6)
  v_pk_add_f32 v[56:57], v[56:57], v[24:25]
  v_pk_add_f32 v[58:59], v[58:59], v[26:27]
  v_cvt_pk_bf16_f32 v72, v56, v57
  v_cvt_pk_bf16_f32 v73, v58, v59
  buffer_store_dwordx2 v[72:73], v6, s[8:11], s54 offen offset:0 sc1
  v_lshlrev_b32 v68, 16, v254
  v_and_b32 v69, s63, v254
  v_lshlrev_b32 v70, 16, v255
  v_and_b32 v71, s63, v255
  v_pk_add_f32 v[60:61], v[60:61], v[68:69]
  v_pk_add_f32 v[62:63], v[62:63], v[70:71]
  s_waitcnt lgkmcnt(5)
  v_pk_add_f32 v[60:61], v[60:61], v[28:29]
  v_pk_add_f32 v[62:63], v[62:63], v[30:31]
  s_waitcnt lgkmcnt(4)
  v_pk_add_f32 v[60:61], v[60:61], v[32:33]
  v_pk_add_f32 v[62:63], v[62:63], v[34:35]
  s_waitcnt lgkmcnt(3)
  v_pk_add_f32 v[60:61], v[60:61], v[36:37]
  v_pk_add_f32 v[62:63], v[62:63], v[38:39]
  v_cvt_pk_bf16_f32 v74, v60, v61
  v_cvt_pk_bf16_f32 v75, v62, v63
  buffer_store_dwordx2 v[74:75], v6, s[8:11], s54 offen offset:1024 sc1
  v_lshlrev_b32 v68, 16, v12
  v_and_b32 v69, s63, v12
  v_lshlrev_b32 v70, 16, v13
  v_and_b32 v71, s63, v13
  v_pk_add_f32 v[64:65], v[64:65], v[68:69]
  v_pk_add_f32 v[66:67], v[66:67], v[70:71]
  s_waitcnt lgkmcnt(2)
  v_pk_add_f32 v[64:65], v[64:65], v[40:41]
  v_pk_add_f32 v[66:67], v[66:67], v[42:43]
  s_waitcnt lgkmcnt(1)
  v_pk_add_f32 v[64:65], v[64:65], v[44:45]
  v_pk_add_f32 v[66:67], v[66:67], v[46:47]
  s_waitcnt lgkmcnt(0)
  v_pk_add_f32 v[64:65], v[64:65], v[48:49]
  v_pk_add_f32 v[66:67], v[66:67], v[50:51]
  v_cvt_pk_bf16_f32 v76, v64, v65
  v_cvt_pk_bf16_f32 v77, v66, v67
  buffer_store_dwordx2 v[76:77], v6, s[8:11], s65 offen offset:2048 sc1
  v_and_b32 v78, s66, v76
  v_and_b32 v79, s66, v77
  v_dot2c_f32_bf16 v10, s64, v72
  v_dot2c_f32_bf16 v11, v72, v72
  v_dot2c_f32_bf16 v10, s64, v73
  v_dot2c_f32_bf16 v11, v73, v73
  v_dot2c_f32_bf16 v10, s64, v74
  v_dot2c_f32_bf16 v11, v74, v74
  v_dot2c_f32_bf16 v10, s64, v75
  v_dot2c_f32_bf16 v11, v75, v75
  v_dot2c_f32_bf16 v10, s64, v78
  v_dot2c_f32_bf16 v11, v78, v78
  v_dot2c_f32_bf16 v10, s64, v79
  v_dot2c_f32_bf16 v11, v79, v79
  s_nop 1
  v_mov_b32 v12, v10
  v_mov_b32 v13, v11
  s_nop 0
  v_permlane32_swap_b32 v10, v12
  v_permlane32_swap_b32 v11, v13
  v_add_f32 v10, v10, v12
  v_add_f32 v11, v11, v13
  v_mov_b32 v12, v10
  v_mov_b32 v13, v11
  s_nop 0
  v_permlane16_swap_b32 v10, v12
  v_permlane16_swap_b32 v11, v13
  v_add_f32 v10, v10, v12
  v_add_f32 v11, v11, v13
  s_mov_b64 exec, 0xffff
  buffer_store_dwordx2 v[10:11], v9, s[8:11], s68 offen sc1
  s_mov_b64 exec, -1
  v_mov_b32 v12, 0
  v_mov_b32 v13, s27
  s_lshl_b32 s70, s24, 1
  s_and_b32 s71, s25, 1
  s_add_u32 s70, s70, s71
  s_lshr_b32 s71, s25, 1
  s_and_b32 s71, s71, 1
  s_lshr_b32 s72, s25, 2
  s_mul_i32 s73, s26, 7
  s_cmp_eq_u32 s26, 7
  s_cselect_b32 s74, 1, 0
  s_sub_u32 s73, s73, s74
  s_mul_i32 s74, s72, 270
  s_add_u32 s74, s74, s73
  s_lshl_b32 s74, s74, 10
  s_add_u32 s74, s74, 0x1900000
  s_and_b32 s21, s25, 1
  s_lshl_b32 s21, s21, 1
  s_add_u32 s21, s21, s71
  s_mul_i32 s21, s21, 0
  s_cmp_ge_u32 s26, 6
  s_cselect_b32 s75, 0x7f000000, 0
  s_add_u32 s97, s21, 0
  s_cmp_ge_u32 s97, 5
  s_cselect_b32 s60, 5, 0
  s_sub_u32 s97, s97, s60
  s_mul_i32 s97, s97, 55296
  s_add_u32 s97, s97, s74
  s_add_u32 s98, s21, 1
  s_cmp_ge_u32 s98, 5
  s_cselect_b32 s60, 5, 0
  s_sub_u32 s98, s98, s60
  s_mul_i32 s98, s98, 55296
  s_add_u32 s98, s98, s74
  s_add_u32 s99, s21, 2
  s_cmp_ge_u32 s99, 5
  s_cselect_b32 s60, 5, 0
  s_sub_u32 s99, s99, s60
  s_mul_i32 s99, s99, 55296
  s_add_u32 s99, s99, s74
  s_add_u32 s100, s21, 3
  s_cmp_ge_u32 s100, 5
  s_cselect_b32 s60, 5, 0
  s_sub_u32 s100, s100, s60
  s_mul_i32 s100, s100, 55296
  s_add_u32 s100, s100, s74
  s_add_u32 s101, s21, 4
  s_cmp_ge_u32 s101, 5
  s_cselect_b32 s60, 5, 0
  s_sub_u32 s101, s101, s60
  s_mul_i32 s101, s101, 55296
  s_add_u32 s101, s101, s74
  s_add_u32 s60, s59, s17
  buffer_load_dwordx4 v[140:143], v2, s[8:11], s60 offen offset:2048 sc1
  s_add_u32 s60, s59, s17
  buffer_load_dwordx4 v[144:147], v2, s[8:11], s60 offen offset:3072 sc1
  s_add_u32 s60, s59, s17
  s_add_u32 s60, s60, 4096
  buffer_load_dwordx4 v[148:151], v2, s[8:11], s60 offen offset:0 sc1
  s_add_u32 s60, s59, s17
  s_add_u32 s60, s60, 4096
  buffer_load_dwordx4 v[152:155], v2, s[8:11], s60 offen offset:1024 sc1
  s_add_u32 s60, s59, s17
  s_add_u32 s60, s60, 4096
  buffer_load_dwordx4 v[156:159], v2, s[8:11], s60 offen offset:2048 sc1
  s_waitcnt vmcnt(5)
  s_barrier
  s_cmp_eq_u32 s26, 7
  s_cbranch_scc1 LD_svc
  s_add_u32 s60, s59, s17
  s_add_u32 s60, s60, 4096
  buffer_load_dwordx4 v[160:163], v2, s[8:11], s60 offen offset:3072 sc1
  s_add_u32 s60, s59, s17
  s_add_u32 s60, s60, 8192
  buffer_load_dwordx4 v[164:167], v2, s[8:11], s60 offen offset:0 sc1
  s_add_u32 s60, s59, s17
  s_add_u32 s60, s60, 8192
  buffer_load_dwordx4 v[168:171], v2, s[8:11], s60 offen offset:1024 sc1
  s_add_u32 s60, s59, s18
  buffer_load_dwordx4 v[172:175], v2, s[8:11], s60 offen offset:0 sc1
  s_add_u32 s60, s59, s18
  buffer_load_dwordx4 v[176:179], v2, s[8:11], s60 offen offset:1024 sc1
  s_add_u32 s60, s59, s18
  buffer_load_dwordx4 v[180:183], v2, s[8:11], s60 offen offset:2048 sc1
  s_add_u32 s60, s59, s18
  buffer_load_dwordx4 v[184:187], v2, s[8:11], s60 offen offset:3072 sc1
  s_add_u32 s60, s59, s18
  s_add_u32 s60, s60, 4096
  buffer_load_dwordx4 v[188:191], v2, s[8:11], s60 offen offset:0 sc1
  s_add_u32 s60, s59, s18
  s_add_u32 s60, s60, 4096
  buffer_load_dwordx4 v[192:195], v2, s[8:11], s60 offen offset:1024 sc1
  s_add_u32 s60, s59, s18
  s_add_u32 s60, s60, 4096
  buffer_load_dwordx4 v[196:199], v2, s[8:11], s60 offen offset:2048 sc1
  s_add_u32 s60, s59, s18
  s_add_u32 s60, s60, 4096
  buffer_load_dwordx4 v[200:203], v2, s[8:11], s60 offen offset:3072 sc1
  s_add_u32 s60, s59, s18
  s_add_u32 s60, s60, 8192
  buffer_load_dwordx4 v[204:207], v2, s[8:11], s60 offen offset:0 sc1
  s_add_u32 s60, s59, s18
  s_add_u32 s60, s60, 8192
  buffer_load_dwordx4 v[208:211], v2, s[8:11], s60 offen offset:1024 sc1
  s_add_u32 s60, s59, s19
  buffer_load_dwordx4 v[212:215], v2, s[8:11], s60 offen offset:0 sc1
  s_add_u32 s60, s59, s19
  buffer_load_dwordx4 v[216:219], v2, s[8:11], s60 offen offset:1024 sc1
  s_add_u32 s60, s59, s19
  buffer_load_dwordx4 v[220:223], v2, s[8:11], s60 offen offset:2048 sc1
  v_and_b32 v5, 31, v1
  v_lshrrev_b32 v6, 5, v1
  v_lshlrev_b32 v4, 2, v5
  v_bfe_u32 v7, v1, 4, 1
  v_mul_u32_u24 v7, 55296, v7
  v_lshl_add_u32 v7, v6, 8, v7
  v_and_b32 v8, 15, v1
  v_lshl_add_u32 v7, v8, 4, v7
  s_mul_i32 s44, s56, 442368
  s_lshl_b32 s45, s58, 9
  s_add_u32 s44, s44, s45
  s_add_u32 s44, s44, 0x1000000
  s_cmp_lt_u32 s58, 108
  s_cselect_b32 s44, s44, 0x7f000000
  s_mul_i32 s47, s26, 15360
  s_add_u32 s47, s47, 0xdc00
  v_add_u32 v3, s47, v2
  s_mul_i32 s30, s70, 160
  s_mul_i32 s61, s72, 5
  s_add_u32 s30, s30, s61
  s_lshl_b32 s30, s30, 10
  s_lshl_b32 s61, s71, 8
  s_add_u32 s30, s30, s61
  s_lshl_b32 s61, s26, 5
  s_add_u32 s30, s30, s61
  s_add_u32 s30, s30, 0xb00000
  s_lshl_b32 s34, s70, 3
  s_add_u32 s34, s34, s71
  s_mul_i32 s34, s34, 20480
  s_mul_i32 s61, s72, 160
  s_add_u32 s34, s34, s61
  s_mul_i32 s61, s26, 2560
  s_add_u32 s34, s34, s61
  s_add_u32 s31, s30, 40960
  s_add_u32 s35, s34, 40960
  s_add_u32 s32, s30, 81920
  s_add_u32 s36, s34, 81920
  s_add_u32 s33, s30, 122880
  s_add_u32 s37, s34, 122880
  s_lshl_b32 s61, s70, 3
  s_add_u32 s61, s61, s71
  s_mul_i32 s42, s61, 55296
  s_lshl_b32 s61, s73, 10
  s_add_u32 s42, s42, s61
  s_add_u32 s42, s42, 0x1000000
  s_lshl_b32 s77, s56, 8
  s_lshl_b32 s78, s57, 2
  s_add_u32 s77, s77, s78
  s_lshl_b32 s77, s77, 5
  s_add_u32 s77, s77, 0x1c80000
  s_lshl_b32 s78, s70, 8
  s_lshl_b32 s78, s78, 5
  s_add_u32 s78, s78, 0x1c80000
  s_mov_b32 s63, 0xffff0000
  v_lshrrev_b32 v15, 4, v1
  v_xor_b32 v14, v1, v15
  s_lshl_b32 s61, s26, 10
  v_lshlrev_b32 v8, 4, v14
  v_add_u32 v8, s61, v8
  v_cmp_le_u32 vcc, 20, v1
  s_nop 1
  v_cndmask_b32 v14, 0, 1, vcc
  v_mul_u32_u24 v15, 20, v14
  v_sub_u32 v15, v1, v15
  v_mul_u32_u24 v5, 1280, v14
  v_lshl_add_u32 v5, v15, 3, v5
  v_lshrrev_b32 v9, 1, v15
  v_lshlrev_b32 v6, 9, v9
  v_lshl_add_u32 v6, v14, 4, v6
  v_and_b32 v9, 1, v15
  v_lshl_add_u32 v6, v9, 3, v6
  s_lshl_b32 s61, s26, 1
  v_add_u32 v14, s61, v14
  v_xor_b32 v14, v14, v15
  v_and_b32 v14, 15, v14
  v_lshlrev_b32 v14, 4, v14
  v_lshrrev_b32 v9, 2, v15
  v_lshlrev_b32 v9, 13, v9
  v_add_u32 v9, v9, v14
  v_and_b32 v14, 3, v15
  v_lshl_add_u32 v9, v14, 8, v9
  v_mov_b32 v14, 0x7f000000
  v_cmp_gt_u32 vcc, 40, v1
  s_nop 1
  v_cndmask_b32 v5, v14, v5, vcc
  v_cndmask_b32 v6, v14, v6, vcc
  v_cndmask_b32 v9, 0, v9, vcc
  s_cmp_lg_u32 s26, 0
  s_cbranch_scc1 LD_nrt
  s_getpc_b64 s[66:67]
Lrt11:
  v_lshlrev_b32 v72, 5, v1
  v_add_u32 v72, s25, v72
  v_lshlrev_b32 v72, 7, v72
  v_min_u32 v72, Lk_endcode-Lrt11-4, v72
  s_mov_b64 exec, 0x3ff
  global_load_dword v73, v72, s[66:67]
  s_mov_b64 exec, -1
LD_nrt:
  s_barrier
  ds_read_b128 v[48:51], v2 offset:0
  ds_read_b128 v[52:55], v2 offset:1024
  ds_read_b128 v[56:59], v2 offset:2048
  ds_read_b128 v[60:63], v2 offset:3072
  ds_read_b128 v[64:67], v2 offset:4096
  s_waitcnt lgkmcnt(4)
  v_mfma_f32_32x32x16_bf16 v[16:31], v[92:95], v[48:51], 0
  s_add_u32 s60, s59, s19
  buffer_load_dwordx4 v[224:227], v2, s[8:11], s60 offen offset:3072 sc1
  ds_read_b128 v[68:71], v2 offset:5120
  s_waitcnt lgkmcnt(4)
  v_mfma_f32_32x32x16_bf16 v[16:31], v[96:99], v[52:55], v[16:31]
  ds_read_b128 v[48:51], v2 offset:6144
  s_waitcnt lgkmcnt(4)
  v_mfma_f32_32x32x16_bf16 v[16:31], v[100:103], v[56:59], v[16:31]
  s_add_u32 s60, s59, s19
  s_add_u32 s60, s60, 4096
  buffer_load_dwordx4 v[228:231], v2, s[8:11], s60 offen offset:0 sc1
  ds_read_b128 v[52:55], v2 offset:7168
  s_waitcnt lgkmcnt(4)
  v_mfma_f32_32x32x16_bf16 v[16:31], v[104:107], v[60:63], v[16:31]
  ds_read_b128 v[56:59], v2 offset:8192
  s_waitcnt lgkmcnt(4)
  v_mfma_f32_32x32x16_bf16 v[16:31], v[108:111], v[64:67], v[16:31]
  s_add_u32 s60, s59, s19
  s_add_u32 s60, s60, 4096
  buffer_load_dwordx4 v[232:235], v2, s[8:11], s60 offen offset:1024 sc1
  ds_read_b128 v[60:63], v2 offset:9216
  s_waitcnt lgkmcnt(4)
  v_mfma_f32_32x32x16_bf16 v[16:31], v[112:115], v[68:71], v[16:31]
  s_barrier
  ds_read_b128 v[64:67], v2 offset:10240
  s_waitcnt lgkmcnt(4)
  v_mfma_f32_32x32x16_bf16 v[16:31], v[116:119], v[48:51], v[16:31]
  s_add_u32 s60, s59, s19
  s_add_u32 s60, s60, 4096
  buffer_load_dwordx4 v[236:239], v2, s[8:11], s60 offen offset:2048 sc1
  ds_read_b128 v[68:71], v2 offset:11264
  s_waitcnt lgkmcnt(4)
  v_mfma_f32_32x32x16_bf16 v[16:31], v[120:123], v[52:55], v[16:31]
  ds_read_b128 v[48:51], v2 offset:12288
  s_waitcnt lgkmcnt(4)
  v_mfma_f32_32x32x16_bf16 v[16:31], v[124:127], v[56:59], v[16:31]
  s_add_u32 s60, s59, s19
  s_add_u32 s60, s60, 4096
  buffer_load_dwordx4 v[240:243], v2, s[8:11], s60 offen offset:3072 sc1
  ds_read_b128 v[52:55], v2 offset:13312
  s_waitcnt lgkmcnt(4)
  v_mfma_f32_32x32x16_bf16 v[16:31], v[128:131], v[60:63], v[16:31]
  ds_read_b128 v[56:59], v2 offset:14336
  s_waitcnt lgkmcnt(4)
  v_mfma_f32_32x32x16_bf16 v[16:31], v[132:135], v[64:67], v[16:31]
  s_add_u32 s60, s59, s19
  s_add_u32 s60, s60, 8192
  buffer_load_dwordx4 v[244:247], v2, s[8:11], s60 offen offset:0 sc1
  ds_read_b128 v[60:63], v2 offset:15360
  s_waitcnt lgkmcnt(4)
  v_mfma_f32_32x32x16_bf16 v[16:31], v[136:139], v[68:71], v[16:31]
  ds_read_b128 v[64:67], v2 offset:16384
  s_waitcnt vmcnt(26)
  s_waitcnt lgkmcnt(4)
  v_mfma_f32_32x32x16_bf16 v[16:31], v[140:143], v[48:51], v[16:31]
  s_add_u32 s60, s59, s19
  s_add_u32 s60, s60, 8192
  buffer_load_dwordx4 v[248:251], v2, s[8:11], s60 offen offset:1024 sc1
  ds_read_b128 v[68:71], v2 offset:17408
  s_waitcnt vmcnt(26)
  s_waitcnt lgkmcnt(4)
  v_mfma_f32_32x32x16_bf16 v[16:31], v[144:147], v[52:55], v[16:31]
  ds_read_b128 v[48:51], v2 offset:18432
  s_waitcnt vmcnt(25)
  s_waitcnt lgkmcnt(4)
  v_mfma_f32_32x32x16_bf16 v[16:31], v[148:151], v[56:59], v[16:31]
  s_add_u32 s60, s59, 40960
  v_and_b32 v0, 31, v1
  v_lshlrev_b32 v0, 2, v0
  v_lshrrev_b32 v252, 5, v1
  v_lshl_add_u32 v0, v252, 9, v0
  buffer_load_dword v252, v0, s[8:11], s60 offen offset:0 sc1
  buffer_load_dword v253, v0, s[8:11], s60 offen offset:128 sc1
  buffer_load_dword v254, v0, s[8:11], s60 offen offset:256 sc1
  buffer_load_dword v255, v0, s[8:11], s60 offen offset:384 sc1
  ds_read_b128 v[52:55], v2 offset:19456
  s_waitcnt vmcnt(28)
  s_waitcnt lgkmcnt(4)
  v_mfma_f32_32x32x16_bf16 v[16:31], v[152:155], v[60:63], v[16:31]
  s_barrier
  ds_read_b128 v[56:59], v2 offset:20480
  s_waitcnt vmcnt(27)
  s_waitcnt lgkmcnt(4)
  v_mfma_f32_32x32x16_bf16 v[16:31], v[156:159], v[64:67], v[16:31]
  ds_read_b128 v[60:63], v2 offset:21504
  s_waitcnt vmcnt(26)
  s_waitcnt lgkmcnt(4)
  v_mfma_f32_32x32x16_bf16 v[16:31], v[160:163], v[68:71], v[16:31]
  ds_read_b128 v[64:67], v2 offset:22528
  s_waitcnt vmcnt(25)
  s_waitcnt lgkmcnt(4)
  v_mfma_f32_32x32x16_bf16 v[16:31], v[164:167], v[48:51], v[16:31]
  ds_read_b128 v[68:71], v2 offset:23552
  s_waitcnt vmcnt(24)
  s_waitcnt lgkmcnt(4)
  v_mfma_f32_32x32x16_bf16 v[16:31], v[168:171], v[52:55], v[16:31]
  ds_read_b128 v[48:51], v2 offset:24576
  s_waitcnt vmcnt(23)
  s_waitcnt lgkmcnt(4)
  v_mfma_f32_32x32x16_bf16 v[16:31], v[172:175], v[56:59], v[16:31]
  ds_read_b128 v[52:55], v2 offset:25600
  s_waitcnt vmcnt(22)
  s_waitcnt lgkmcnt(4)
  v_mfma_f32_32x32x16_bf16 v[16:31], v[176:179], v[60:63], v[16:31]
  ds_read_b128 v[56:59], v2 offset:26624
  s_waitcnt vmcnt(21)
  s_waitcnt lgkmcnt(4)
  v_mfma_f32_32x32x16_bf16 v[16:31], v[180:183], v[64:67], v[16:31]
  ds_read_b128 v[60:63], v2 offset:27648
  s_waitcnt vmcnt(20)
  s_waitcnt lgkmcnt(4)
  v_mfma_f32_32x32x16_bf16 v[16:31], v[184:187], v[68:71], v[16:31]
  ds_read_b128 v[64:67], v2 offset:28672
  s_waitcnt vmcnt(19)
  s_waitcnt lgkmcnt(4)
  v_mfma_f32_32x32x16_bf16 v[16:31], v[188:191], v[48:51], v[16:31]
  ds_read_b128 v[68:71], v2 offset:29696
  s_waitcnt vmcnt(18)
  s_waitcnt lgkmcnt(4)
  v_mfma_f32_32x32x16_bf16 v[16:31], v[192:195], v[52:55], v[16:31]
  s_barrier
  ds_read_b128 v[48:51], v2 offset:30720
  s_waitcnt vmcnt(17)
  s_waitcnt lgkmcnt(4)
  v_mfma_f32_32x32x16_bf16 v[16:31], v[196:199], v[56:59], v[16:31]
  ds_read_b128 v[52:55], v2 offset:31744
  s_waitcnt vmcnt(16)
  s_waitcnt lgkmcnt(4)
  v_mfma_f32_32x32x16_bf16 v[16:31], v[200:203], v[60:63], v[16:31]
  ds_read_b128 v[56:59], v2 offset:32768
  s_waitcnt vmcnt(15)
  s_waitcnt lgkmcnt(4)
  v_mfma_f32_32x32x16_bf16 v[16:31], v[204:207], v[64:67], v[16:31]
  ds_read_b128 v[60:63], v2 offset:33792
  s_waitcnt vmcnt(14)
  s_waitcnt lgkmcnt(4)
  v_mfma_f32_32x32x16_bf16 v[16:31], v[208:211], v[68:71], v[16:31]
  ds_read_b128 v[64:67], v2 offset:34816
  s_waitcnt vmcnt(13)
  s_waitcnt lgkmcnt(4)
  v_mfma_f32_32x32x16_bf16 v[16:31], v[212:215], v[48:51], v[16:31]
  ds_read_b128 v[68:71], v2 offset:35840
  s_waitcnt vmcnt(12)
  s_waitcnt lgkmcnt(4)
  v_mfma_f32_32x32x16_bf16 v[16:31], v[216:219], v[52:55], v[16:31]
  ds_read_b128 v[48:51], v2 offset:36864
  s_waitcnt vmcnt(11)
  s_waitcnt lgkmcnt(4)
  v_mfma_f32_32x32x16_bf16 v[16:31], v[220:223], v[56:59], v[16:31]
  ds_read_b128 v[52:55], v2 offset:37888
  s_waitcnt vmcnt(10)
  s_waitcnt lgkmcnt(4)
  v_mfma_f32_32x32x16_bf16 v[16:31], v[224:227], v[60:63], v[16:31]
  ds_read_b128 v[56:59], v2 offset:38912
  s_waitcnt vmcnt(9)
  s_waitcnt lgkmcnt(4)
  v_mfma_f32_32x32x16_bf16 v[16:31], v[228:231], v[64:67], v[16:31]
  ds_read_b128 v[60:63], v2 offset:39936
  s_waitcnt vmcnt(8)
  s_waitcnt lgkmcnt(4)
  v_mfma_f32_32x32x16_bf16 v[16:31], v[232:235], v[68:71], v[16:31]
  ds_read_b128 v[64:67], v2 offset:51200
  s_waitcnt vmcnt(7)
  s_waitcnt lgkmcnt(4)
  v_mfma_f32_32x32x16_bf16 v[16:31], v[236:239], v[48:51], v[16:31]
  ds_read_b32 v10, v4 offset:53248
  s_barrier
  ds_read_b128 v[68:71], v2 offset:40960
  s_waitcnt vmcnt(6)
  s_waitcnt lgkmcnt(5)
  v_mfma_f32_32x32x16_bf16 v[16:31], v[240:243], v[52:55], v[16:31]
  ds_read_b128 v[48:51], v2 offset:41984
  s_waitcnt vmcnt(5)
  s_waitcnt lgkmcnt(5)
  v_mfma_f32_32x32x16_bf16 v[16:31], v[244:247], v[56:59], v[16:31]
  ds_read_b128 v[52:55], v2 offset:43008
  s_waitcnt vmcnt(4)
  s_waitcnt lgkmcnt(5)
  v_mfma_f32_32x32x16_bf16 v[16:31], v[248:251], v[60:63], v[16:31]
  ds_read_b128 v[56:59], v2 offset:44032
  s_waitcnt vmcnt(0)
  s_waitcnt lgkmcnt(5)
  v_mfma_f32_32x32x16_bf16 v[16:31], v[252:255], v[64:67], v[16:31]
  ds_read_b128 v[60:63], v2 offset:45056
  s_waitcnt lgkmcnt(4)
  v_mfma_f32_32x32x16_bf16 v[32:47], v[92:95], v[68:71], 0
  ds_read_b128 v[64:67], v2 offset:46080
  s_waitcnt lgkmcnt(4)
  v_mfma_f32_32x32x16_bf16 v[32:47], v[96:99], v[48:51], v[32:47]
  ds_read_b128 v[68:71], v2 offset:47104
  s_waitcnt lgkmcnt(4)
  v_mfma_f32_32x32x16_bf16 v[32:47], v[100:103], v[52:55], v[32:47]
  s_add_u32 s60, s97, 0x0
  s_add_u32 m0, s47, 0
  s_nop 0
  buffer_load_dwordx4 v2, s[8:11], s60 offen sc1 lds
  v_mul_f32 v11, 0xbfb8aa3b, v10
  v_mul_f32 v16, v11, v16
  v_mul_f32 v17, v11, v17
  v_mul_f32 v18, v11, v18
  ds_read_b128 v[48:51], v2 offset:48128
  s_waitcnt lgkmcnt(4)
  v_mfma_f32_32x32x16_bf16 v[32:47], v[104:107], v[56:59], v[32:47]
  v_mul_f32 v19, v11, v19
  v_mul_f32 v20, v11, v20
  v_mul_f32 v21, v11, v21
  v_mul_f32 v22, v11, v22
  ds_read_b128 v[52:55], v2 offset:49152
  s_waitcnt lgkmcnt(4)
  v_mfma_f32_32x32x16_bf16 v[32:47], v[108:111], v[60:63], v[32:47]
  v_mul_f32 v23, v11, v23
  v_exp_f32 v16, v16
  v_mul_f32 v24, v10, v24
  v_exp_f32 v17, v17
  ds_read_b128 v[56:59], v2 offset:50176
  s_waitcnt lgkmcnt(4)
  v_mfma_f32_32x32x16_bf16 v[32:47], v[112:115], v[64:67], v[32:47]
  v_mul_f32 v25, v10, v25
  v_exp_f32 v18, v18
  v_mul_f32 v26, v10, v26
  v_exp_f32 v19, v19
  s_barrier
  ds_read_b128 v[60:63], v2 offset:0
  s_waitcnt lgkmcnt(4)
  v_mfma_f32_32x32x16_bf16 v[32:47], v[116:119], v[68:71], v[32:47]
  s_add_u32 s60, s97, 0x400
  s_add_u32 m0, s47, 1024
  s_nop 0
  buffer_load_dwordx4 v2, s[8:11], s60 offen sc1 lds
  v_mul_f32 v27, v10, v27
  v_exp_f32 v20, v20
  v_mul_f32 v28, v10, v28
  v_exp_f32 v21, v21
  ds_read_b128 v[64:67], v2 offset:1024
  s_waitcnt lgkmcnt(4)
  v_mfma_f32_32x32x16_bf16 v[32:47], v[120:123], v[48:51], v[32:47]
  v_mul_f32 v29, v10, v29
  v_exp_f32 v22, v22
  v_mul_f32 v30, v10, v30
  v_exp_f32 v23, v23
  ds_read_b128 v[68:71], v2 offset:2048
  s_waitcnt lgkmcnt(4)
  v_mfma_f32_32x32x16_bf16 v[32:47], v[124:127], v[52:55], v[32:47]
  v_mul_f32 v31, v10, v31
  v_add_f32 v16, 1.0, v16
  v_add_f32 v17, 1.0, v17
  v_add_f32 v18, 1.0, v18
  ds_read_b128 v[48:51], v2 offset:3072
  s_waitcnt lgkmcnt(4)
  v_mfma_f32_32x32x16_bf16 v[32:47], v[128:131], v[56:59], v[32:47]
  v_add_f32 v19, 1.0, v19
  v_add_f32 v20, 1.0, v20
  v_add_f32 v21, 1.0, v21
  v_add_f32 v22, 1.0, v22
  ds_read_b128 v[52:55], v2 offset:4096
  s_waitcnt lgkmcnt(4)
  v_mfma_f32_32x32x16_bf16 v[32:47], v[132:135], v[60:63], v[32:47]
  s_add_u32 s60, s97, 0x800
  s_add_u32 m0, s47, 2048
  s_nop 0
  buffer_load_dwordx4 v2, s[8:11], s60 offen sc1 lds
  v_add_f32 v23, 1.0, v23
  v_rcp_f32 v16, v16
  v_rcp_f32 v17, v17
  v_rcp_f32 v18, v18
  ds_read_b128 v[56:59], v2 offset:5120
  s_waitcnt lgkmcnt(4)
  v_mfma_f32_32x32x16_bf16 v[32:47], v[136:139], v[64:67], v[32:47]
  v_rcp_f32 v19, v19
  v_rcp_f32 v20, v20
  v_rcp_f32 v21, v21
  v_rcp_f32 v22, v22
  ds_read_b128 v[60:63], v2 offset:6144
  s_waitcnt lgkmcnt(4)
  v_mfma_f32_32x32x16_bf16 v[32:47], v[140:143], v[68:71], v[32:47]
  v_rcp_f32 v23, v23
  v_mul_f32 v24, v16, v24
  v_mul_f32 v25, v17, v25
  v_mul_f32 v26, v18, v26
  ds_read_b128 v[64:67], v2 offset:7168
  s_waitcnt lgkmcnt(4)
  v_mfma_f32_32x32x16_bf16 v[32:47], v[144:147], v[48:51], v[32:47]
  v_mul_f32 v27, v19, v27
  v_mul_f32 v28, v20, v28
  v_mul_f32 v29, v21, v29
  v_mul_f32 v30, v22, v30
  ds_read_b128 v[68:71], v2 offset:8192
  s_waitcnt lgkmcnt(4)
  v_mfma_f32_32x32x16_bf16 v[32:47], v[148:151], v[52:55], v[32:47]
  s_add_u32 s60, s97, 0xc00
  s_add_u32 m0, s47, 3072
  s_nop 0
  buffer_load_dwordx4 v2, s[8:11], s60 offen sc1 lds
  v_mul_f32 v31, v23, v31
  v_cvt_pk_bf16_f32 v72, v24, v25
  v_cvt_pk_bf16_f32 v73, v26, v27
  v_cvt_pk_bf16_f32 v74, v28, v29
  ds_read_b128 v[48:51], v2 offset:9216
  s_waitcnt lgkmcnt(4)
  v_mfma_f32_32x32x16_bf16 v[32:47], v[152:155], v[56:59], v[32:47]
  v_cvt_pk_bf16_f32 v75, v30, v31
  s_add_u32 s46, s44, 0x0
  buffer_store_dwordx4 v[72:75], v7, s[8:11], s46 offen sc1
  s_barrier
  ds_read_b128 v[52:55], v2 offset:10240
  s_waitcnt lgkmcnt(4)
  v_mfma_f32_32x32x16_bf16 v[32:47], v[156:159], v[60:63], v[32:47]
  ds_read_b128 v[56:59], v2 offset:11264
  s_waitcnt lgkmcnt(4)
  v_mfma_f32_32x32x16_bf16 v[32:47], v[160:163], v[64:67], v[32:47]
  ds_read_b128 v[60:63], v2 offset:12288
  s_waitcnt lgkmcnt(4)
  v_mfma_f32_32x32x16_bf16 v[32:47], v[164:167], v[68:71], v[32:47]
  s_add_u32 s60, s97, 0x1000
  s_add_u32 m0, s47, 4096
  s_nop 0
  buffer_load_dwordx4 v2, s[8:11], s60 offen sc1 lds
  ds_read_b128 v[64:67], v2 offset:13312
  s_waitcnt lgkmcnt(4)
  v_mfma_f32_32x32x16_bf16 v[32:47], v[168:171], v[48:51], v[32:47]
  ds_read_b128 v[68:71], v2 offset:14336
  s_waitcnt lgkmcnt(4)
  v_mfma_f32_32x32x16_bf16 v[32:47], v[172:175], v[52:55], v[32:47]
  ds_read_b128 v[48:51], v2 offset:15360
  s_waitcnt lgkmcnt(4)
  v_mfma_f32_32x32x16_bf16 v[32:47], v[176:179], v[56:59], v[32:47]
  ds_read_b128 v[52:55], v2 offset:16384
  s_waitcnt lgkmcnt(4)
  v_mfma_f32_32x32x16_bf16 v[32:47], v[180:183], v[60:63], v[32:47]
  s_add_u32 s60, s97, 0x1400
  s_add_u32 m0, s47, 5120
  s_nop 0
  buffer_load_dwordx4 v2, s[8:11], s60 offen sc1 lds
  ds_read_b128 v[56:59], v2 offset:17408
  s_waitcnt lgkmcnt(4)
  v_mfma_f32_32x32x16_bf16 v[32:47], v[184:187], v[64:67], v[32:47]
  ds_read_b128 v[60:63], v2 offset:18432
  s_waitcnt lgkmcnt(4)
  v_mfma_f32_32x32x16_bf16 v[32:47], v[188:191], v[68:71], v[32:47]
  ds_read_b128 v[64:67], v2 offset:19456
  s_waitcnt lgkmcnt(4)
  v_mfma_f32_32x32x16_bf16 v[32:47], v[192:195], v[48:51], v[32:47]
  s_barrier
  ds_read_b128 v[68:71], v2 offset:20480
  s_waitcnt lgkmcnt(4)
  v_mfma_f32_32x32x16_bf16 v[32:47], v[196:199], v[52:55], v[32:47]
  s_add_u32 s60, s97, 0x1800
  s_add_u32 s60, s60, s75
  s_add_u32 m0, s47, 6144
  s_nop 0
  buffer_load_dwordx4 v2, s[8:11], s60 offen sc1 lds
  ds_read_b128 v[48:51], v2 offset:21504
  s_waitcnt lgkmcnt(4)
  v_mfma_f32_32x32x16_bf16 v[32:47], v[200:203], v[56:59], v[32:47]
  ds_read_b128 v[52:55], v2 offset:22528
  s_waitcnt lgkmcnt(4)
  v_mfma_f32_32x32x16_bf16 v[32:47], v[204:207], v[60:63], v[32:47]
  ds_read_b128 v[56:59], v2 offset:23552
  s_waitcnt lgkmcnt(4)
  v_mfma_f32_32x32x16_bf16 v[32:47], v[208:211], v[64:67], v[32:47]
  ds_read_b128 v[60:63], v2 offset:24576
  s_waitcnt lgkmcnt(4)
  v_mfma_f32_32x32x16_bf16 v[32:47], v[212:215], v[68:71], v[32:47]
  s_add_u32 s60, s98, 0x0
  s_add_u32 m0, s47, 7168
  s_nop 0
  buffer_load_dwordx4 v2, s[8:11], s60 offen sc1 lds
  ds_read_b128 v[64:67], v2 offset:25600
  s_waitcnt lgkmcnt(4)
  v_mfma_f32_32x32x16_bf16 v[32:47], v[216:219], v[48:51], v[32:47]
  ds_read_b128 v[68:71], v2 offset:26624
  s_waitcnt lgkmcnt(4)
  v_mfma_f32_32x32x16_bf16 v[32:47], v[220:223], v[52:55], v[32:47]
  ds_read_b128 v[48:51], v2 offset:27648
  s_waitcnt lgkmcnt(4)
  v_mfma_f32_32x32x16_bf16 v[32:47], v[224:227], v[56:59], v[32:47]
  ds_read_b128 v[52:55], v2 offset:28672
  s_waitcnt lgkmcnt(4)
  v_mfma_f32_32x32x16_bf16 v[32:47], v[228:231], v[60:63], v[32:47]
  s_add_u32 s60, s98, 0x400
  s_add_u32 m0, s47, 8192
  s_nop 0
  buffer_load_dwordx4 v2, s[8:11], s60 offen sc1 lds
  ds_read_b128 v[56:59], v2 offset:29696
  s_waitcnt lgkmcnt(4)
  v_mfma_f32_32x32x16_bf16 v[32:47], v[232:235], v[64:67], v[32:47]
  ds_read_b128 v[60:63], v2 offset:52224
  s_waitcnt lgkmcnt(4)
  v_mfma_f32_32x32x16_bf16 v[32:47], v[236:239], v[68:71], v[32:47]
  ds_read_b32 v10, v4 offset:53376
  s_waitcnt vmcnt(5)
  s_barrier
  ds_read_b128 v[64:67], v2 offset:30720
  s_waitcnt lgkmcnt(5)
  v_mfma_f32_32x32x16_bf16 v[32:47], v[240:243], v[48:51], v[32:47]
  ds_read_b128 v[68:71], v2 offset:31744
  s_waitcnt lgkmcnt(5)
  v_mfma_f32_32x32x16_bf16 v[32:47], v[244:247], v[52:55], v[32:47]
  s_add_u32 s60, s98, 0x800
  s_add_u32 m0, s47, 9216
  s_nop 0
  buffer_load_dwordx4 v2, s[8:11], s60 offen sc1 lds
  ds_read_b128 v[48:51], v2 offset:32768
  s_waitcnt lgkmcnt(5)
  v_mfma_f32_32x32x16_bf16 v[32:47], v[248:251], v[56:59], v[32:47]
  ds_read_b128 v[52:55], v2 offset:33792
  s_waitcnt lgkmcnt(5)
  v_mfma_f32_32x32x16_bf16 v[32:47], v[252:255], v[60:63], v[32:47]
  ds_read_b128 v[56:59], v2 offset:34816
  s_waitcnt lgkmcnt(4)
  v_mfma_f32_32x32x16_bf16 v[16:31], v[92:95], v[64:67], 0
  ds_read_b128 v[60:63], v2 offset:35840
  s_waitcnt lgkmcnt(4)
  v_mfma_f32_32x32x16_bf16 v[16:31], v[96:99], v[68:71], v[16:31]
  ds_read_b128 v[64:67], v2 offset:36864
  s_waitcnt lgkmcnt(4)
  v_mfma_f32_32x32x16_bf16 v[16:31], v[100:103], v[48:51], v[16:31]
  s_add_u32 s60, s98, 0xc00
  s_add_u32 m0, s47, 10240
  s_nop 0
  buffer_load_dwordx4 v2, s[8:11], s60 offen sc1 lds
  v_mul_f32 v11, 0xbfb8aa3b, v10
  v_mul_f32 v32, v11, v32
  v_mul_f32 v33, v11, v33
  v_mul_f32 v34, v11, v34
  ds_read_b128 v[68:71], v2 offset:37888
  s_waitcnt lgkmcnt(4)
  v_mfma_f32_32x32x16_bf16 v[16:31], v[104:107], v[52:55], v[16:31]
  v_mul_f32 v35, v11, v35
  v_mul_f32 v36, v11, v36
  v_mul_f32 v37, v11, v37
  v_mul_f32 v38, v11, v38
  ds_read_b128 v[48:51], v2 offset:38912
  s_waitcnt lgkmcnt(4)
  v_mfma_f32_32x32x16_bf16 v[16:31], v[108:111], v[56:59], v[16:31]
  v_mul_f32 v39, v11, v39
  v_exp_f32 v32, v32
  v_mul_f32 v40, v10, v40
  v_exp_f32 v33, v33
  ds_read_b128 v[52:55], v2 offset:39936
  s_waitcnt lgkmcnt(4)
  v_mfma_f32_32x32x16_bf16 v[16:31], v[112:115], v[60:63], v[16:31]
  v_mul_f32 v41, v10, v41
  v_exp_f32 v34, v34
  v_mul_f32 v42, v10, v42
  v_exp_f32 v35, v35
  s_barrier
  ds_read_b128 v[56:59], v2 offset:40960
  s_waitcnt lgkmcnt(4)
  v_mfma_f32_32x32x16_bf16 v[16:31], v[116:119], v[64:67], v[16:31]
  s_add_u32 s60, s98, 0x1000
  s_add_u32 m0, s47, 11264
  s_nop 0
  buffer_load_dwordx4 v2, s[8:11], s60 offen sc1 lds
  v_mul_f32 v43, v10, v43
  v_exp_f32 v36, v36
  v_mul_f32 v44, v10, v44
  v_exp_f32 v37, v37
  ds_read_b128 v[60:63], v2 offset:41984
  s_waitcnt lgkmcnt(4)
  v_mfma_f32_32x32x16_bf16 v[16:31], v[120:123], v[68:71], v[16:31]
  v_mul_f32 v45, v10, v45
  v_exp_f32 v38, v38
  v_mul_f32 v46, v10, v46
  v_exp_f32 v39, v39
  ds_read_b128 v[64:67], v2 offset:43008
  s_waitcnt lgkmcnt(4)
  v_mfma_f32_32x32x16_bf16 v[16:31], v[124:127], v[48:51], v[16:31]
  v_mul_f32 v47, v10, v47
  v_add_f32 v32, 1.0, v32
  v_add_f32 v33, 1.0, v33
  v_add_f32 v34, 1.0, v34
  ds_read_b128 v[68:71], v2 offset:44032
  s_waitcnt lgkmcnt(4)
  v_mfma_f32_32x32x16_bf16 v[16:31], v[128:131], v[52:55], v[16:31]
  v_add_f32 v35, 1.0, v35
  v_add_f32 v36, 1.0, v36
  v_add_f32 v37, 1.0, v37
  v_add_f32 v38, 1.0, v38
  ds_read_b128 v[48:51], v2 offset:45056
  s_waitcnt lgkmcnt(4)
  v_mfma_f32_32x32x16_bf16 v[16:31], v[132:135], v[56:59], v[16:31]
  s_add_u32 s60, s98, 0x1400
  s_add_u32 m0, s47, 12288
  s_nop 0
  buffer_load_dwordx4 v2, s[8:11], s60 offen sc1 lds
  v_add_f32 v39, 1.0, v39
  v_rcp_f32 v32, v32
  v_rcp_f32 v33, v33
  v_rcp_f32 v34, v34
  ds_read_b128 v[52:55], v2 offset:46080
  s_waitcnt lgkmcnt(4)
  v_mfma_f32_32x32x16_bf16 v[16:31], v[136:139], v[60:63], v[16:31]
  v_rcp_f32 v35, v35
  v_rcp_f32 v36, v36
  v_rcp_f32 v37, v37
  v_rcp_f32 v38, v38
  ds_read_b128 v[56:59], v2 offset:47104
  s_waitcnt lgkmcnt(4)
  v_mfma_f32_32x32x16_bf16 v[16:31], v[140:143], v[64:67], v[16:31]
  v_rcp_f32 v39, v39
  v_mul_f32 v40, v32, v40
  v_mul_f32 v41, v33, v41
  v_mul_f32 v42, v34, v42
  ds_read_b128 v[60:63], v2 offset:48128
  s_waitcnt lgkmcnt(4)
  v_mfma_f32_32x32x16_bf16 v[16:31], v[144:147], v[68:71], v[16:31]
  v_mul_f32 v43, v35, v43
  v_mul_f32 v44, v36, v44
  v_mul_f32 v45, v37, v45
  v_mul_f32 v46, v38, v46
  ds_read_b128 v[64:67], v2 offset:49152
  s_waitcnt lgkmcnt(4)
  v_mfma_f32_32x32x16_bf16 v[16:31], v[148:151], v[48:51], v[16:31]
  s_add_u32 s60, s98, 0x1800
  s_add_u32 s60, s60, s75
  s_add_u32 m0, s47, 13312
  s_nop 0
  buffer_load_dwordx4 v2, s[8:11], s60 offen sc1 lds
  v_mul_f32 v47, v39, v47
  v_cvt_pk_bf16_f32 v72, v40, v41
  v_cvt_pk_bf16_f32 v73, v42, v43
  v_cvt_pk_bf16_f32 v74, v44, v45
  ds_read_b128 v[68:71], v2 offset:50176
  s_waitcnt lgkmcnt(4)
  v_mfma_f32_32x32x16_bf16 v[16:31], v[152:155], v[52:55], v[16:31]
  v_cvt_pk_bf16_f32 v75, v46, v47
  s_add_u32 s46, s44, 0x1b000
  buffer_store_dwordx4 v[72:75], v7, s[8:11], s46 offen sc1
  s_barrier
  ds_read_b128 v[48:51], v2 offset:0
  s_waitcnt lgkmcnt(4)
  v_mfma_f32_32x32x16_bf16 v[16:31], v[156:159], v[56:59], v[16:31]
  ds_read_b128 v[52:55], v2 offset:1024
  s_waitcnt lgkmcnt(4)
  v_mfma_f32_32x32x16_bf16 v[16:31], v[160:163], v[60:63], v[16:31]
  ds_read_b128 v[56:59], v2 offset:2048
  s_waitcnt lgkmcnt(4)
  v_mfma_f32_32x32x16_bf16 v[16:31], v[164:167], v[64:67], v[16:31]
  s_add_u32 s60, s99, 0x0
  s_add_u32 m0, s47, 14336
  s_nop 0
  buffer_load_dwordx4 v2, s[8:11], s60 offen sc1 lds
  ds_read_b128 v[60:63], v2 offset:3072
  s_waitcnt lgkmcnt(4)
  v_mfma_f32_32x32x16_bf16 v[16:31], v[168:171], v[68:71], v[16:31]
  ds_read_b128 v[64:67], v2 offset:4096
  s_waitcnt lgkmcnt(4)
  v_mfma_f32_32x32x16_bf16 v[16:31], v[172:175], v[48:51], v[16:31]
  ds_read_b128 v[68:71], v2 offset:5120
  s_waitcnt lgkmcnt(4)
  v_mfma_f32_32x32x16_bf16 v[16:31], v[176:179], v[52:55], v[16:31]
  ds_read_b128 v[48:51], v2 offset:6144
  s_waitcnt lgkmcnt(4)
  v_mfma_f32_32x32x16_bf16 v[16:31], v[180:183], v[56:59], v[16:31]
  s_add_u32 s60, s99, 0x400
  buffer_load_dwordx4 v[76:79], v2, s[8:11], s60 offen sc1
  ds_read_b128 v[52:55], v2 offset:7168
  s_waitcnt lgkmcnt(4)
  v_mfma_f32_32x32x16_bf16 v[16:31], v[184:187], v[60:63], v[16:31]
  ds_read_b128 v[56:59], v2 offset:8192
  s_waitcnt lgkmcnt(4)
  v_mfma_f32_32x32x16_bf16 v[16:31], v[188:191], v[64:67], v[16:31]
  ds_read_b128 v[60:63], v2 offset:9216
  s_waitcnt lgkmcnt(4)
  v_mfma_f32_32x32x16_bf16 v[16:31], v[192:195], v[68:71], v[16:31]
  s_barrier
  ds_read_b128 v[64:67], v2 offset:10240
  s_waitcnt lgkmcnt(4)
  v_mfma_f32_32x32x16_bf16 v[16:31], v[196:199], v[48:51], v[16:31]
  s_add_u32 s60, s99, 0x800
  buffer_load_dwordx4 v[80:83], v2, s[8:11], s60 offen sc1
  ds_read_b128 v[68:71], v2 offset:11264
  s_waitcnt lgkmcnt(4)
  v_mfma_f32_32x32x16_bf16 v[16:31], v[200:203], v[52:55], v[16:31]
  ds_read_b128 v[48:51], v2 offset:12288
  s_waitcnt lgkmcnt(4)
  v_mfma_f32_32x32x16_bf16 v[16:31], v[204:207], v[56:59], v[16:31]
  ds_read_b128 v[52:55], v2 offset:13312
  s_waitcnt lgkmcnt(4)
  v_mfma_f32_32x32x16_bf16 v[16:31], v[208:211], v[60:63], v[16:31]
  ds_read_b128 v[56:59], v2 offset:14336
  s_waitcnt lgkmcnt(4)
  v_mfma_f32_32x32x16_bf16 v[16:31], v[212:215], v[64:67], v[16:31]
  s_add_u32 s60, s99, 0xc00
  buffer_load_dwordx4 v[84:87], v2, s[8:11], s60 offen sc1
  ds_read_b128 v[60:63], v2 offset:15360
  s_waitcnt lgkmcnt(4)
  v_mfma_f32_32x32x16_bf16 v[16:31], v[216:219], v[68:71], v[16:31]
  ds_read_b128 v[64:67], v2 offset:16384
  s_waitcnt lgkmcnt(4)
  v_mfma_f32_32x32x16_bf16 v[16:31], v[220:223], v[48:51], v[16:31]
  ds_read_b128 v[68:71], v2 offset:17408
  s_waitcnt lgkmcnt(4)
  v_mfma_f32_32x32x16_bf16 v[16:31], v[224:227], v[52:55], v[16:31]
  ds_read_b128 v[48:51], v2 offset:18432
  s_waitcnt lgkmcnt(4)
  v_mfma_f32_32x32x16_bf16 v[16:31], v[228:231], v[56:59], v[16:31]
  s_add_u32 s60, s99, 0x1000
  buffer_load_dwordx4 v[88:91], v2, s[8:11], s60 offen sc1
  ds_read_b128 v[52:55], v2 offset:19456
  s_waitcnt lgkmcnt(4)
  v_mfma_f32_32x32x16_bf16 v[16:31], v[232:235], v[60:63], v[16:31]
  ds_read_b128 v[56:59], v2 offset:51200
  s_waitcnt lgkmcnt(4)
  v_mfma_f32_32x32x16_bf16 v[16:31], v[236:239], v[64:67], v[16:31]
  ds_read_b32 v10, v4 offset:53504
  s_waitcnt vmcnt(5)
  s_barrier
  ds_read_b128 v[60:63], v2 offset:20480
  s_waitcnt lgkmcnt(5)
  v_mfma_f32_32x32x16_bf16 v[16:31], v[240:243], v[68:71], v[16:31]
  ds_read_b128 v[64:67], v2 offset:21504
  s_waitcnt lgkmcnt(5)
  v_mfma_f32_32x32x16_bf16 v[16:31], v[244:247], v[48:51], v[16:31]
  ds_read_b128 v[68:71], v2 offset:22528
  s_waitcnt lgkmcnt(5)
  v_mfma_f32_32x32x16_bf16 v[16:31], v[248:251], v[52:55], v[16:31]
  ds_read_b128 v[48:51], v2 offset:23552
  s_waitcnt lgkmcnt(5)
  v_mfma_f32_32x32x16_bf16 v[16:31], v[252:255], v[56:59], v[16:31]
  ds_read_b128 v[52:55], v2 offset:24576
  s_waitcnt lgkmcnt(4)
  v_mfma_f32_32x32x16_bf16 v[32:47], v[92:95], v[60:63], 0
  ds_read_b128 v[56:59], v2 offset:25600
  s_waitcnt lgkmcnt(4)
  v_mfma_f32_32x32x16_bf16 v[32:47], v[96:99], v[64:67], v[32:47]
  s_add_u32 s60, s99, 0x1400
  buffer_load_dwordx4 v[92:95], v2, s[8:11], s60 offen sc1
  ds_read_b128 v[60:63], v2 offset:26624
  s_waitcnt lgkmcnt(4)
  v_mfma_f32_32x32x16_bf16 v[32:47], v[100:103], v[68:71], v[32:47]
  v_mul_f32 v11, 0xbfb8aa3b, v10
  v_mul_f32 v16, v11, v16
  v_mul_f32 v17, v11, v17
  v_mul_f32 v18, v11, v18
  ds_read_b128 v[64:67], v2 offset:27648
  s_waitcnt lgkmcnt(4)
  v_mfma_f32_32x32x16_bf16 v[32:47], v[104:107], v[48:51], v[32:47]
  v_mul_f32 v19, v11, v19
  v_mul_f32 v20, v11, v20
  v_mul_f32 v21, v11, v21
  v_mul_f32 v22, v11, v22
  ds_read_b128 v[68:71], v2 offset:28672
  s_waitcnt lgkmcnt(4)
  v_mfma_f32_32x32x16_bf16 v[32:47], v[108:111], v[52:55], v[32:47]
  s_add_u32 s60, s99, 0x1800
  s_add_u32 s60, s60, s75
  buffer_load_dwordx4 v[96:99], v2, s[8:11], s60 offen sc1
  v_mul_f32 v23, v11, v23
  v_exp_f32 v16, v16
  v_mul_f32 v24, v10, v24
  v_exp_f32 v17, v17
  ds_read_b128 v[48:51], v2 offset:29696
  s_waitcnt lgkmcnt(4)
  v_mfma_f32_32x32x16_bf16 v[32:47], v[112:115], v[56:59], v[32:47]
  v_mul_f32 v25, v10, v25
  v_exp_f32 v18, v18
  v_mul_f32 v26, v10, v26
  v_exp_f32 v19, v19
  s_barrier
  ds_read_b128 v[52:55], v2 offset:30720
  s_waitcnt lgkmcnt(4)
  v_mfma_f32_32x32x16_bf16 v[32:47], v[116:119], v[60:63], v[32:47]
  v_mul_f32 v27, v10, v27
  v_exp_f32 v20, v20
  v_mul_f32 v28, v10, v28
  v_exp_f32 v21, v21
  ds_read_b128 v[56:59], v2 offset:31744
  s_waitcnt lgkmcnt(4)
  v_mfma_f32_32x32x16_bf16 v[32:47], v[120:123], v[64:67], v[32:47]
  s_add_u32 s60, s100, 0x0
  buffer_load_dwordx4 v[100:103], v2, s[8:11], s60 offen sc1
  v_mul_f32 v29, v10, v29
  v_exp_f32 v22, v22
  v_mul_f32 v30, v10, v30
  v_exp_f32 v23, v23
  ds_read_b128 v[60:63], v2 offset:32768
  s_waitcnt lgkmcnt(4)
  v_mfma_f32_32x32x16_bf16 v[32:47], v[124:127], v[68:71], v[32:47]
  v_mul_f32 v31, v10, v31
  v_add_f32 v16, 1.0, v16
  v_add_f32 v17, 1.0, v17
  v_add_f32 v18, 1.0, v18
  ds_read_b128 v[64:67], v2 offset:33792
  s_waitcnt lgkmcnt(4)
  v_mfma_f32_32x32x16_bf16 v[32:47], v[128:131], v[48:51], v[32:47]
  v_add_f32 v19, 1.0, v19
  v_add_f32 v20, 1.0, v20
  v_add_f32 v21, 1.0, v21
  v_add_f32 v22, 1.0, v22
  ds_read_b128 v[68:71], v2 offset:34816
  s_waitcnt lgkmcnt(4)
  v_mfma_f32_32x32x16_bf16 v[32:47], v[132:135], v[52:55], v[32:47]
  s_add_u32 s60, s100, 0x400
  buffer_load_dwordx4 v[104:107], v2, s[8:11], s60 offen sc1
  v_add_f32 v23, 1.0, v23
  v_rcp_f32 v16, v16
  v_rcp_f32 v17, v17
  v_rcp_f32 v18, v18
  ds_read_b128 v[48:51], v2 offset:35840
  s_waitcnt lgkmcnt(4)
  v_mfma_f32_32x32x16_bf16 v[32:47], v[136:139], v[56:59], v[32:47]
  v_rcp_f32 v19, v19
  v_rcp_f32 v20, v20
  v_rcp_f32 v21, v21
  v_rcp_f32 v22, v22
  ds_read_b128 v[52:55], v2 offset:36864
  s_waitcnt lgkmcnt(4)
  v_mfma_f32_32x32x16_bf16 v[32:47], v[140:143], v[60:63], v[32:47]
  v_rcp_f32 v23, v23
  v_mul_f32 v24, v16, v24
  v_mul_f32 v25, v17, v25
  v_mul_f32 v26, v18, v26
  ds_read_b128 v[56:59], v2 offset:37888
  s_waitcnt lgkmcnt(4)
  v_mfma_f32_32x32x16_bf16 v[32:47], v[144:147], v[64:67], v[32:47]
  s_add_u32 s60, s100, 0x800
  buffer_load_dwordx4 v[108:111], v2, s[8:11], s60 offen sc1
  v_mul_f32 v27, v19, v27
  v_mul_f32 v28, v20, v28
  v_mul_f32 v29, v21, v29
  v_mul_f32 v30, v22, v30
  ds_read_b128 v[60:63], v2 offset:38912
  s_waitcnt lgkmcnt(4)
  v_mfma_f32_32x32x16_bf16 v[32:47], v[148:151], v[68:71], v[32:47]
  v_mul_f32 v31, v23, v31
  v_cvt_pk_bf16_f32 v72, v24, v25
  v_cvt_pk_bf16_f32 v73, v26, v27
  v_cvt_pk_bf16_f32 v74, v28, v29
  ds_read_b128 v[64:67], v2 offset:39936
  s_waitcnt lgkmcnt(4)
  v_mfma_f32_32x32x16_bf16 v[32:47], v[152:155], v[48:51], v[32:47]
  v_cvt_pk_bf16_f32 v75, v30, v31
  s_add_u32 s46, s44, 0x36000
  buffer_store_dwordx4 v[72:75], v7, s[8:11], s46 offen sc1
  s_barrier
  ds_read_b128 v[68:71], v2 offset:40960
  s_waitcnt lgkmcnt(4)
  v_mfma_f32_32x32x16_bf16 v[32:47], v[156:159], v[52:55], v[32:47]
  s_add_u32 s60, s100, 0xc00
  buffer_load_dwordx4 v[112:115], v2, s[8:11], s60 offen sc1
  ds_read_b128 v[48:51], v2 offset:41984
  s_waitcnt lgkmcnt(4)
  v_mfma_f32_32x32x16_bf16 v[32:47], v[160:163], v[56:59], v[32:47]
  s_waitcnt vmcnt(11)
  ds_read_b128 v[156:159], v3 offset:0
  ds_read_b128 v[52:55], v2 offset:43008
  s_waitcnt lgkmcnt(5)
  v_mfma_f32_32x32x16_bf16 v[32:47], v[164:167], v[60:63], v[32:47]
  ds_read_b128 v[160:163], v3 offset:1024
  ds_read_b128 v[56:59], v2 offset:44032
  s_waitcnt lgkmcnt(6)
  v_mfma_f32_32x32x16_bf16 v[32:47], v[168:171], v[64:67], v[32:47]
  s_add_u32 s60, s100, 0x1000
  buffer_load_dwordx4 v[116:119], v2, s[8:11], s60 offen sc1
  ds_read_b128 v[164:167], v3 offset:2048
  ds_read_b128 v[60:63], v2 offset:45056
  s_waitcnt lgkmcnt(7)
  v_mfma_f32_32x32x16_bf16 v[32:47], v[172:175], v[68:71], v[32:47]
  ds_read_b128 v[168:171], v3 offset:3072
  ds_read_b128 v[64:67], v2 offset:46080
  s_waitcnt lgkmcnt(8)
  v_mfma_f32_32x32x16_bf16 v[32:47], v[176:179], v[48:51], v[32:47]
  ds_read_b128 v[172:175], v3 offset:4096
  ds_read_b128 v[68:71], v2 offset:47104
  s_waitcnt lgkmcnt(8)
  v_mfma_f32_32x32x16_bf16 v[32:47], v[180:183], v[52:55], v[32:47]
  s_add_u32 s60, s100, 0x1400
  buffer_load_dwordx4 v[120:123], v2, s[8:11], s60 offen sc1
  ds_read_b128 v[176:179], v3 offset:5120
  v_lshlrev_b32 v14, 7, v1
  s_lshl_b32 s48, s26, 1
  s_lshl_b32 s48, 0x30003, s48
  s_mov_b32 s49, 0
  s_mov_b64 exec, s[48:49]
  buffer_load_dword v15, v14, s[8:11], s78 offen offset:0 sc1
  s_mov_b64 exec, -1
  ds_read_b128 v[48:51], v2 offset:48128
  s_waitcnt lgkmcnt(8)
  v_mfma_f32_32x32x16_bf16 v[32:47], v[184:187], v[56:59], v[32:47]
  ds_read_b128 v[180:183], v3 offset:6144
  ds_read_b128 v[52:55], v2 offset:49152
  s_waitcnt lgkmcnt(8)
  v_mfma_f32_32x32x16_bf16 v[32:47], v[188:191], v[60:63], v[32:47]
  ds_read_b128 v[184:187], v3 offset:7168
  ds_read_b128 v[56:59], v2 offset:50176
  s_waitcnt lgkmcnt(8)
  v_mfma_f32_32x32x16_bf16 v[32:47], v[192:195], v[64:67], v[32:47]
  s_add_u32 s60, s100, 0x1800
  s_add_u32 s60, s60, s75
  buffer_load_dwordx4 v[124:127], v2, s[8:11], s60 offen sc1
  ds_read_b128 v[188:191], v3 offset:8192
  s_barrier
  ds_read_b128 v[60:63], v2 offset:0
  s_waitcnt lgkmcnt(8)
  v_mfma_f32_32x32x16_bf16 v[32:47], v[196:199], v[68:71], v[32:47]
  s_setprio 2
  ds_read_b128 v[192:195], v3 offset:9216
  ds_read_b128 v[64:67], v2 offset:1024
  s_waitcnt lgkmcnt(8)
  v_mfma_f32_32x32x16_bf16 v[32:47], v[200:203], v[48:51], v[32:47]
  ds_read_b128 v[196:199], v3 offset:10240
  ds_read_b128 v[68:71], v2 offset:2048
  s_waitcnt lgkmcnt(8)
  v_mfma_f32_32x32x16_bf16 v[32:47], v[204:207], v[52:55], v[32:47]
  s_add_u32 s60, s101, 0x0
  buffer_load_dwordx4 v[128:131], v2, s[8:11], s60 offen sc1
  ds_read_b128 v[200:203], v3 offset:11264
  ds_read_b128 v[48:51], v2 offset:3072
  s_waitcnt lgkmcnt(8)
  v_mfma_f32_32x32x16_bf16 v[32:47], v[208:211], v[56:59], v[32:47]
  ds_read_b128 v[204:207], v3 offset:12288
  ds_read_b128 v[52:55], v2 offset:4096
  s_waitcnt lgkmcnt(8)
  v_mfma_f32_32x32x16_bf16 v[32:47], v[212:215], v[60:63], v[32:47]
  ds_read_b128 v[208:211], v3 offset:13312
  ds_read_b128 v[56:59], v2 offset:5120
  s_waitcnt lgkmcnt(8)
  v_mfma_f32_32x32x16_bf16 v[32:47], v[216:219], v[64:67], v[32:47]
  s_add_u32 s60, s101, 0x400
  buffer_load_dwordx4 v[132:135], v2, s[8:11], s60 offen sc1
  ds_read_b128 v[212:215], v3 offset:14336
  ds_read_b128 v[60:63], v2 offset:6144
  s_waitcnt lgkmcnt(8)
  v_mfma_f32_32x32x16_bf16 v[32:47], v[220:223], v[68:71], v[32:47]
  s_mov_b64 exec, s[48:49]
  s_waitcnt vmcnt(3)
  v_cmp_ne_u32 vcc, s27, v15
  s_nop 4
  s_cbranch_vccz Lchk12x
  s_mov_b32 s28, 0
Lchk12:
  s_sleep 1
  buffer_load_dword v15, v14, s[8:11], s78 offen offset:0 sc1
  s_add_u32 s28, s28, 1
  s_waitcnt vmcnt(0)
  s_cmp_gt_u32 s28, 1000000
  s_cbranch_scc1 Lchk12x
  v_cmp_ne_u32 vcc, s27, v15
  s_nop 4
  s_cbranch_vccnz Lchk12
Lchk12x:
  s_mov_b64 exec, -1
  ds_read_b128 v[64:67], v2 offset:7168
  s_waitcnt lgkmcnt(7)
  v_mfma_f32_32x32x16_bf16 v[32:47], v[224:227], v[48:51], v[32:47]
  s_add_u32 s61, s42, 0x0
  buffer_load_dwordx4 v[216:219], v2, s[8:11], s61 offen sc1
  ds_read_b128 v[68:71], v2 offset:8192
  s_waitcnt lgkmcnt(6)
  v_mfma_f32_32x32x16_bf16 v[32:47], v[228:231], v[52:55], v[32:47]
  s_add_u32 s60, s101, 0x800
  buffer_load_dwordx4 v[136:139], v2, s[8:11], s60 offen sc1
  v_mov_b32 v14, 0xd204
  v_mov_b32 v15, 1
  s_mov_b64 exec, 1
  ds_add_rtn_u32 v15, v14, v15
  s_mov_b64 exec, -1
  ds_read_b128 v[48:51], v2 offset:9216
  s_waitcnt lgkmcnt(6)
  v_mfma_f32_32x32x16_bf16 v[32:47], v[232:235], v[56:59], v[32:47]
  s_add_u32 s61, s42, 0x400
  buffer_load_dwordx4 v[220:223], v2, s[8:11], s61 offen sc1
  ds_read_b128 v[52:55], v2 offset:52224
  s_waitcnt lgkmcnt(5)
  v_mfma_f32_32x32x16_bf16 v[32:47], v[236:239], v[60:63], v[32:47]
  ds_read_b32 v10, v4 offset:53632
  s_waitcnt lgkmcnt(5)
  v_mfma_f32_32x32x16_bf16 v[32:47], v[240:243], v[64:67], v[32:47]
  s_add_u32 s60, s101, 0xc00
  buffer_load_dwordx4 v[140:143], v2, s[8:11], s60 offen sc1
  s_add_u32 s61, s42, 0x800
  buffer_load_dwordx4 v[224:227], v2, s[8:11], s61 offen sc1
  s_waitcnt lgkmcnt(4)
  v_mfma_f32_32x32x16_bf16 v[32:47], v[244:247], v[68:71], v[32:47]
  s_waitcnt lgkmcnt(3)
  v_readfirstlane_b32 s61, v15
  s_add_u32 s29, s77, 4096
  s_cmp_eq_u32 s61, 6
  s_cselect_b32 s29, s29, 0x7f000000
  s_mov_b64 exec, 1
  buffer_store_dword v13, v12, s[8:11], s29 offen offset:0 sc1
  s_mov_b64 exec, -1
  s_waitcnt lgkmcnt(2)
  v_mfma_f32_32x32x16_bf16 v[32:47], v[248:251], v[48:51], v[32:47]
  s_add_u32 s61, s42, 0xc00
  buffer_load_dwordx4 v[228:231], v2, s[8:11], s61 offen sc1
  s_waitcnt lgkmcnt(1)
  v_mfma_f32_32x32x16_bf16 v[32:47], v[252:255], v[52:55], v[32:47]
  s_add_u32 s60, s101, 0x1000
  buffer_load_dwordx4 v[144:147], v2, s[8:11], s60 offen sc1
  s_add_u32 s61, s42, 0x1000
  buffer_load_dwordx4 v[48:51], v2, s[8:11], s61 offen sc1
  s_add_u32 s61, s42, 0x1400
  buffer_load_dwordx4 v[52:55], v2, s[8:11], s61 offen sc1
  s_add_u32 s61, s42, 0x1800
  s_add_u32 s61, s61, s75
  buffer_load_dwordx4 v[56:59], v2, s[8:11], s61 offen sc1
  s_waitcnt lgkmcnt(0)
  v_mul_f32 v11, 0xbfb8aa3b, v10
  s_nop 0
  v_mul_f32 v32, v11, v32
  v_mul_f32 v33, v11, v33
  v_mul_f32 v34, v11, v34
  v_mul_f32 v35, v11, v35
  v_mul_f32 v36, v11, v36
  v_mul_f32 v37, v11, v37
  v_mul_f32 v38, v11, v38
  v_mul_f32 v39, v11, v39
  v_exp_f32 v32, v32
  v_mul_f32 v40, v10, v40
  v_exp_f32 v33, v33
  v_mul_f32 v41, v10, v41
  v_exp_f32 v34, v34
  v_mul_f32 v42, v10, v42
  v_exp_f32 v35, v35
  v_mul_f32 v43, v10, v43
  v_exp_f32 v36, v36
  v_mul_f32 v44, v10, v44
  v_exp_f32 v37, v37
  v_mul_f32 v45, v10, v45
  v_exp_f32 v38, v38
  v_mul_f32 v46, v10, v46
  v_exp_f32 v39, v39
  v_mul_f32 v47, v10, v47
  v_add_f32 v32, 1.0, v32
  v_add_f32 v33, 1.0, v33
  v_add_f32 v34, 1.0, v34
  v_add_f32 v35, 1.0, v35
  v_add_f32 v36, 1.0, v36
  v_add_f32 v37, 1.0, v37
  v_add_f32 v38, 1.0, v38
  v_add_f32 v39, 1.0, v39
  v_rcp_f32 v32, v32
  v_rcp_f32 v33, v33
  v_rcp_f32 v34, v34
  v_rcp_f32 v35, v35
  v_rcp_f32 v36, v36
  v_rcp_f32 v37, v37
  v_rcp_f32 v38, v38
  v_rcp_f32 v39, v39
  v_mul_f32 v40, v32, v40
  v_mul_f32 v41, v33, v41
  v_mul_f32 v42, v34, v42
  v_mul_f32 v43, v35, v43
  v_mul_f32 v44, v36, v44
  v_mul_f32 v45, v37, v45
  v_mul_f32 v46, v38, v46
  v_mul_f32 v47, v39, v47
  v_cvt_pk_bf16_f32 v72, v40, v41
  v_cvt_pk_bf16_f32 v73, v42, v43
  v_cvt_pk_bf16_f32 v74, v44, v45
  v_cvt_pk_bf16_f32 v75, v46, v47
  s_add_u32 s46, s44, 0x51000
  buffer_store_dwordx4 v[72:75], v7, s[8:11], s46 offen sc1
  s_setprio 0
  v_lshlrev_b32 v3, 7, v1
  s_lshl_b32 s49, s26, 1
  s_lshl_b32 s49, 3, s49
  s_cmp_eq_u32 s26, 7
  s_cselect_b32 s49, 0xe000, s49
  s_lshl_b32 s51, s49, 16
  s_mov_b32 s48, 0
  s_mov_b32 s50, 0
  buffer_load_dwordx2 v[252:253], v6, s[8:11], s30 offen sc1
  s_waitcnt vmcnt(12)
  v_mfma_f32_16x16x32_bf16 v[232:235], v[156:159], v[216:219], 0
  s_waitcnt vmcnt(10)
  v_mfma_f32_16x16x32_bf16 v[232:235], v[160:163], v[220:223], v[232:235]
  s_add_u32 s60, s101, 0x1400
  buffer_load_dwordx4 v[148:151], v2, s[8:11], s60 offen sc1
  s_waitcnt vmcnt(9)
  v_mfma_f32_16x16x32_bf16 v[232:235], v[164:167], v[224:227], v[232:235]
  s_waitcnt vmcnt(7)
  v_mfma_f32_16x16x32_bf16 v[232:235], v[168:171], v[228:231], v[232:235]
  s_add_u32 s60, s101, 0x1800
  s_add_u32 s60, s60, s75
  buffer_load_dwordx4 v[152:155], v2, s[8:11], s60 offen sc1
  s_waitcnt vmcnt(6)
  v_mfma_f32_16x16x32_bf16 v[232:235], v[172:175], v[48:51], v[232:235]
  s_waitcnt vmcnt(5)
  v_mfma_f32_16x16x32_bf16 v[232:235], v[176:179], v[52:55], v[232:235]
  s_add_u32 s61, s42, 0x1b000
  buffer_load_dwordx4 v[60:63], v2, s[8:11], s61 offen sc1
  s_waitcnt vmcnt(5)
  v_mfma_f32_16x16x32_bf16 v[232:235], v[180:183], v[56:59], v[232:235]
  s_waitcnt vmcnt(4)
  v_mov_b32 v10, 0xd200
  v_mov_b32 v11, 1
  s_mov_b64 exec, 1
  ds_add_rtn_u32 v14, v10, v11
  s_waitcnt lgkmcnt(0)
  v_readfirstlane_b32 s61, v14
  s_nop 1
  s_cmp_eq_u32 s61, 6
  s_cbranch_scc0 LE_nf
  s_add_u32 s29, s77, 6144
  buffer_store_dword v13, v12, s[8:11], s29 offen sc1
LE_nf:
  s_mov_b64 exec, -1
  v_mfma_f32_16x16x32_bf16 v[236:239], v[184:187], v[216:219], 0
  s_add_u32 s61, s42, 0x1b400
  buffer_load_dwordx4 v[64:67], v2, s[8:11], s61 offen sc1
  v_mfma_f32_16x16x32_bf16 v[236:239], v[188:191], v[220:223], v[236:239]
  v_mfma_f32_16x16x32_bf16 v[236:239], v[192:195], v[224:227], v[236:239]
  s_add_u32 s61, s42, 0x1b800
  buffer_load_dwordx4 v[68:71], v2, s[8:11], s61 offen sc1
  v_mfma_f32_16x16x32_bf16 v[236:239], v[196:199], v[228:231], v[236:239]
  v_mfma_f32_16x16x32_bf16 v[236:239], v[200:203], v[48:51], v[236:239]
  s_add_u32 s61, s42, 0x1bc00
  buffer_load_dwordx4 v[16:19], v2, s[8:11], s61 offen sc1
  v_mfma_f32_16x16x32_bf16 v[236:239], v[204:207], v[52:55], v[236:239]
  v_mfma_f32_16x16x32_bf16 v[236:239], v[208:211], v[56:59], v[236:239]
  s_add_u32 s61, s42, 0x1c000
  buffer_load_dwordx4 v[20:23], v2, s[8:11], s61 offen sc1
  s_barrier
  v_xor_b32 v4, 0x0, v8
  ds_write_b128 v4, v[232:235] offset:0
  v_mfma_f32_16x16x32_bf16 v[240:243], v[212:215], v[216:219], 0
  v_mfma_f32_16x16x32_bf16 v[240:243], v[76:79], v[220:223], v[240:243]
  s_add_u32 s61, s42, 0x1c400
  buffer_load_dwordx4 v[24:27], v2, s[8:11], s61 offen sc1
  v_mfma_f32_16x16x32_bf16 v[240:243], v[80:83], v[224:227], v[240:243]
  v_mfma_f32_16x16x32_bf16 v[240:243], v[84:87], v[228:231], v[240:243]
  v_xor_b32 v4, 0x40, v8
  ds_write_b128 v4, v[236:239] offset:8192
  s_add_u32 s61, s42, 0x1c800
  s_add_u32 s61, s61, s75
  buffer_load_dwordx4 v[28:31], v2, s[8:11], s61 offen sc1
  v_mfma_f32_16x16x32_bf16 v[240:243], v[88:91], v[48:51], v[240:243]
  v_mfma_f32_16x16x32_bf16 v[240:243], v[92:95], v[52:55], v[240:243]
  v_mfma_f32_16x16x32_bf16 v[240:243], v[96:99], v[56:59], v[240:243]
  s_mov_b64 exec, s[48:49]
  buffer_load_dword v7, v3, s[8:11], s78 offen offset:0 sc1
  s_mov_b64 exec, -1
  v_mfma_f32_16x16x32_bf16 v[232:235], v[100:103], v[216:219], 0
  v_mfma_f32_16x16x32_bf16 v[232:235], v[104:107], v[220:223], v[232:235]
  v_mfma_f32_16x16x32_bf16 v[232:235], v[108:111], v[224:227], v[232:235]
  v_mfma_f32_16x16x32_bf16 v[232:235], v[112:115], v[228:231], v[232:235]
  v_xor_b32 v4, 0x80, v8
  ds_write_b128 v4, v[240:243] offset:16384
  v_mfma_f32_16x16x32_bf16 v[232:235], v[116:119], v[48:51], v[232:235]
  v_mfma_f32_16x16x32_bf16 v[232:235], v[120:123], v[52:55], v[232:235]
  v_mfma_f32_16x16x32_bf16 v[232:235], v[124:127], v[56:59], v[232:235]
  v_mfma_f32_16x16x32_bf16 v[236:239], v[128:131], v[216:219], 0
  v_mfma_f32_16x16x32_bf16 v[236:239], v[132:135], v[220:223], v[236:239]
  v_mfma_f32_16x16x32_bf16 v[236:239], v[136:139], v[224:227], v[236:239]
  v_mfma_f32_16x16x32_bf16 v[236:239], v[140:143], v[228:231], v[236:239]
  v_xor_b32 v4, 0xc0, v8
  s_nop 2
  ds_write_b128 v4, v[232:235] offset:24576
  v_mfma_f32_16x16x32_bf16 v[236:239], v[144:147], v[48:51], v[236:239]
  s_waitcnt vmcnt(9)
  v_mfma_f32_16x16x32_bf16 v[236:239], v[148:151], v[52:55], v[236:239]
  s_waitcnt vmcnt(8)
  v_mfma_f32_16x16x32_bf16 v[236:239], v[152:155], v[56:59], v[236:239]
  buffer_load_dwordx2 v[254:255], v6, s[8:11], s31 offen sc1
  s_mov_b64 exec, s[48:49]
  s_waitcnt vmcnt(1)
  v_cmp_ne_u32 vcc, s27, v7
  s_nop 4
  s_cbranch_vccz Lchk13x
  s_mov_b32 s28, 0
Lchk13:
  s_sleep 2
  buffer_load_dword v7, v3, s[8:11], s78 offen offset:0 sc1
  s_add_u32 s28, s28, 1
  s_waitcnt vmcnt(0)
  s_cmp_gt_u32 s28, 1000000
  s_cbranch_scc1 Lchk13x
  v_cmp_ne_u32 vcc, s27, v7
  s_nop 4
  s_cbranch_vccnz Lchk13
Lchk13x:
  s_mov_b64 exec, -1
  v_mfma_f32_16x16x32_bf16 v[240:243], v[156:159], v[60:63], 0
  v_mfma_f32_16x16x32_bf16 v[240:243], v[160:163], v[64:67], v[240:243]
  s_add_u32 s61, s42, 0x36000
  buffer_load_dwordx4 v[216:219], v2, s[8:11], s61 offen sc1
  v_mfma_f32_16x16x32_bf16 v[240:243], v[164:167], v[68:71], v[240:243]
  v_mfma_f32_16x16x32_bf16 v[240:243], v[168:171], v[16:19], v[240:243]
  v_xor_b32 v4, 0x8000, v8
  ds_write_b128 v4, v[236:239] offset:0
  s_add_u32 s61, s42, 0x36400
  buffer_load_dwordx4 v[220:223], v2, s[8:11], s61 offen sc1
  v_mfma_f32_16x16x32_bf16 v[240:243], v[172:175], v[20:23], v[240:243]
  v_mfma_f32_16x16x32_bf16 v[240:243], v[176:179], v[24:27], v[240:243]
  s_add_u32 s61, s42, 0x36800
  buffer_load_dwordx4 v[224:227], v2, s[8:11], s61 offen sc1
  v_mfma_f32_16x16x32_bf16 v[240:243], v[180:183], v[28:31], v[240:243]
  s_waitcnt lgkmcnt(0)
  s_barrier
  ds_read_b128 v[32:35], v9 offset:0
  ds_read_b128 v[36:39], v9 offset:1024
  ds_read_b128 v[40:43], v9 offset:2048
  ds_read_b128 v[44:47], v9 offset:3072
  v_mfma_f32_16x16x32_bf16 v[232:235], v[184:187], v[60:63], 0
  s_add_u32 s61, s42, 0x36c00
  buffer_load_dwordx4 v[228:231], v2, s[8:11], s61 offen sc1
  v_lshlrev_b32 v72, 16, v252
  v_and_b32 v73, s63, v252
  v_mfma_f32_16x16x32_bf16 v[232:235], v[188:191], v[64:67], v[232:235]
  v_lshlrev_b32 v74, 16, v253
  v_and_b32 v75, s63, v253
  v_mfma_f32_16x16x32_bf16 v[232:235], v[192:195], v[68:71], v[232:235]
  s_add_u32 s61, s42, 0x37000
  buffer_load_dwordx4 v[48:51], v2, s[8:11], s61 offen sc1
  v_mfma_f32_16x16x32_bf16 v[232:235], v[196:199], v[16:19], v[232:235]
  v_xor_b32 v4, 0x8000, v8
  ds_write_b128 v4, v[240:243] offset:8192
  s_waitcnt lgkmcnt(4)
  v_add_f32 v72, v72, v32
  v_add_f32 v73, v73, v33
  v_mfma_f32_16x16x32_bf16 v[232:235], v[200:203], v[20:23], v[232:235]
  s_add_u32 s61, s42, 0x37400
  buffer_load_dwordx4 v[52:55], v2, s[8:11], s61 offen sc1
  v_add_f32 v74, v74, v34
  v_add_f32 v75, v75, v35
  ds_read_b128 v[32:35], v9 offset:4096
  v_mfma_f32_16x16x32_bf16 v[232:235], v[204:207], v[24:27], v[232:235]
  s_waitcnt lgkmcnt(4)
  v_add_f32 v72, v72, v36
  v_add_f32 v73, v73, v37
  v_mfma_f32_16x16x32_bf16 v[232:235], v[208:211], v[28:31], v[232:235]
  s_add_u32 s61, s42, 0x37800
  s_add_u32 s61, s61, s75
  buffer_load_dwordx4 v[56:59], v2, s[8:11], s61 offen sc1
  v_add_f32 v74, v74, v38
  v_add_f32 v75, v75, v39
  ds_read_b128 v[36:39], v9 offset:5120
  v_mfma_f32_16x16x32_bf16 v[236:239], v[212:215], v[60:63], 0
  s_waitcnt lgkmcnt(4)
  v_add_f32 v72, v72, v40
  v_add_f32 v73, v73, v41
  v_mfma_f32_16x16x32_bf16 v[236:239], v[76:79], v[64:67], v[236:239]
  v_add_f32 v74, v74, v42
  v_add_f32 v75, v75, v43
  ds_read_b128 v[40:43], v9 offset:6144
  v_mfma_f32_16x16x32_bf16 v[236:239], v[80:83], v[68:71], v[236:239]
  s_waitcnt lgkmcnt(4)
  v_add_f32 v72, v72, v44
  v_add_f32 v73, v73, v45
  v_mfma_f32_16x16x32_bf16 v[236:239], v[84:87], v[16:19], v[236:239]
  v_xor_b32 v4, 0x8040, v8
  ds_write_b128 v4, v[232:235] offset:16384
  v_add_f32 v74, v74, v46
  v_add_f32 v75, v75, v47
  ds_read_b128 v[44:47], v9 offset:7168
  v_mfma_f32_16x16x32_bf16 v[236:239], v[88:91], v[20:23], v[236:239]
  s_waitcnt lgkmcnt(4)
  v_add_f32 v72, v72, v32
  v_add_f32 v73, v73, v33
  v_mfma_f32_16x16x32_bf16 v[236:239], v[92:95], v[24:27], v[236:239]
  v_add_f32 v74, v74, v34
  v_add_f32 v75, v75, v35
  v_mfma_f32_16x16x32_bf16 v[236:239], v[96:99], v[28:31], v[236:239]
  s_waitcnt lgkmcnt(3)
  v_add_f32 v72, v72, v36
  v_add_f32 v73, v73, v37
  s_mov_b64 exec, s[50:51]
  buffer_load_dword v7, v3, s[8:11], s78 offen offset:0 sc1
  s_mov_b64 exec, -1
  v_mfma_f32_16x16x32_bf16 v[240:243], v[100:103], v[60:63], 0
  v_add_f32 v74, v74, v38
  v_add_f32 v75, v75, v39
  v_mfma_f32_16x16x32_bf16 v[240:243], v[104:107], v[64:67], v[240:243]
  s_waitcnt lgkmcnt(2)
  v_add_f32 v72, v72, v40
  v_add_f32 v73, v73, v41
  v_mfma_f32_16x16x32_bf16 v[240:243], v[108:111], v[68:71], v[240:243]
  v_add_f32 v74, v74, v42
  v_add_f32 v75, v75, v43
  v_mfma_f32_16x16x32_bf16 v[240:243], v[112:115], v[16:19], v[240:243]
  v_xor_b32 v4, 0x8080, v8
  ds_write_b128 v4, v[236:239] offset:24576
  s_waitcnt lgkmcnt(1)
  v_add_f32 v72, v72, v44
  v_add_f32 v73, v73, v45
  v_mfma_f32_16x16x32_bf16 v[240:243], v[116:119], v[20:23], v[240:243]
  v_add_f32 v74, v74, v46
  v_add_f32 v75, v75, v47
  v_mfma_f32_16x16x32_bf16 v[240:243], v[120:123], v[24:27], v[240:243]
  v_cvt_pk_bf16_f32 v14, v72, v73
  v_cvt_pk_bf16_f32 v15, v74, v75
  buffer_store_dwordx2 v[14:15], v5, s[12:15], s34 offen
  v_mfma_f32_16x16x32_bf16 v[240:243], v[124:127], v[28:31], v[240:243]
  v_mfma_f32_16x16x32_bf16 v[232:235], v[128:131], v[60:63], 0
  v_mfma_f32_16x16x32_bf16 v[232:235], v[132:135], v[64:67], v[232:235]
  v_mfma_f32_16x16x32_bf16 v[232:235], v[136:139], v[68:71], v[232:235]
  v_mfma_f32_16x16x32_bf16 v[232:235], v[140:143], v[16:19], v[232:235]
  v_xor_b32 v4, 0x100c0, v8
  s_nop 2
  ds_write_b128 v4, v[240:243] offset:0
  v_mfma_f32_16x16x32_bf16 v[232:235], v[144:147], v[20:23], v[232:235]
  v_mfma_f32_16x16x32_bf16 v[232:235], v[148:151], v[24:27], v[232:235]
  v_mfma_f32_16x16x32_bf16 v[232:235], v[152:155], v[28:31], v[232:235]
  buffer_load_dwordx2 v[252:253], v6, s[8:11], s32 offen sc1
  s_mov_b64 exec, s[50:51]
  s_waitcnt vmcnt(2)
  v_cmp_ne_u32 vcc, s27, v7
  s_nop 4
  s_cbranch_vccz Lchk14x
  s_mov_b32 s28, 0
Lchk14:
  s_sleep 2
  buffer_load_dword v7, v3, s[8:11], s78 offen offset:0 sc1
  s_add_u32 s28, s28, 1
  s_waitcnt vmcnt(0)
  s_cmp_gt_u32 s28, 1000000
  s_cbranch_scc1 Lchk14x
  v_cmp_ne_u32 vcc, s27, v7
  s_nop 4
  s_cbranch_vccnz Lchk14
Lchk14x:
  s_mov_b64 exec, -1
  v_mfma_f32_16x16x32_bf16 v[236:239], v[156:159], v[216:219], 0
  v_mfma_f32_16x16x32_bf16 v[236:239], v[160:163], v[220:223], v[236:239]
  s_add_u32 s61, s42, 0x51000
  buffer_load_dwordx4 v[60:63], v2, s[8:11], s61 offen sc1
  v_mfma_f32_16x16x32_bf16 v[236:239], v[164:167], v[224:227], v[236:239]
  v_mfma_f32_16x16x32_bf16 v[236:239], v[168:171], v[228:231], v[236:239]
  v_xor_b32 v4, 0x10000, v8
  ds_write_b128 v4, v[232:235] offset:8192
  s_add_u32 s61, s42, 0x51400
  buffer_load_dwordx4 v[64:67], v2, s[8:11], s61 offen sc1
  v_mfma_f32_16x16x32_bf16 v[236:239], v[172:175], v[48:51], v[236:239]
  v_mfma_f32_16x16x32_bf16 v[236:239], v[176:179], v[52:55], v[236:239]
  s_add_u32 s61, s42, 0x51800
  buffer_load_dwordx4 v[68:71], v2, s[8:11], s61 offen sc1
  v_mfma_f32_16x16x32_bf16 v[236:239], v[180:183], v[56:59], v[236:239]
  s_waitcnt lgkmcnt(0)
  s_barrier
  ds_read_b128 v[32:35], v9 offset:40960
  ds_read_b128 v[36:39], v9 offset:41984
  ds_read_b128 v[40:43], v9 offset:43008
  ds_read_b128 v[44:47], v9 offset:44032
  v_mfma_f32_16x16x32_bf16 v[240:243], v[184:187], v[216:219], 0
  s_add_u32 s61, s42, 0x51c00
  buffer_load_dwordx4 v[16:19], v2, s[8:11], s61 offen sc1
  v_lshlrev_b32 v72, 16, v254
  v_and_b32 v73, s63, v254
  v_mfma_f32_16x16x32_bf16 v[240:243], v[188:191], v[220:223], v[240:243]
  v_lshlrev_b32 v74, 16, v255
  v_and_b32 v75, s63, v255
  v_mfma_f32_16x16x32_bf16 v[240:243], v[192:195], v[224:227], v[240:243]
  s_add_u32 s61, s42, 0x52000
  buffer_load_dwordx4 v[20:23], v2, s[8:11], s61 offen sc1
  v_mfma_f32_16x16x32_bf16 v[240:243], v[196:199], v[228:231], v[240:243]
  v_xor_b32 v4, 0x0, v8
  ds_write_b128 v4, v[236:239] offset:0
  s_waitcnt lgkmcnt(4)
  v_add_f32 v72, v72, v32
  v_add_f32 v73, v73, v33
  v_mfma_f32_16x16x32_bf16 v[240:243], v[200:203], v[48:51], v[240:243]
  s_add_u32 s61, s42, 0x52400
  buffer_load_dwordx4 v[24:27], v2, s[8:11], s61 offen sc1
  v_add_f32 v74, v74, v34
  v_add_f32 v75, v75, v35
  ds_read_b128 v[32:35], v9 offset:45056
  v_mfma_f32_16x16x32_bf16 v[240:243], v[204:207], v[52:55], v[240:243]
  s_waitcnt lgkmcnt(4)
  v_add_f32 v72, v72, v36
  v_add_f32 v73, v73, v37
  v_mfma_f32_16x16x32_bf16 v[240:243], v[208:211], v[56:59], v[240:243]
  s_add_u32 s61, s42, 0x52800
  s_add_u32 s61, s61, s75
  buffer_load_dwordx4 v[28:31], v2, s[8:11], s61 offen sc1
  v_add_f32 v74, v74, v38
  v_add_f32 v75, v75, v39
  ds_read_b128 v[36:39], v9 offset:46080
  v_mfma_f32_16x16x32_bf16 v[232:235], v[212:215], v[216:219], 0
  s_waitcnt lgkmcnt(4)
  v_add_f32 v72, v72, v40
  v_add_f32 v73, v73, v41
  v_mfma_f32_16x16x32_bf16 v[232:235], v[76:79], v[220:223], v[232:235]
  v_add_f32 v74, v74, v42
  v_add_f32 v75, v75, v43
  ds_read_b128 v[40:43], v9 offset:47104
  v_mfma_f32_16x16x32_bf16 v[232:235], v[80:83], v[224:227], v[232:235]
  s_waitcnt lgkmcnt(4)
  v_add_f32 v72, v72, v44
  v_add_f32 v73, v73, v45
  v_mfma_f32_16x16x32_bf16 v[232:235], v[84:87], v[228:231], v[232:235]
  v_xor_b32 v4, 0x40, v8
  ds_write_b128 v4, v[240:243] offset:8192
  v_add_f32 v74, v74, v46
  v_add_f32 v75, v75, v47
  ds_read_b128 v[44:47], v9 offset:48128
  v_mfma_f32_16x16x32_bf16 v[232:235], v[88:91], v[48:51], v[232:235]
  s_waitcnt lgkmcnt(4)
  v_add_f32 v72, v72, v32
  v_add_f32 v73, v73, v33
  v_mfma_f32_16x16x32_bf16 v[232:235], v[92:95], v[52:55], v[232:235]
  v_add_f32 v74, v74, v34
  v_add_f32 v75, v75, v35
  v_mfma_f32_16x16x32_bf16 v[232:235], v[96:99], v[56:59], v[232:235]
  s_waitcnt lgkmcnt(3)
  v_add_f32 v72, v72, v36
  v_add_f32 v73, v73, v37
  v_mfma_f32_16x16x32_bf16 v[236:239], v[100:103], v[216:219], 0
  v_add_f32 v74, v74, v38
  v_add_f32 v75, v75, v39
  v_mfma_f32_16x16x32_bf16 v[236:239], v[104:107], v[220:223], v[236:239]
  s_waitcnt lgkmcnt(2)
  v_add_f32 v72, v72, v40
  v_add_f32 v73, v73, v41
  v_mfma_f32_16x16x32_bf16 v[236:239], v[108:111], v[224:227], v[236:239]
  v_add_f32 v74, v74, v42
  v_add_f32 v75, v75, v43
  v_mfma_f32_16x16x32_bf16 v[236:239], v[112:115], v[228:231], v[236:239]
  v_xor_b32 v4, 0x80, v8
  ds_write_b128 v4, v[232:235] offset:16384
  s_waitcnt lgkmcnt(1)
  v_add_f32 v72, v72, v44
  v_add_f32 v73, v73, v45
  v_mfma_f32_16x16x32_bf16 v[236:239], v[116:119], v[48:51], v[236:239]
  v_add_f32 v74, v74, v46
  v_add_f32 v75, v75, v47
  v_mfma_f32_16x16x32_bf16 v[236:239], v[120:123], v[52:55], v[236:239]
  v_cvt_pk_bf16_f32 v14, v72, v73
  v_cvt_pk_bf16_f32 v15, v74, v75
  buffer_store_dwordx2 v[14:15], v5, s[12:15], s35 offen
  v_mfma_f32_16x16x32_bf16 v[236:239], v[124:127], v[56:59], v[236:239]
  v_mfma_f32_16x16x32_bf16 v[240:243], v[128:131], v[216:219], 0
  v_mfma_f32_16x16x32_bf16 v[240:243], v[132:135], v[220:223], v[240:243]
  v_mfma_f32_16x16x32_bf16 v[240:243], v[136:139], v[224:227], v[240:243]
  v_mfma_f32_16x16x32_bf16 v[240:243], v[140:143], v[228:231], v[240:243]
  v_xor_b32 v4, 0xc0, v8
  s_nop 2
  ds_write_b128 v4, v[236:239] offset:24576
  v_mfma_f32_16x16x32_bf16 v[240:243], v[144:147], v[48:51], v[240:243]
  v_mfma_f32_16x16x32_bf16 v[240:243], v[148:151], v[52:55], v[240:243]
  v_mfma_f32_16x16x32_bf16 v[240:243], v[152:155], v[56:59], v[240:243]
  buffer_load_dwordx2 v[254:255], v6, s[8:11], s33 offen sc1
  s_waitcnt vmcnt(8)
  v_mfma_f32_16x16x32_bf16 v[232:235], v[156:159], v[60:63], 0
  s_waitcnt vmcnt(7)
  v_mfma_f32_16x16x32_bf16 v[232:235], v[160:163], v[64:67], v[232:235]
  s_waitcnt vmcnt(6)
  v_mfma_f32_16x16x32_bf16 v[232:235], v[164:167], v[68:71], v[232:235]
  s_waitcnt vmcnt(5)
  v_mfma_f32_16x16x32_bf16 v[232:235], v[168:171], v[16:19], v[232:235]
  v_xor_b32 v4, 0x8000, v8
  ds_write_b128 v4, v[240:243] offset:0
  s_waitcnt vmcnt(4)
  v_mfma_f32_16x16x32_bf16 v[232:235], v[172:175], v[20:23], v[232:235]
  s_waitcnt vmcnt(3)
  v_mfma_f32_16x16x32_bf16 v[232:235], v[176:179], v[24:27], v[232:235]
  s_waitcnt vmcnt(2)
  v_mfma_f32_16x16x32_bf16 v[232:235], v[180:183], v[28:31], v[232:235]
  s_waitcnt lgkmcnt(0)
  s_barrier
  ds_read_b128 v[32:35], v9 offset:0
  ds_read_b128 v[36:39], v9 offset:1024
  ds_read_b128 v[40:43], v9 offset:2048
  ds_read_b128 v[44:47], v9 offset:3072
  v_mfma_f32_16x16x32_bf16 v[236:239], v[184:187], v[60:63], 0
  v_lshlrev_b32 v72, 16, v252
  v_and_b32 v73, s63, v252
  v_mfma_f32_16x16x32_bf16 v[236:239], v[188:191], v[64:67], v[236:239]
  v_lshlrev_b32 v74, 16, v253
  v_and_b32 v75, s63, v253
  v_mfma_f32_16x16x32_bf16 v[236:239], v[192:195], v[68:71], v[236:239]
  v_mfma_f32_16x16x32_bf16 v[236:239], v[196:199], v[16:19], v[236:239]
  v_xor_b32 v4, 0x8000, v8
  ds_write_b128 v4, v[232:235] offset:8192
  s_waitcnt lgkmcnt(4)
  v_add_f32 v72, v72, v32
  v_add_f32 v73, v73, v33
  v_mfma_f32_16x16x32_bf16 v[236:239], v[200:203], v[20:23], v[236:239]
  v_add_f32 v74, v74, v34
  v_add_f32 v75, v75, v35
  ds_read_b128 v[32:35], v9 offset:4096
  v_mfma_f32_16x16x32_bf16 v[236:239], v[204:207], v[24:27], v[236:239]
  s_waitcnt lgkmcnt(4)
  v_add_f32 v72, v72, v36
  v_add_f32 v73, v73, v37
  v_mfma_f32_16x16x32_bf16 v[236:239], v[208:211], v[28:31], v[236:239]
  v_add_f32 v74, v74, v38
  v_add_f32 v75, v75, v39
  ds_read_b128 v[36:39], v9 offset:5120
  v_mfma_f32_16x16x32_bf16 v[240:243], v[212:215], v[60:63], 0
  s_waitcnt lgkmcnt(4)
  v_add_f32 v72, v72, v40
  v_add_f32 v73, v73, v41
  v_mfma_f32_16x16x32_bf16 v[240:243], v[76:79], v[64:67], v[240:243]
  v_add_f32 v74, v74, v42
  v_add_f32 v75, v75, v43
  ds_read_b128 v[40:43], v9 offset:6144
  v_mfma_f32_16x16x32_bf16 v[240:243], v[80:83], v[68:71], v[240:243]
  s_waitcnt lgkmcnt(4)
  v_add_f32 v72, v72, v44
  v_add_f32 v73, v73, v45
  v_mfma_f32_16x16x32_bf16 v[240:243], v[84:87], v[16:19], v[240:243]
  v_xor_b32 v4, 0x8040, v8
  ds_write_b128 v4, v[236:239] offset:16384
  v_add_f32 v74, v74, v46
  v_add_f32 v75, v75, v47
  ds_read_b128 v[44:47], v9 offset:7168
  v_mfma_f32_16x16x32_bf16 v[240:243], v[88:91], v[20:23], v[240:243]
  s_waitcnt lgkmcnt(4)
  v_add_f32 v72, v72, v32
  v_add_f32 v73, v73, v33
  v_mfma_f32_16x16x32_bf16 v[240:243], v[92:95], v[24:27], v[240:243]
  v_add_f32 v74, v74, v34
  v_add_f32 v75, v75, v35
  v_mfma_f32_16x16x32_bf16 v[240:243], v[96:99], v[28:31], v[240:243]
  s_waitcnt lgkmcnt(3)
  v_add_f32 v72, v72, v36
  v_add_f32 v73, v73, v37
  v_mfma_f32_16x16x32_bf16 v[232:235], v[100:103], v[60:63], 0
  v_add_f32 v74, v74, v38
  v_add_f32 v75, v75, v39
  v_mfma_f32_16x16x32_bf16 v[232:235], v[104:107], v[64:67], v[232:235]
  s_waitcnt lgkmcnt(2)
  v_add_f32 v72, v72, v40
  v_add_f32 v73, v73, v41
  v_mfma_f32_16x16x32_bf16 v[232:235], v[108:111], v[68:71], v[232:235]
  v_add_f32 v74, v74, v42
  v_add_f32 v75, v75, v43
  v_mfma_f32_16x16x32_bf16 v[232:235], v[112:115], v[16:19], v[232:235]
  v_xor_b32 v4, 0x8080, v8
  ds_write_b128 v4, v[240:243] offset:24576
  s_waitcnt lgkmcnt(1)
  v_add_f32 v72, v72, v44
  v_add_f32 v73, v73, v45
  v_mfma_f32_16x16x32_bf16 v[232:235], v[116:119], v[20:23], v[232:235]
  v_add_f32 v74, v74, v46
  v_add_f32 v75, v75, v47
  v_mfma_f32_16x16x32_bf16 v[232:235], v[120:123], v[24:27], v[232:235]
  v_cvt_pk_bf16_f32 v14, v72, v73
  v_cvt_pk_bf16_f32 v15, v74, v75
  buffer_store_dwordx2 v[14:15], v5, s[12:15], s36 offen
  v_mfma_f32_16x16x32_bf16 v[232:235], v[124:127], v[28:31], v[232:235]
  v_mfma_f32_16x16x32_bf16 v[236:239], v[128:131], v[60:63], 0
  v_mfma_f32_16x16x32_bf16 v[236:239], v[132:135], v[64:67], v[236:239]
  v_mfma_f32_16x16x32_bf16 v[236:239], v[136:139], v[68:71], v[236:239]
  v_mfma_f32_16x16x32_bf16 v[236:239], v[140:143], v[16:19], v[236:239]
  v_xor_b32 v4, 0x100c0, v8
  s_nop 2
  ds_write_b128 v4, v[232:235] offset:0
  v_mfma_f32_16x16x32_bf16 v[236:239], v[144:147], v[20:23], v[236:239]
  v_mfma_f32_16x16x32_bf16 v[236:239], v[148:151], v[24:27], v[236:239]
  v_mfma_f32_16x16x32_bf16 v[236:239], v[152:155], v[28:31], v[236:239]
  v_xor_b32 v4, 0x10000, v8
  s_nop 6
  ds_write_b128 v4, v[236:239] offset:8192
  s_waitcnt lgkmcnt(0)
  s_barrier
  ds_read_b128 v[32:35], v9 offset:40960
  ds_read_b128 v[36:39], v9 offset:41984
  ds_read_b128 v[40:43], v9 offset:43008
  ds_read_b128 v[44:47], v9 offset:44032
  s_waitcnt vmcnt(1)
  v_lshlrev_b32 v72, 16, v254
  v_and_b32 v73, s63, v254
  v_lshlrev_b32 v74, 16, v255
  v_and_b32 v75, s63, v255
  s_waitcnt lgkmcnt(3)
  v_add_f32 v72, v72, v32
  v_add_f32 v73, v73, v33
  v_add_f32 v74, v74, v34
  v_add_f32 v75, v75, v35
  ds_read_b128 v[32:35], v9 offset:45056
  s_waitcnt lgkmcnt(3)
  v_add_f32 v72, v72, v36
  v_add_f32 v73, v73, v37
  v_add_f32 v74, v74, v38
  v_add_f32 v75, v75, v39
  ds_read_b128 v[36:39], v9 offset:46080
  s_waitcnt lgkmcnt(3)
  v_add_f32 v72, v72, v40
  v_add_f32 v73, v73, v41
  v_add_f32 v74, v74, v42
  v_add_f32 v75, v75, v43
  ds_read_b128 v[40:43], v9 offset:47104
  s_waitcnt lgkmcnt(3)
  v_add_f32 v72, v72, v44
  v_add_f32 v73, v73, v45
  v_add_f32 v74, v74, v46
  v_add_f32 v75, v75, v47
  ds_read_b128 v[44:47], v9 offset:48128
  s_waitcnt lgkmcnt(3)
  v_add_f32 v72, v72, v32
  v_add_f32 v73, v73, v33
  v_add_f32 v74, v74, v34
  v_add_f32 v75, v75, v35
  s_waitcnt lgkmcnt(2)
  v_add_f32 v72, v72, v36
  v_add_f32 v73, v73, v37
  v_add_f32 v74, v74, v38
  v_add_f32 v75, v75, v39
  s_waitcnt lgkmcnt(1)
  v_add_f32 v72, v72, v40
  v_add_f32 v73, v73, v41
  v_add_f32 v74, v74, v42
  v_add_f32 v75, v75, v43
  s_waitcnt lgkmcnt(0)
  v_add_f32 v72, v72, v44
  v_add_f32 v73, v73, v45
  v_add_f32 v74, v74, v46
  v_add_f32 v75, v75, v47
  v_cvt_pk_bf16_f32 v14, v72, v73
  v_cvt_pk_bf16_f32 v15, v74, v75
  buffer_store_dwordx2 v[14:15], v5, s[12:15], s37 offen
  s_branch LE_done
LD_svc:
  v_lshlrev_b32 v8, 13, v1
  v_lshlrev_b32 v3, 7, v1
  s_lshl_b32 s44, s56, 2
  s_lshr_b32 s45, s24, 1
  s_add_u32 s44, s44, s45
  s_lshl_b32 s44, s44, 8
  s_lshl_b32 s44, s44, 5
  s_add_u32 s44, s44, 0x1c00000
  s_mov_b64 exec, 15
  buffer_store_dword v13, v8, s[8:11], s69 offen sc1
  s_mov_b64 exec, -1
  v_and_b32 v5, 31, v1
  v_lshrrev_b32 v6, 5, v1
  v_bfe_u32 v7, v1, 4, 1
  v_lshlrev_b32 v7, 11, v7
  v_lshl_add_u32 v7, v6, 10, v7
  v_and_b32 v8, 15, v1
  v_lshl_add_u32 v7, v8, 3, v7
  v_lshlrev_b32 v4, 2, v5
  s_mul_i32 s45, s56, 163840
  s_add_u32 s45, s45, 0xb00000
  s_lshl_b32 s46, s56, 14
  s_add_u32 s46, s46, 0xe00000
  s_mov_b32 s47, 0x3acccccd
  v_mov_b32 v10, 0xd200
  ds_write_b32 v10, v12
  ds_write_b32 v10, v12 offset:4
  v_lshlrev_b32 v10, 7, v1
  s_mul_i32 s43, s25, 69120
  s_add_u32 s43, s43, 0x1900000
  s_mov_b32 s50, 0x1e00000
  s_mov_b32 s52, -1
  s_mov_b32 s53, 0x3fffff
  s_mul_i32 s30, s70, 160
  s_mul_i32 s61, s72, 5
  s_add_u32 s30, s30, s61
  s_lshl_b32 s30, s30, 10
  s_lshl_b32 s61, s71, 8
  s_add_u32 s30, s30, s61
  s_lshl_b32 s61, s26, 5
  s_add_u32 s30, s30, s61
  s_add_u32 s30, s30, 0xb00000
  s_lshl_b32 s34, s70, 3
  s_add_u32 s34, s34, s71
  s_mul_i32 s34, s34, 20480
  s_mul_i32 s61, s72, 160
  s_add_u32 s34, s34, s61
  s_mul_i32 s61, s26, 2560
  s_add_u32 s34, s34, s61
  s_add_u32 s31, s30, 40960
  s_add_u32 s35, s34, 40960
  s_add_u32 s32, s30, 81920
  s_add_u32 s36, s34, 81920
  s_add_u32 s33, s30, 122880
  s_add_u32 s37, s34, 122880
  s_lshl_b32 s61, s70, 3
  s_add_u32 s61, s61, s71
  s_mul_i32 s42, s61, 55296
  s_lshl_b32 s61, s73, 10
  s_add_u32 s42, s42, s61
  s_add_u32 s42, s42, 0x1000000
  s_lshl_b32 s77, s56, 8
  s_lshl_b32 s78, s57, 2
  s_add_u32 s77, s77, s78
  s_lshl_b32 s77, s77, 5
  s_add_u32 s77, s77, 0x1c80000
  s_lshl_b32 s78, s70, 8
  s_lshl_b32 s78, s78, 5
  s_add_u32 s78, s78, 0x1c80000
  s_mov_b32 s63, 0xffff0000
  s_mov_b64 exec, 0xff
  s_mov_b32 s28, 0
Lpoll15:
  buffer_load_dword v9, v3, s[8:11], s44 offen offset:0 sc1
  s_add_u32 s28, s28, 1
  s_cmp_gt_u32 s28, 1000000
  s_cbranch_scc1 Lpoll15x
  s_waitcnt vmcnt(0)
  v_cmp_ne_u32 vcc, s27, v9
  s_nop 4
  s_cbranch_vccz Lpoll15x
  s_sleep 1
  s_branch Lpoll15
Lpoll15x:
  s_waitcnt vmcnt(0)
  s_mov_b64 exec, -1
  s_mov_b32 m0, 0x0
  s_add_u32 s48, s45, 0x0
  s_add_u32 s48, s48, s16
  buffer_load_dwordx4 v2, s[8:11], s48 offen offset:0 sc1 lds
  buffer_load_dwordx4 v2, s[8:11], s48 offen offset:1024 sc1 lds
  buffer_load_dwordx4 v2, s[8:11], s48 offen offset:2048 sc1 lds
  buffer_load_dwordx4 v2, s[8:11], s48 offen offset:3072 sc1 lds
  s_mov_b32 m0, 0x1000
  s_add_u32 s48, s45, 0x1000
  s_add_u32 s48, s48, s16
  buffer_load_dwordx4 v2, s[8:11], s48 offen offset:0 sc1 lds
  buffer_load_dwordx4 v2, s[8:11], s48 offen offset:1024 sc1 lds
  buffer_load_dwordx4 v2, s[8:11], s48 offen offset:2048 sc1 lds
  buffer_load_dwordx4 v2, s[8:11], s48 offen offset:3072 sc1 lds
  s_mov_b32 m0, 0x2000
  s_add_u32 s48, s45, 0x2000
  s_add_u32 s48, s48, s16
  buffer_load_dwordx4 v2, s[8:11], s48 offen offset:0 sc1 lds
  buffer_load_dwordx4 v2, s[8:11], s48 offen offset:1024 sc1 lds
  s_mov_b32 m0, 0x2800
  s_add_u32 s48, s45, 0x0
  s_add_u32 s48, s48, s17
  buffer_load_dwordx4 v2, s[8:11], s48 offen offset:0 sc1 lds
  buffer_load_dwordx4 v2, s[8:11], s48 offen offset:1024 sc1 lds
  buffer_load_dwordx4 v2, s[8:11], s48 offen offset:2048 sc1 lds
  buffer_load_dwordx4 v2, s[8:11], s48 offen offset:3072 sc1 lds
  s_mov_b32 m0, 0x3800
  s_add_u32 s48, s45, 0x1000
  s_add_u32 s48, s48, s17
  buffer_load_dwordx4 v2, s[8:11], s48 offen offset:0 sc1 lds
  buffer_load_dwordx4 v2, s[8:11], s48 offen offset:1024 sc1 lds
  buffer_load_dwordx4 v2, s[8:11], s48 offen offset:2048 sc1 lds
  buffer_load_dwordx4 v2, s[8:11], s48 offen offset:3072 sc1 lds
  s_mov_b32 m0, 0x4800
  s_add_u32 s48, s45, 0x2000
  s_add_u32 s48, s48, s17
  buffer_load_dwordx4 v2, s[8:11], s48 offen offset:0 sc1 lds
  buffer_load_dwordx4 v2, s[8:11], s48 offen offset:1024 sc1 lds
  s_add_u32 s49, s46, 0x0
  buffer_load_dwordx2 v[16:17], v7, s[8:11], s49 offen offset:0 sc1
  buffer_load_dwordx2 v[18:19], v7, s[8:11], s49 offen offset:128 sc1
  buffer_load_dwordx2 v[20:21], v7, s[8:11], s49 offen offset:256 sc1
  buffer_load_dwordx2 v[22:23], v7, s[8:11], s49 offen offset:384 sc1
  buffer_load_dwordx2 v[24:25], v7, s[8:11], s49 offen offset:512 sc1
  buffer_load_dwordx2 v[26:27], v7, s[8:11], s49 offen offset:640 sc1
  buffer_load_dwordx2 v[28:29], v7, s[8:11], s49 offen offset:768 sc1
  buffer_load_dwordx2 v[30:31], v7, s[8:11], s49 offen offset:896 sc1
  s_mov_b64 exec, 0xff00
  buffer_load_dword v9, v3, s[8:11], s44 offen offset:0 sc1
  s_mov_b64 exec, -1
  s_waitcnt vmcnt(19)
  s_waitcnt lgkmcnt(0)
  s_barrier
  s_mov_b32 m0, 0x5000
  s_add_u32 s48, s45, 0x0
  s_add_u32 s48, s48, s18
  buffer_load_dwordx4 v2, s[8:11], s48 offen offset:0 sc1 lds
  buffer_load_dwordx4 v2, s[8:11], s48 offen offset:1024 sc1 lds
  buffer_load_dwordx4 v2, s[8:11], s48 offen offset:2048 sc1 lds
  buffer_load_dwordx4 v2, s[8:11], s48 offen offset:3072 sc1 lds
  s_mov_b32 m0, 0x6000
  s_add_u32 s48, s45, 0x1000
  s_add_u32 s48, s48, s18
  buffer_load_dwordx4 v2, s[8:11], s48 offen offset:0 sc1 lds
  buffer_load_dwordx4 v2, s[8:11], s48 offen offset:1024 sc1 lds
  buffer_load_dwordx4 v2, s[8:11], s48 offen offset:2048 sc1 lds
  buffer_load_dwordx4 v2, s[8:11], s48 offen offset:3072 sc1 lds
  s_mov_b32 m0, 0x7000
  s_add_u32 s48, s45, 0x2000
  s_add_u32 s48, s48, s18
  buffer_load_dwordx4 v2, s[8:11], s48 offen offset:0 sc1 lds
  buffer_load_dwordx4 v2, s[8:11], s48 offen offset:1024 sc1 lds
  s_mov_b32 m0, 0x7800
  s_add_u32 s48, s45, 0x0
  s_add_u32 s48, s48, s19
  buffer_load_dwordx4 v2, s[8:11], s48 offen offset:0 sc1 lds
  buffer_load_dwordx4 v2, s[8:11], s48 offen offset:1024 sc1 lds
  buffer_load_dwordx4 v2, s[8:11], s48 offen offset:2048 sc1 lds
  buffer_load_dwordx4 v2, s[8:11], s48 offen offset:3072 sc1 lds
  s_mov_b32 m0, 0x8800
  s_add_u32 s48, s45, 0x1000
  s_add_u32 s48, s48, s19
  buffer_load_dwordx4 v2, s[8:11], s48 offen offset:0 sc1 lds
  buffer_load_dwordx4 v2, s[8:11], s48 offen offset:1024 sc1 lds
  buffer_load_dwordx4 v2, s[8:11], s48 offen offset:2048 sc1 lds
  buffer_load_dwordx4 v2, s[8:11], s48 offen offset:3072 sc1 lds
  s_mov_b32 m0, 0x9800
  s_add_u32 s48, s45, 0x2000
  s_add_u32 s48, s48, s19
  buffer_load_dwordx4 v2, s[8:11], s48 offen offset:0 sc1 lds
  buffer_load_dwordx4 v2, s[8:11], s48 offen offset:1024 sc1 lds
  s_waitcnt vmcnt(29)
  s_barrier
  s_mov_b32 m0, 0xa000
  s_add_u32 s48, s45, 0xa000
  s_add_u32 s48, s48, s16
  buffer_load_dwordx4 v2, s[8:11], s48 offen offset:0 sc1 lds
  buffer_load_dwordx4 v2, s[8:11], s48 offen offset:1024 sc1 lds
  buffer_load_dwordx4 v2, s[8:11], s48 offen offset:2048 sc1 lds
  buffer_load_dwordx4 v2, s[8:11], s48 offen offset:3072 sc1 lds
  s_mov_b32 m0, 0xb000
  s_add_u32 s48, s45, 0xb000
  s_add_u32 s48, s48, s16
  buffer_load_dwordx4 v2, s[8:11], s48 offen offset:0 sc1 lds
  buffer_load_dwordx4 v2, s[8:11], s48 offen offset:1024 sc1 lds
  buffer_load_dwordx4 v2, s[8:11], s48 offen offset:2048 sc1 lds
  buffer_load_dwordx4 v2, s[8:11], s48 offen offset:3072 sc1 lds
  s_mov_b32 m0, 0xc000
  s_add_u32 s48, s45, 0xc000
  s_add_u32 s48, s48, s16
  buffer_load_dwordx4 v2, s[8:11], s48 offen offset:0 sc1 lds
  buffer_load_dwordx4 v2, s[8:11], s48 offen offset:1024 sc1 lds
  s_mul_i32 s64, s72, 160
  s_add_u32 s65, s64, 159
  s_lshr_b32 s64, s64, 8
  s_lshr_b32 s65, s65, 8
  s_lshl_b32 s64, s64, 13
  s_lshl_b32 s65, s65, 13
  s_add_u32 s64, s64, 0x1e08000
  s_add_u32 s65, s65, 0x1e08000
  s_mov_b64 exec, s[52:53]
  buffer_load_dword v40, v3, s[8:11], s64 offen offset:0 sc1
  s_mov_b64 exec, -1
  s_mov_b64 exec, s[52:53]
  buffer_load_dword v41, v3, s[8:11], s65 offen offset:0 sc1
  s_mov_b64 exec, -1
  s_waitcnt vmcnt(36)
  v_add_f32 v16, v16, v24
  v_add_f32 v17, v17, v25
  s_waitcnt vmcnt(35)
  v_add_f32 v18, v18, v26
  v_add_f32 v19, v19, v27
  s_waitcnt vmcnt(34)
  v_add_f32 v20, v20, v28
  v_add_f32 v21, v21, v29
  s_waitcnt vmcnt(33)
  v_add_f32 v22, v22, v30
  v_add_f32 v23, v23, v31
  v_add_f32 v16, v16, v20
  v_add_f32 v17, v17, v21
  v_add_f32 v18, v18, v22
  v_add_f32 v19, v19, v23
  v_add_f32 v16, v16, v18
  v_add_f32 v17, v17, v19
  v_mov_b32 v18, v16
  v_mov_b32 v19, v17
  s_nop 0
  v_permlane32_swap_b32 v16, v18
  v_permlane32_swap_b32 v17, v19
  v_add_f32 v16, v16, v18
  v_add_f32 v17, v17, v19
  v_mul_f32 v16, s47, v16
  v_mul_f32 v17, s47, v17
  v_fma_f32 v17, -v16, v16, v17
  v_max_f32 v17, 0, v17
  v_add_f32 v17, 0x3727c5ac, v17
  v_rsq_f32 v17, v17
  v_cvt_pk_bf16_f32 v20, -v16, -v16
  v_mov_b32 v21, v20
  v_mov_b32 v22, v20
  v_mov_b32 v23, v20
  ds_write_b128 v2, v[20:23] offset:51200
  ds_write_b32 v4, v17 offset:53248
  s_waitcnt vmcnt(22)
  s_waitcnt lgkmcnt(0)
  s_barrier
  s_mov_b32 m0, 0x0
  s_add_u32 s48, s45, 0xa000
  s_add_u32 s48, s48, s17
  buffer_load_dwordx4 v2, s[8:11], s48 offen offset:0 sc1 lds
  buffer_load_dwordx4 v2, s[8:11], s48 offen offset:1024 sc1 lds
  buffer_load_dwordx4 v2, s[8:11], s48 offen offset:2048 sc1 lds
  buffer_load_dwordx4 v2, s[8:11], s48 offen offset:3072 sc1 lds
  s_mov_b32 m0, 0x1000
  s_add_u32 s48, s45, 0xb000
  s_add_u32 s48, s48, s17
  buffer_load_dwordx4 v2, s[8:11], s48 offen offset:0 sc1 lds
  buffer_load_dwordx4 v2, s[8:11], s48 offen offset:1024 sc1 lds
  buffer_load_dwordx4 v2, s[8:11], s48 offen offset:2048 sc1 lds
  buffer_load_dwordx4 v2, s[8:11], s48 offen offset:3072 sc1 lds
  s_mov_b32 m0, 0x2000
  s_add_u32 s48, s45, 0xc000
  s_add_u32 s48, s48, s17
  buffer_load_dwordx4 v2, s[8:11], s48 offen offset:0 sc1 lds
  buffer_load_dwordx4 v2, s[8:11], s48 offen offset:1024 sc1 lds
  s_add_u32 s49, s46, 0x1000
  buffer_load_dwordx2 v[16:17], v7, s[8:11], s49 offen offset:0 sc1
  buffer_load_dwordx2 v[18:19], v7, s[8:11], s49 offen offset:128 sc1
  buffer_load_dwordx2 v[20:21], v7, s[8:11], s49 offen offset:256 sc1
  buffer_load_dwordx2 v[22:23], v7, s[8:11], s49 offen offset:384 sc1
  buffer_load_dwordx2 v[24:25], v7, s[8:11], s49 offen offset:512 sc1
  buffer_load_dwordx2 v[26:27], v7, s[8:11], s49 offen offset:640 sc1
  buffer_load_dwordx2 v[28:29], v7, s[8:11], s49 offen offset:768 sc1
  buffer_load_dwordx2 v[30:31], v7, s[8:11], s49 offen offset:896 sc1
  s_waitcnt vmcnt(30)
  s_barrier
  s_mov_b32 m0, 0x2800
  s_add_u32 s48, s45, 0xa000
  s_add_u32 s48, s48, s18
  buffer_load_dwordx4 v2, s[8:11], s48 offen offset:0 sc1 lds
  buffer_load_dwordx4 v2, s[8:11], s48 offen offset:1024 sc1 lds
  buffer_load_dwordx4 v2, s[8:11], s48 offen offset:2048 sc1 lds
  buffer_load_dwordx4 v2, s[8:11], s48 offen offset:3072 sc1 lds
  s_mov_b32 m0, 0x3800
  s_add_u32 s48, s45, 0xb000
  s_add_u32 s48, s48, s18
  buffer_load_dwordx4 v2, s[8:11], s48 offen offset:0 sc1 lds
  buffer_load_dwordx4 v2, s[8:11], s48 offen offset:1024 sc1 lds
  buffer_load_dwordx4 v2, s[8:11], s48 offen offset:2048 sc1 lds
  buffer_load_dwordx4 v2, s[8:11], s48 offen offset:3072 sc1 lds
  s_mov_b32 m0, 0x4800
  s_add_u32 s48, s45, 0xc000
  s_add_u32 s48, s48, s18
  buffer_load_dwordx4 v2, s[8:11], s48 offen offset:0 sc1 lds
  buffer_load_dwordx4 v2, s[8:11], s48 offen offset:1024 sc1 lds
  s_mov_b64 exec, s[52:53]
  s_waitcnt vmcnt(29)
  v_cmp_ne_u32 vcc, s27, v40
  s_nop 4
  s_cbranch_vccz Lchk16x
  s_mov_b32 s28, 0
Lchk16:
  s_sleep 16
  buffer_load_dword v40, v3, s[8:11], s64 offen offset:0 sc1
  s_add_u32 s28, s28, 1
  s_waitcnt vmcnt(0)
  s_cmp_gt_u32 s28, 1000000
  s_cbranch_scc1 Lchk16x
  v_cmp_ne_u32 vcc, s27, v40
  s_nop 4
  s_cbranch_vccnz Lchk16
Lchk16x:
  s_mov_b64 exec, -1
  s_mov_b64 exec, s[52:53]
  s_waitcnt vmcnt(28)
  v_cmp_ne_u32 vcc, s27, v41
  s_nop 4
  s_cbranch_vccz Lchk17x
  s_mov_b32 s28, 0
Lchk17:
  s_sleep 16
  buffer_load_dword v41, v3, s[8:11], s65 offen offset:0 sc1
  s_add_u32 s28, s28, 1
  s_waitcnt vmcnt(0)
  s_cmp_gt_u32 s28, 1000000
  s_cbranch_scc1 Lchk17x
  v_cmp_ne_u32 vcc, s27, v41
  s_nop 4
  s_cbranch_vccnz Lchk17
Lchk17x:
  s_mov_b64 exec, -1
  s_barrier
  s_mov_b64 exec, 0xff00
  v_cmp_ne_u32 vcc, s27, v9
  s_nop 4
  s_cbranch_vccz Lchk18x
  s_mov_b32 s28, 0
Lchk18:
  s_sleep 4
  buffer_load_dword v9, v3, s[8:11], s44 offen offset:0 sc1
  s_add_u32 s28, s28, 1
  s_waitcnt vmcnt(0)
  s_cmp_gt_u32 s28, 1000000
  s_cbranch_scc1 Lchk18x
  v_cmp_ne_u32 vcc, s27, v9
  s_nop 4
  s_cbranch_vccnz Lchk18
Lchk18x:
  s_mov_b64 exec, -1
  s_mov_b32 m0, 0x5000
  s_add_u32 s48, s45, 0xa000
  s_add_u32 s48, s48, s19
  buffer_load_dwordx4 v2, s[8:11], s48 offen offset:0 sc1 lds
  buffer_load_dwordx4 v2, s[8:11], s48 offen offset:1024 sc1 lds
  buffer_load_dwordx4 v2, s[8:11], s48 offen offset:2048 sc1 lds
  buffer_load_dwordx4 v2, s[8:11], s48 offen offset:3072 sc1 lds
  s_mov_b32 m0, 0x6000
  s_add_u32 s48, s45, 0xb000
  s_add_u32 s48, s48, s19
  buffer_load_dwordx4 v2, s[8:11], s48 offen offset:0 sc1 lds
  buffer_load_dwordx4 v2, s[8:11], s48 offen offset:1024 sc1 lds
  buffer_load_dwordx4 v2, s[8:11], s48 offen offset:2048 sc1 lds
  buffer_load_dwordx4 v2, s[8:11], s48 offen offset:3072 sc1 lds
  s_mov_b32 m0, 0x7000
  s_add_u32 s48, s45, 0xc000
  s_add_u32 s48, s48, s19
  buffer_load_dwordx4 v2, s[8:11], s48 offen offset:0 sc1 lds
  buffer_load_dwordx4 v2, s[8:11], s48 offen offset:1024 sc1 lds
  s_add_u32 s60, s97, 0x0
  buffer_load_dwordx4 v[156:159], v2, s[8:11], s60 offen sc1
  s_add_u32 s60, s97, 0x400
  buffer_load_dwordx4 v[160:163], v2, s[8:11], s60 offen sc1
  s_add_u32 s60, s97, 0x800
  buffer_load_dwordx4 v[164:167], v2, s[8:11], s60 offen sc1
  s_add_u32 s60, s97, 0xc00
  buffer_load_dwordx4 v[168:171], v2, s[8:11], s60 offen sc1
  s_waitcnt vmcnt(32)
  s_barrier
  s_mov_b32 m0, 0x7800
  s_add_u32 s48, s45, 0x14000
  s_add_u32 s48, s48, s16
  buffer_load_dwordx4 v2, s[8:11], s48 offen offset:0 sc1 lds
  buffer_load_dwordx4 v2, s[8:11], s48 offen offset:1024 sc1 lds
  buffer_load_dwordx4 v2, s[8:11], s48 offen offset:2048 sc1 lds
  buffer_load_dwordx4 v2, s[8:11], s48 offen offset:3072 sc1 lds
  s_mov_b32 m0, 0x8800
  s_add_u32 s48, s45, 0x15000
  s_add_u32 s48, s48, s16
  buffer_load_dwordx4 v2, s[8:11], s48 offen offset:0 sc1 lds
  buffer_load_dwordx4 v2, s[8:11], s48 offen offset:1024 sc1 lds
  buffer_load_dwordx4 v2, s[8:11], s48 offen offset:2048 sc1 lds
  buffer_load_dwordx4 v2, s[8:11], s48 offen offset:3072 sc1 lds
  s_mov_b32 m0, 0x9800
  s_add_u32 s48, s45, 0x16000
  s_add_u32 s48, s48, s16
  buffer_load_dwordx4 v2, s[8:11], s48 offen offset:0 sc1 lds
  buffer_load_dwordx4 v2, s[8:11], s48 offen offset:1024 sc1 lds
  s_waitcnt vmcnt(37)
  v_add_f32 v16, v16, v24
  v_add_f32 v17, v17, v25
  s_waitcnt vmcnt(36)
  v_add_f32 v18, v18, v26
  v_add_f32 v19, v19, v27
  s_waitcnt vmcnt(35)
  v_add_f32 v20, v20, v28
  v_add_f32 v21, v21, v29
  s_waitcnt vmcnt(34)
  v_add_f32 v22, v22, v30
  v_add_f32 v23, v23, v31
  v_add_f32 v16, v16, v20
  v_add_f32 v17, v17, v21
  v_add_f32 v18, v18, v22
  v_add_f32 v19, v19, v23
  v_add_f32 v16, v16, v18
  v_add_f32 v17, v17, v19
  v_mov_b32 v18, v16
  v_mov_b32 v19, v17
  s_nop 0
  v_permlane32_swap_b32 v16, v18
  v_permlane32_swap_b32 v17, v19
  v_add_f32 v16, v16, v18
  v_add_f32 v17, v17, v19
  v_mul_f32 v16, s47, v16
  v_mul_f32 v17, s47, v17
  v_fma_f32 v17, -v16, v16, v17
  v_max_f32 v17, 0, v17
  v_add_f32 v17, 0x3727c5ac, v17
  v_rsq_f32 v17, v17
  v_cvt_pk_bf16_f32 v20, -v16, -v16
  v_mov_b32 v21, v20
  v_mov_b32 v22, v20
  v_mov_b32 v23, v20
  ds_write_b128 v2, v[20:23] offset:52224
  ds_write_b32 v4, v17 offset:53376
  s_add_u32 s60, s97, 0x1000
  buffer_load_dwordx4 v[172:175], v2, s[8:11], s60 offen sc1
  s_add_u32 s60, s97, 0x1400
  buffer_load_dwordx4 v[176:179], v2, s[8:11], s60 offen sc1
  s_add_u32 s60, s97, 0x1800
  s_add_u32 s60, s60, s75
  buffer_load_dwordx4 v[180:183], v2, s[8:11], s60 offen sc1
  s_add_u32 s60, s98, 0x0
  buffer_load_dwordx4 v[184:187], v2, s[8:11], s60 offen sc1
  s_waitcnt vmcnt(28)
  s_waitcnt lgkmcnt(0)
  s_barrier
  s_mov_b32 m0, 0xa000
  s_add_u32 s48, s45, 0x14000
  s_add_u32 s48, s48, s17
  buffer_load_dwordx4 v2, s[8:11], s48 offen offset:0 sc1 lds
  buffer_load_dwordx4 v2, s[8:11], s48 offen offset:1024 sc1 lds
  buffer_load_dwordx4 v2, s[8:11], s48 offen offset:2048 sc1 lds
  buffer_load_dwordx4 v2, s[8:11], s48 offen offset:3072 sc1 lds
  s_mov_b32 m0, 0xb000
  s_add_u32 s48, s45, 0x15000
  s_add_u32 s48, s48, s17
  buffer_load_dwordx4 v2, s[8:11], s48 offen offset:0 sc1 lds
  buffer_load_dwordx4 v2, s[8:11], s48 offen offset:1024 sc1 lds
  buffer_load_dwordx4 v2, s[8:11], s48 offen offset:2048 sc1 lds
  buffer_load_dwordx4 v2, s[8:11], s48 offen offset:3072 sc1 lds
  s_mov_b32 m0, 0xc000
  s_add_u32 s48, s45, 0x16000
  s_add_u32 s48, s48, s17
  buffer_load_dwordx4 v2, s[8:11], s48 offen offset:0 sc1 lds
  buffer_load_dwordx4 v2, s[8:11], s48 offen offset:1024 sc1 lds
  s_add_u32 s49, s46, 0x2000
  buffer_load_dwordx2 v[16:17], v7, s[8:11], s49 offen offset:0 sc1
  buffer_load_dwordx2 v[18:19], v7, s[8:11], s49 offen offset:128 sc1
  buffer_load_dwordx2 v[20:21], v7, s[8:11], s49 offen offset:256 sc1
  buffer_load_dwordx2 v[22:23], v7, s[8:11], s49 offen offset:384 sc1
  buffer_load_dwordx2 v[24:25], v7, s[8:11], s49 offen offset:512 sc1
  buffer_load_dwordx2 v[26:27], v7, s[8:11], s49 offen offset:640 sc1
  buffer_load_dwordx2 v[28:29], v7, s[8:11], s49 offen offset:768 sc1
  buffer_load_dwordx2 v[30:31], v7, s[8:11], s49 offen offset:896 sc1
  s_add_u32 s60, s98, 0x400
  buffer_load_dwordx4 v[188:191], v2, s[8:11], s60 offen sc1
  s_add_u32 s60, s98, 0x800
  buffer_load_dwordx4 v[192:195], v2, s[8:11], s60 offen sc1
  s_add_u32 s60, s98, 0xc00
  buffer_load_dwordx4 v[196:199], v2, s[8:11], s60 offen sc1
  s_add_u32 s60, s98, 0x1000
  buffer_load_dwordx4 v[200:203], v2, s[8:11], s60 offen sc1
  s_waitcnt vmcnt(40)
  s_barrier
  s_mov_b32 m0, 0x0
  s_add_u32 s48, s45, 0x14000
  s_add_u32 s48, s48, s18
  buffer_load_dwordx4 v2, s[8:11], s48 offen offset:0 sc1 lds
  buffer_load_dwordx4 v2, s[8:11], s48 offen offset:1024 sc1 lds
  buffer_load_dwordx4 v2, s[8:11], s48 offen offset:2048 sc1 lds
  buffer_load_dwordx4 v2, s[8:11], s48 offen offset:3072 sc1 lds
  s_mov_b32 m0, 0x1000
  s_add_u32 s48, s45, 0x15000
  s_add_u32 s48, s48, s18
  buffer_load_dwordx4 v2, s[8:11], s48 offen offset:0 sc1 lds
  buffer_load_dwordx4 v2, s[8:11], s48 offen offset:1024 sc1 lds
  buffer_load_dwordx4 v2, s[8:11], s48 offen offset:2048 sc1 lds
  buffer_load_dwordx4 v2, s[8:11], s48 offen offset:3072 sc1 lds
  s_mov_b32 m0, 0x2000
  s_add_u32 s48, s45, 0x16000
  s_add_u32 s48, s48, s18
  buffer_load_dwordx4 v2, s[8:11], s48 offen offset:0 sc1 lds
  buffer_load_dwordx4 v2, s[8:11], s48 offen offset:1024 sc1 lds
  s_add_u32 s60, s98, 0x1400
  buffer_load_dwordx4 v[204:207], v2, s[8:11], s60 offen sc1
  s_add_u32 s60, s98, 0x1800
  s_add_u32 s60, s60, s75
  buffer_load_dwordx4 v[208:211], v2, s[8:11], s60 offen sc1
  s_add_u32 s60, s99, 0x0
  s_waitcnt vmcnt(51)
  buffer_load_dwordx4 v[212:215], v2, s[8:11], s60 offen sc1
  s_add_u32 s60, s99, 0x400
  s_waitcnt vmcnt(51)
  buffer_load_dwordx4 v[76:79], v2, s[8:11], s60 offen sc1
  s_waitcnt vmcnt(40)
  s_barrier
  s_mov_b64 exec, 1
  buffer_store_dword v13, v12, s[8:11], s77 offen offset:0 sc1
  s_mov_b64 exec, -1
  s_mov_b32 m0, 0x2800
  s_add_u32 s48, s45, 0x14000
  s_add_u32 s48, s48, s19
  buffer_load_dwordx4 v2, s[8:11], s48 offen offset:0 sc1 lds
  buffer_load_dwordx4 v2, s[8:11], s48 offen offset:1024 sc1 lds
  buffer_load_dwordx4 v2, s[8:11], s48 offen offset:2048 sc1 lds
  buffer_load_dwordx4 v2, s[8:11], s48 offen offset:3072 sc1 lds
  s_mov_b32 m0, 0x3800
  s_add_u32 s48, s45, 0x15000
  s_add_u32 s48, s48, s19
  buffer_load_dwordx4 v2, s[8:11], s48 offen offset:0 sc1 lds
  buffer_load_dwordx4 v2, s[8:11], s48 offen offset:1024 sc1 lds
  buffer_load_dwordx4 v2, s[8:11], s48 offen offset:2048 sc1 lds
  buffer_load_dwordx4 v2, s[8:11], s48 offen offset:3072 sc1 lds
  s_mov_b32 m0, 0x4800
  s_add_u32 s48, s45, 0x16000
  s_add_u32 s48, s48, s19
  buffer_load_dwordx4 v2, s[8:11], s48 offen offset:0 sc1 lds
  buffer_load_dwordx4 v2, s[8:11], s48 offen offset:1024 sc1 lds
  s_add_u32 s60, s99, 0x800
  buffer_load_dwordx4 v[80:83], v2, s[8:11], s60 offen sc1
  s_add_u32 s60, s99, 0xc00
  s_waitcnt vmcnt(51)
  buffer_load_dwordx4 v[84:87], v2, s[8:11], s60 offen sc1
  s_add_u32 s60, s99, 0x1000
  s_waitcnt vmcnt(51)
  buffer_load_dwordx4 v[88:91], v2, s[8:11], s60 offen sc1
  s_add_u32 s60, s99, 0x1400
  s_waitcnt vmcnt(51)
  buffer_load_dwordx4 v[92:95], v2, s[8:11], s60 offen sc1
  s_waitcnt vmcnt(41)
  s_barrier
  s_mov_b32 m0, 0x5000
  s_add_u32 s48, s45, 0x1e000
  s_add_u32 s48, s48, s16
  buffer_load_dwordx4 v2, s[8:11], s48 offen offset:0 sc1 lds
  buffer_load_dwordx4 v2, s[8:11], s48 offen offset:1024 sc1 lds
  buffer_load_dwordx4 v2, s[8:11], s48 offen offset:2048 sc1 lds
  buffer_load_dwordx4 v2, s[8:11], s48 offen offset:3072 sc1 lds
  s_mov_b32 m0, 0x6000
  s_add_u32 s48, s45, 0x1f000
  s_add_u32 s48, s48, s16
  buffer_load_dwordx4 v2, s[8:11], s48 offen offset:0 sc1 lds
  buffer_load_dwordx4 v2, s[8:11], s48 offen offset:1024 sc1 lds
  buffer_load_dwordx4 v2, s[8:11], s48 offen offset:2048 sc1 lds
  buffer_load_dwordx4 v2, s[8:11], s48 offen offset:3072 sc1 lds
  s_mov_b32 m0, 0x7000
  s_add_u32 s48, s45, 0x20000
  s_add_u32 s48, s48, s16
  buffer_load_dwordx4 v2, s[8:11], s48 offen offset:0 sc1 lds
  buffer_load_dwordx4 v2, s[8:11], s48 offen offset:1024 sc1 lds
  s_waitcnt vmcnt(46)
  v_add_f32 v16, v16, v24
  v_add_f32 v17, v17, v25
  s_waitcnt vmcnt(45)
  v_add_f32 v18, v18, v26
  v_add_f32 v19, v19, v27
  s_waitcnt vmcnt(44)
  v_add_f32 v20, v20, v28
  v_add_f32 v21, v21, v29
  s_waitcnt vmcnt(43)
  v_add_f32 v22, v22, v30
  v_add_f32 v23, v23, v31
  v_add_f32 v16, v16, v20
  v_add_f32 v17, v17, v21
  v_add_f32 v18, v18, v22
  v_add_f32 v19, v19, v23
  v_add_f32 v16, v16, v18
  v_add_f32 v17, v17, v19
  v_mov_b32 v18, v16
  v_mov_b32 v19, v17
  s_nop 0
  v_permlane32_swap_b32 v16, v18
  v_permlane32_swap_b32 v17, v19
  v_add_f32 v16, v16, v18
  v_add_f32 v17, v17, v19
  v_mul_f32 v16, s47, v16
  v_mul_f32 v17, s47, v17
  v_fma_f32 v17, -v16, v16, v17
  v_max_f32 v17, 0, v17
  v_add_f32 v17, 0x3727c5ac, v17
  v_rsq_f32 v17, v17
  v_cvt_pk_bf16_f32 v20, -v16, -v16
  v_mov_b32 v21, v20
  v_mov_b32 v22, v20
  v_mov_b32 v23, v20
  ds_write_b128 v2, v[20:23] offset:51200
  ds_write_b32 v4, v17 offset:53504
  s_cmp_lg_u32 s2, 0
  s_cbranch_scc1 LD_nb
  s_mov_b32 s54, 0xfffff
  s_mov_b32 s55, 0xfffff
  s_mov_b32 s51, 0xff0000
  s_add_u32 s29, s50, 0x8000
  s_mov_b64 exec, s[52:53]
  buffer_load_dword v44, v3, s[8:11], s29 offen offset:0 sc1
  s_mov_b64 exec, -1
  s_add_u32 s29, s50, 0xa000
  s_mov_b64 exec, s[52:53]
  buffer_load_dword v45, v3, s[8:11], s29 offen offset:0 sc1
  s_mov_b64 exec, -1
  s_add_u32 s29, s50, 0xc000
  s_mov_b64 exec, s[52:53]
  buffer_load_dword v46, v3, s[8:11], s29 offen offset:0 sc1
  s_mov_b64 exec, -1
  s_add_u32 s29, s50, 0xe000
  s_mov_b64 exec, s[52:53]
  buffer_load_dword v47, v3, s[8:11], s29 offen offset:0 sc1
  s_mov_b64 exec, -1
  s_add_u32 s29, s50, 0x10000
  s_mov_b64 exec, s[52:53]
  buffer_load_dword v48, v3, s[8:11], s29 offen offset:0 sc1
  s_mov_b64 exec, -1
  s_add_u32 s29, s50, 0x12000
  s_mov_b64 exec, s[54:55]
  buffer_load_dword v49, v3, s[8:11], s29 offen offset:0 sc1
  s_mov_b64 exec, -1
  s_add_u32 s29, s50, 0x14000
  s_mov_b64 exec, s[54:55]
  buffer_load_dword v50, v3, s[8:11], s29 offen offset:0 sc1
  s_mov_b64 exec, -1
  s_add_u32 s29, s50, 0x16000
  s_mov_b64 exec, 0xfffff
  buffer_load_dword v51, v3, s[8:11], s29 offen offset:0 sc1
  s_mov_b64 exec, -1
  s_add_u32 s29, s50, 0x8000
  s_mov_b64 exec, s[52:53]
  s_waitcnt vmcnt(7)
  v_cmp_ne_u32 vcc, s27, v44
  s_nop 4
  s_cbranch_vccz Lchk19x
  s_mov_b32 s28, 0
Lchk19:
  s_sleep 16
  buffer_load_dword v44, v3, s[8:11], s29 offen offset:0 sc1
  s_add_u32 s28, s28, 1
  s_waitcnt vmcnt(0)
  s_cmp_gt_u32 s28, 1000000
  s_cbranch_scc1 Lchk19x
  v_cmp_ne_u32 vcc, s27, v44
  s_nop 4
  s_cbranch_vccnz Lchk19
Lchk19x:
  s_mov_b64 exec, -1
  s_add_u32 s29, s50, 0xa000
  s_mov_b64 exec, s[52:53]
  s_waitcnt vmcnt(6)
  v_cmp_ne_u32 vcc, s27, v45
  s_nop 4
  s_cbranch_vccz Lchk20x
  s_mov_b32 s28, 0
Lchk20:
  s_sleep 16
  buffer_load_dword v45, v3, s[8:11], s29 offen offset:0 sc1
  s_add_u32 s28, s28, 1
  s_waitcnt vmcnt(0)
  s_cmp_gt_u32 s28, 1000000
  s_cbranch_scc1 Lchk20x
  v_cmp_ne_u32 vcc, s27, v45
  s_nop 4
  s_cbranch_vccnz Lchk20
Lchk20x:
  s_mov_b64 exec, -1
  s_add_u32 s29, s50, 0xc000
  s_mov_b64 exec, s[52:53]
  s_waitcnt vmcnt(5)
  v_cmp_ne_u32 vcc, s27, v46
  s_nop 4
  s_cbranch_vccz Lchk21x
  s_mov_b32 s28, 0
Lchk21:
  s_sleep 16
  buffer_load_dword v46, v3, s[8:11], s29 offen offset:0 sc1
  s_add_u32 s28, s28, 1
  s_waitcnt vmcnt(0)
  s_cmp_gt_u32 s28, 1000000
  s_cbranch_scc1 Lchk21x
  v_cmp_ne_u32 vcc, s27, v46
  s_nop 4
  s_cbranch_vccnz Lchk21
Lchk21x:
  s_mov_b64 exec, -1
  s_add_u32 s29, s50, 0xe000
  s_mov_b64 exec, s[52:53]
  s_waitcnt vmcnt(4)
  v_cmp_ne_u32 vcc, s27, v47
  s_nop 4
  s_cbranch_vccz Lchk22x
  s_mov_b32 s28, 0
Lchk22:
  s_sleep 16
  buffer_load_dword v47, v3, s[8:11], s29 offen offset:0 sc1
  s_add_u32 s28, s28, 1
  s_waitcnt vmcnt(0)
  s_cmp_gt_u32 s28, 1000000
  s_cbranch_scc1 Lchk22x
  v_cmp_ne_u32 vcc, s27, v47
  s_nop 4
  s_cbranch_vccnz Lchk22
Lchk22x:
  s_mov_b64 exec, -1
  s_add_u32 s29, s50, 0x10000
  s_mov_b64 exec, s[52:53]
  s_waitcnt vmcnt(3)
  v_cmp_ne_u32 vcc, s27, v48
  s_nop 4
  s_cbranch_vccz Lchk23x
  s_mov_b32 s28, 0
Lchk23:
  s_sleep 16
  buffer_load_dword v48, v3, s[8:11], s29 offen offset:0 sc1
  s_add_u32 s28, s28, 1
  s_waitcnt vmcnt(0)
  s_cmp_gt_u32 s28, 1000000
  s_cbranch_scc1 Lchk23x
  v_cmp_ne_u32 vcc, s27, v48
  s_nop 4
  s_cbranch_vccnz Lchk23
Lchk23x:
  s_mov_b64 exec, -1
  s_add_u32 s29, s50, 0x12000
  s_mov_b64 exec, s[54:55]
  s_waitcnt vmcnt(2)
  v_cmp_ne_u32 vcc, s27, v49
  s_nop 4
  s_cbranch_vccz Lchk24x
  s_mov_b32 s28, 0
Lchk24:
  s_sleep 16
  buffer_load_dword v49, v3, s[8:11], s29 offen offset:0 sc1
  s_add_u32 s28, s28, 1
  s_waitcnt vmcnt(0)
  s_cmp_gt_u32 s28, 1000000
  s_cbranch_scc1 Lchk24x
  v_cmp_ne_u32 vcc, s27, v49
  s_nop 4
  s_cbranch_vccnz Lchk24
Lchk24x:
  s_mov_b64 exec, -1
  s_add_u32 s29, s50, 0x14000
  s_mov_b64 exec, s[54:55]
  s_waitcnt vmcnt(1)
  v_cmp_ne_u32 vcc, s27, v50
  s_nop 4
  s_cbranch_vccz Lchk25x
  s_mov_b32 s28, 0
Lchk25:
  s_sleep 16
  buffer_load_dword v50, v3, s[8:11], s29 offen offset:0 sc1
  s_add_u32 s28, s28, 1
  s_waitcnt vmcnt(0)
  s_cmp_gt_u32 s28, 1000000
  s_cbranch_scc1 Lchk25x
  v_cmp_ne_u32 vcc, s27, v50
  s_nop 4
  s_cbranch_vccnz Lchk25
Lchk25x:
  s_mov_b64 exec, -1
  s_add_u32 s29, s50, 0x16000
  s_mov_b64 exec, 0xfffff
  s_waitcnt vmcnt(0)
  v_cmp_ne_u32 vcc, s27, v51
  s_nop 4
  s_cbranch_vccz Lchk26x
  s_mov_b32 s28, 0
Lchk26:
  s_sleep 16
  buffer_load_dword v51, v3, s[8:11], s29 offen offset:0 sc1
  s_add_u32 s28, s28, 1
  s_waitcnt vmcnt(0)
  s_cmp_gt_u32 s28, 1000000
  s_cbranch_scc1 Lchk26x
  v_cmp_ne_u32 vcc, s27, v51
  s_nop 4
  s_cbranch_vccnz Lchk26
Lchk26x:
  s_mov_b64 exec, -1
  s_mov_b64 exec, 1
  buffer_store_dword v13, v12, s[8:11], s51 offen offset:0 sc1
  s_mov_b64 exec, -1
LD_nb:
  s_add_u32 s60, s99, 0x1800
  s_add_u32 s60, s60, s75
  buffer_load_dwordx4 v[96:99], v2, s[8:11], s60 offen sc1
  s_add_u32 s60, s100, 0x0
  buffer_load_dwordx4 v[100:103], v2, s[8:11], s60 offen sc1
  s_add_u32 s60, s100, 0x400
  buffer_load_dwordx4 v[104:107], v2, s[8:11], s60 offen sc1
  s_add_u32 s60, s100, 0x800
  buffer_load_dwordx4 v[108:111], v2, s[8:11], s60 offen sc1
  s_waitcnt vmcnt(33)
  s_waitcnt lgkmcnt(0)
  s_barrier
  s_mov_b32 m0, 0x7800
  s_add_u32 s48, s45, 0x1e000
  s_add_u32 s48, s48, s17
  buffer_load_dwordx4 v2, s[8:11], s48 offen offset:0 sc1 lds
  buffer_load_dwordx4 v2, s[8:11], s48 offen offset:1024 sc1 lds
  buffer_load_dwordx4 v2, s[8:11], s48 offen offset:2048 sc1 lds
  buffer_load_dwordx4 v2, s[8:11], s48 offen offset:3072 sc1 lds
  s_mov_b32 m0, 0x8800
  s_add_u32 s48, s45, 0x1f000
  s_add_u32 s48, s48, s17
  buffer_load_dwordx4 v2, s[8:11], s48 offen offset:0 sc1 lds
  buffer_load_dwordx4 v2, s[8:11], s48 offen offset:1024 sc1 lds
  buffer_load_dwordx4 v2, s[8:11], s48 offen offset:2048 sc1 lds
  buffer_load_dwordx4 v2, s[8:11], s48 offen offset:3072 sc1 lds
  s_mov_b32 m0, 0x9800
  s_add_u32 s48, s45, 0x20000
  s_add_u32 s48, s48, s17
  buffer_load_dwordx4 v2, s[8:11], s48 offen offset:0 sc1 lds
  buffer_load_dwordx4 v2, s[8:11], s48 offen offset:1024 sc1 lds
  s_add_u32 s49, s46, 0x3000
  buffer_load_dwordx2 v[16:17], v7, s[8:11], s49 offen offset:0 sc1
  buffer_load_dwordx2 v[18:19], v7, s[8:11], s49 offen offset:128 sc1
  buffer_load_dwordx2 v[20:21], v7, s[8:11], s49 offen offset:256 sc1
  buffer_load_dwordx2 v[22:23], v7, s[8:11], s49 offen offset:384 sc1
  buffer_load_dwordx2 v[24:25], v7, s[8:11], s49 offen offset:512 sc1
  buffer_load_dwordx2 v[26:27], v7, s[8:11], s49 offen offset:640 sc1
  buffer_load_dwordx2 v[28:29], v7, s[8:11], s49 offen offset:768 sc1
  buffer_load_dwordx2 v[30:31], v7, s[8:11], s49 offen offset:896 sc1
  s_add_u32 s60, s100, 0xc00
  buffer_load_dwordx4 v[112:115], v2, s[8:11], s60 offen sc1
  s_add_u32 s60, s100, 0x1000
  s_waitcnt vmcnt(51)
  buffer_load_dwordx4 v[116:119], v2, s[8:11], s60 offen sc1
  s_add_u32 s60, s100, 0x1400
  s_waitcnt vmcnt(51)
  buffer_load_dwordx4 v[120:123], v2, s[8:11], s60 offen sc1
  s_add_u32 s60, s100, 0x1800
  s_add_u32 s60, s60, s75
  s_waitcnt vmcnt(51)
  buffer_load_dwordx4 v[124:127], v2, s[8:11], s60 offen sc1
  s_waitcnt vmcnt(40)
  s_barrier
  s_mov_b32 m0, 0xa000
  s_add_u32 s48, s45, 0x1e000
  s_add_u32 s48, s48, s18
  buffer_load_dwordx4 v2, s[8:11], s48 offen offset:0 sc1 lds
  buffer_load_dwordx4 v2, s[8:11], s48 offen offset:1024 sc1 lds
  buffer_load_dwordx4 v2, s[8:11], s48 offen offset:2048 sc1 lds
  buffer_load_dwordx4 v2, s[8:11], s48 offen offset:3072 sc1 lds
  s_mov_b32 m0, 0xb000
  s_add_u32 s48, s45, 0x1f000
  s_add_u32 s48, s48, s18
  buffer_load_dwordx4 v2, s[8:11], s48 offen offset:0 sc1 lds
  buffer_load_dwordx4 v2, s[8:11], s48 offen offset:1024 sc1 lds
  buffer_load_dwordx4 v2, s[8:11], s48 offen offset:2048 sc1 lds
  buffer_load_dwordx4 v2, s[8:11], s48 offen offset:3072 sc1 lds
  s_mov_b32 m0, 0xc000
  s_add_u32 s48, s45, 0x20000
  s_add_u32 s48, s48, s18
  buffer_load_dwordx4 v2, s[8:11], s48 offen offset:0 sc1 lds
  buffer_load_dwordx4 v2, s[8:11], s48 offen offset:1024 sc1 lds
  s_add_u32 s60, s101, 0x0
  buffer_load_dwordx4 v[128:131], v2, s[8:11], s60 offen sc1
  s_add_u32 s60, s101, 0x400
  buffer_load_dwordx4 v[132:135], v2, s[8:11], s60 offen sc1
  s_add_u32 s60, s101, 0x800
  s_waitcnt vmcnt(51)
  buffer_load_dwordx4 v[136:139], v2, s[8:11], s60 offen sc1
  s_add_u32 s60, s101, 0xc00
  s_waitcnt vmcnt(51)
  buffer_load_dwordx4 v[140:143], v2, s[8:11], s60 offen sc1
  s_waitcnt vmcnt(40)
  s_barrier
  s_add_u32 s29, s77, 0x800
  s_mov_b64 exec, 1
  buffer_store_dword v13, v12, s[8:11], s29 offen offset:0 sc1
  s_mov_b64 exec, -1
  s_mov_b32 m0, 0x0
  s_add_u32 s48, s45, 0x1e000
  s_add_u32 s48, s48, s19
  buffer_load_dwordx4 v2, s[8:11], s48 offen offset:0 sc1 lds
  buffer_load_dwordx4 v2, s[8:11], s48 offen offset:1024 sc1 lds
  buffer_load_dwordx4 v2, s[8:11], s48 offen offset:2048 sc1 lds
  buffer_load_dwordx4 v2, s[8:11], s48 offen offset:3072 sc1 lds
  s_mov_b32 m0, 0x1000
  s_add_u32 s48, s45, 0x1f000
  s_add_u32 s48, s48, s19
  buffer_load_dwordx4 v2, s[8:11], s48 offen offset:0 sc1 lds
  buffer_load_dwordx4 v2, s[8:11], s48 offen offset:1024 sc1 lds
  buffer_load_dwordx4 v2, s[8:11], s48 offen offset:2048 sc1 lds
  buffer_load_dwordx4 v2, s[8:11], s48 offen offset:3072 sc1 lds
  s_mov_b32 m0, 0x2000
  s_add_u32 s48, s45, 0x20000
  s_add_u32 s48, s48, s19
  buffer_load_dwordx4 v2, s[8:11], s48 offen offset:0 sc1 lds
  buffer_load_dwordx4 v2, s[8:11], s48 offen offset:1024 sc1 lds
  s_add_u32 s60, s101, 0x1000
  buffer_load_dwordx4 v[144:147], v2, s[8:11], s60 offen sc1
  s_add_u32 s60, s101, 0x1400
  s_waitcnt vmcnt(51)
  buffer_load_dwordx4 v[148:151], v2, s[8:11], s60 offen sc1
  s_add_u32 s60, s101, 0x1800
  s_add_u32 s60, s60, s75
  s_waitcnt vmcnt(51)
  buffer_load_dwordx4 v[152:155], v2, s[8:11], s60 offen sc1
  s_waitcnt vmcnt(40)
  s_barrier
  s_waitcnt vmcnt(35)
  v_add_f32 v16, v16, v24
  v_add_f32 v17, v17, v25
  s_waitcnt vmcnt(34)
  v_add_f32 v18, v18, v26
  v_add_f32 v19, v19, v27
  s_waitcnt vmcnt(33)
  v_add_f32 v20, v20, v28
  v_add_f32 v21, v21, v29
  s_waitcnt vmcnt(32)
  v_add_f32 v22, v22, v30
  v_add_f32 v23, v23, v31
  v_add_f32 v16, v16, v20
  v_add_f32 v17, v17, v21
  v_add_f32 v18, v18, v22
  v_add_f32 v19, v19, v23
  v_add_f32 v16, v16, v18
  v_add_f32 v17, v17, v19
  v_mov_b32 v18, v16
  v_mov_b32 v19, v17
  s_nop 0
  v_permlane32_swap_b32 v16, v18
  v_permlane32_swap_b32 v17, v19
  v_add_f32 v16, v16, v18
  v_add_f32 v17, v17, v19
  v_mul_f32 v16, s47, v16
  v_mul_f32 v17, s47, v17
  v_fma_f32 v17, -v16, v16, v17
  v_max_f32 v17, 0, v17
  v_add_f32 v17, 0x3727c5ac, v17
  v_rsq_f32 v17, v17
  v_cvt_pk_bf16_f32 v20, -v16, -v16
  v_mov_b32 v21, v20
  v_mov_b32 v22, v20
  v_mov_b32 v23, v20
  ds_write_b128 v2, v[20:23] offset:52224
  ds_write_b32 v4, v17 offset:53632
  s_waitcnt vmcnt(18)
  s_waitcnt lgkmcnt(0)
  s_barrier
  s_mov_b32 s66, 0xe000e000
  s_mov_b32 s67, 0
  s_mov_b64 exec, s[66:67]
  buffer_load_dword v11, v3, s[8:11], s78 offen offset:0 sc1
  s_mov_b64 exec, -1
  s_waitcnt vmcnt(4)
  s_barrier
  s_mov_b64 exec, s[66:67]
  s_waitcnt vmcnt(0)
  v_cmp_ne_u32 vcc, s27, v11
  s_nop 4
  s_cbranch_vccz Lchk27x
  s_mov_b32 s28, 0
Lchk27:
  s_sleep 2
  buffer_load_dword v11, v3, s[8:11], s78 offen offset:0 sc1
  s_add_u32 s28, s28, 1
  s_waitcnt vmcnt(0)
  s_cmp_gt_u32 s28, 1000000
  s_cbranch_scc1 Lchk27x
  v_cmp_ne_u32 vcc, s27, v11
  s_nop 4
  s_cbranch_vccnz Lchk27
Lchk27x:
  s_mov_b64 exec, -1
  v_lshrrev_b32 v15, 4, v1
  v_xor_b32 v14, v1, v15
  s_lshl_b32 s61, s26, 10
  v_lshlrev_b32 v8, 4, v14
  v_add_u32 v8, s61, v8
  v_cmp_le_u32 vcc, 20, v1
  s_nop 1
  v_cndmask_b32 v14, 0, 1, vcc
  v_mul_u32_u24 v15, 20, v14
  v_sub_u32 v15, v1, v15
  v_mul_u32_u24 v5, 1280, v14
  v_lshl_add_u32 v5, v15, 3, v5
  v_lshrrev_b32 v9, 1, v15
  v_lshlrev_b32 v6, 9, v9
  v_lshl_add_u32 v6, v14, 4, v6
  v_and_b32 v9, 1, v15
  v_lshl_add_u32 v6, v9, 3, v6
  s_lshl_b32 s61, s26, 1
  v_add_u32 v14, s61, v14
  v_xor_b32 v14, v14, v15
  v_and_b32 v14, 15, v14
  v_lshlrev_b32 v14, 4, v14
  v_lshrrev_b32 v9, 2, v15
  v_lshlrev_b32 v9, 13, v9
  v_add_u32 v9, v9, v14
  v_and_b32 v14, 3, v15
  v_lshl_add_u32 v9, v14, 8, v9
  v_mov_b32 v14, 0x7f000000
  v_cmp_gt_u32 vcc, 40, v1
  s_nop 1
  v_cndmask_b32 v5, v14, v5, vcc
  v_cndmask_b32 v6, v14, v6, vcc
  v_cndmask_b32 v9, 0, v9, vcc
  s_add_u32 s61, s42, 0x0
  buffer_load_dwordx4 v[216:219], v2, s[8:11], s61 offen sc1
  s_add_u32 s61, s42, 0x400
  buffer_load_dwordx4 v[220:223], v2, s[8:11], s61 offen sc1
  s_add_u32 s61, s42, 0x800
  buffer_load_dwordx4 v[224:227], v2, s[8:11], s61 offen sc1
  s_add_u32 s61, s42, 0xc00
  buffer_load_dwordx4 v[228:231], v2, s[8:11], s61 offen sc1
  s_add_u32 s61, s42, 0x1000
  buffer_load_dwordx4 v[48:51], v2, s[8:11], s61 offen sc1
  s_add_u32 s61, s42, 0x1400
  buffer_load_dwordx4 v[52:55], v2, s[8:11], s61 offen sc1
  s_add_u32 s61, s42, 0x1800
  s_add_u32 s61, s61, s75
  buffer_load_dwordx4 v[56:59], v2, s[8:11], s61 offen sc1
  s_add_u32 s61, s42, 0x1b000
  buffer_load_dwordx4 v[60:63], v2, s[8:11], s61 offen sc1
  s_add_u32 s61, s42, 0x1b400
  buffer_load_dwordx4 v[64:67], v2, s[8:11], s61 offen sc1
  s_add_u32 s61, s42, 0x1b800
  buffer_load_dwordx4 v[68:71], v2, s[8:11], s61 offen sc1
  s_add_u32 s61, s42, 0x1bc00
  buffer_load_dwordx4 v[16:19], v2, s[8:11], s61 offen sc1
  s_add_u32 s61, s42, 0x1c000
  buffer_load_dwordx4 v[20:23], v2, s[8:11], s61 offen sc1
  s_add_u32 s61, s42, 0x1c400
  buffer_load_dwordx4 v[24:27], v2, s[8:11], s61 offen sc1
  s_add_u32 s61, s42, 0x1c800
  s_add_u32 s61, s61, s75
  buffer_load_dwordx4 v[28:31], v2, s[8:11], s61 offen sc1
  s_setprio 0
  v_lshlrev_b32 v3, 7, v1
  s_lshl_b32 s49, s26, 1
  s_lshl_b32 s49, 3, s49
  s_cmp_eq_u32 s26, 7
  s_cselect_b32 s49, 0xe000, s49
  s_lshl_b32 s51, s49, 16
  s_mov_b32 s48, 0
  s_mov_b32 s50, 0
  buffer_load_dwordx2 v[252:253], v6, s[8:11], s30 offen sc1
  s_waitcnt vmcnt(14)
  v_mfma_f32_16x16x32_bf16 v[232:235], v[156:159], v[216:219], 0
  s_waitcnt vmcnt(13)
  v_mfma_f32_16x16x32_bf16 v[232:235], v[160:163], v[220:223], v[232:235]
  s_waitcnt vmcnt(12)
  v_mfma_f32_16x16x32_bf16 v[232:235], v[164:167], v[224:227], v[232:235]
  s_waitcnt vmcnt(11)
  v_mfma_f32_16x16x32_bf16 v[232:235], v[168:171], v[228:231], v[232:235]
  s_waitcnt vmcnt(10)
  v_mfma_f32_16x16x32_bf16 v[232:235], v[172:175], v[48:51], v[232:235]
  s_waitcnt vmcnt(9)
  v_mfma_f32_16x16x32_bf16 v[232:235], v[176:179], v[52:55], v[232:235]
  s_waitcnt vmcnt(8)
  v_mfma_f32_16x16x32_bf16 v[232:235], v[180:183], v[56:59], v[232:235]
  v_mfma_f32_16x16x32_bf16 v[236:239], v[184:187], v[216:219], 0
  v_mfma_f32_16x16x32_bf16 v[236:239], v[188:191], v[220:223], v[236:239]
  v_mfma_f32_16x16x32_bf16 v[236:239], v[192:195], v[224:227], v[236:239]
  v_mfma_f32_16x16x32_bf16 v[236:239], v[196:199], v[228:231], v[236:239]
  v_mfma_f32_16x16x32_bf16 v[236:239], v[200:203], v[48:51], v[236:239]
  v_mfma_f32_16x16x32_bf16 v[236:239], v[204:207], v[52:55], v[236:239]
  v_mfma_f32_16x16x32_bf16 v[236:239], v[208:211], v[56:59], v[236:239]
  s_barrier
  v_xor_b32 v4, 0x0, v8
  ds_write_b128 v4, v[232:235] offset:0
  v_mfma_f32_16x16x32_bf16 v[240:243], v[212:215], v[216:219], 0
  v_mfma_f32_16x16x32_bf16 v[240:243], v[76:79], v[220:223], v[240:243]
  v_mfma_f32_16x16x32_bf16 v[240:243], v[80:83], v[224:227], v[240:243]
  v_mfma_f32_16x16x32_bf16 v[240:243], v[84:87], v[228:231], v[240:243]
  v_xor_b32 v4, 0x40, v8
  ds_write_b128 v4, v[236:239] offset:8192
  v_mfma_f32_16x16x32_bf16 v[240:243], v[88:91], v[48:51], v[240:243]
  v_mfma_f32_16x16x32_bf16 v[240:243], v[92:95], v[52:55], v[240:243]
  v_mfma_f32_16x16x32_bf16 v[240:243], v[96:99], v[56:59], v[240:243]
  s_mov_b64 exec, s[48:49]
  buffer_load_dword v7, v3, s[8:11], s78 offen offset:0 sc1
  s_mov_b64 exec, -1
  v_mfma_f32_16x16x32_bf16 v[232:235], v[100:103], v[216:219], 0
  v_mfma_f32_16x16x32_bf16 v[232:235], v[104:107], v[220:223], v[232:235]
  v_mfma_f32_16x16x32_bf16 v[232:235], v[108:111], v[224:227], v[232:235]
  v_mfma_f32_16x16x32_bf16 v[232:235], v[112:115], v[228:231], v[232:235]
  v_xor_b32 v4, 0x80, v8
  ds_write_b128 v4, v[240:243] offset:16384
  v_mfma_f32_16x16x32_bf16 v[232:235], v[116:119], v[48:51], v[232:235]
  v_mfma_f32_16x16x32_bf16 v[232:235], v[120:123], v[52:55], v[232:235]
  v_mfma_f32_16x16x32_bf16 v[232:235], v[124:127], v[56:59], v[232:235]
  v_mfma_f32_16x16x32_bf16 v[236:239], v[128:131], v[216:219], 0
  v_mfma_f32_16x16x32_bf16 v[236:239], v[132:135], v[220:223], v[236:239]
  v_mfma_f32_16x16x32_bf16 v[236:239], v[136:139], v[224:227], v[236:239]
  v_mfma_f32_16x16x32_bf16 v[236:239], v[140:143], v[228:231], v[236:239]
  v_xor_b32 v4, 0xc0, v8
  s_nop 2
  ds_write_b128 v4, v[232:235] offset:24576
  v_mfma_f32_16x16x32_bf16 v[236:239], v[144:147], v[48:51], v[236:239]
  v_mfma_f32_16x16x32_bf16 v[236:239], v[148:151], v[52:55], v[236:239]
  v_mfma_f32_16x16x32_bf16 v[236:239], v[152:155], v[56:59], v[236:239]
  buffer_load_dwordx2 v[254:255], v6, s[8:11], s31 offen sc1
  s_mov_b64 exec, s[48:49]
  s_waitcnt vmcnt(1)
  v_cmp_ne_u32 vcc, s27, v7
  s_nop 4
  s_cbranch_vccz Lchk28x
  s_mov_b32 s28, 0
Lchk28:
  s_sleep 2
  buffer_load_dword v7, v3, s[8:11], s78 offen offset:0 sc1
  s_add_u32 s28, s28, 1
  s_waitcnt vmcnt(0)
  s_cmp_gt_u32 s28, 1000000
  s_cbranch_scc1 Lchk28x
  v_cmp_ne_u32 vcc, s27, v7
  s_nop 4
  s_cbranch_vccnz Lchk28
Lchk28x:
  s_mov_b64 exec, -1
  v_mfma_f32_16x16x32_bf16 v[240:243], v[156:159], v[60:63], 0
  v_mfma_f32_16x16x32_bf16 v[240:243], v[160:163], v[64:67], v[240:243]
  s_add_u32 s61, s42, 0x36000
  buffer_load_dwordx4 v[216:219], v2, s[8:11], s61 offen sc1
  v_mfma_f32_16x16x32_bf16 v[240:243], v[164:167], v[68:71], v[240:243]
  v_mfma_f32_16x16x32_bf16 v[240:243], v[168:171], v[16:19], v[240:243]
  v_xor_b32 v4, 0x8000, v8
  ds_write_b128 v4, v[236:239] offset:0
  s_add_u32 s61, s42, 0x36400
  buffer_load_dwordx4 v[220:223], v2, s[8:11], s61 offen sc1
  v_mfma_f32_16x16x32_bf16 v[240:243], v[172:175], v[20:23], v[240:243]
  v_mfma_f32_16x16x32_bf16 v[240:243], v[176:179], v[24:27], v[240:243]
  s_add_u32 s61, s42, 0x36800
  buffer_load_dwordx4 v[224:227], v2, s[8:11], s61 offen sc1
  v_mfma_f32_16x16x32_bf16 v[240:243], v[180:183], v[28:31], v[240:243]
  s_waitcnt lgkmcnt(0)
  s_barrier
  ds_read_b128 v[32:35], v9 offset:0
  ds_read_b128 v[36:39], v9 offset:1024
  ds_read_b128 v[40:43], v9 offset:2048
  ds_read_b128 v[44:47], v9 offset:3072
  v_mfma_f32_16x16x32_bf16 v[232:235], v[184:187], v[60:63], 0
  s_add_u32 s61, s42, 0x36c00
  buffer_load_dwordx4 v[228:231], v2, s[8:11], s61 offen sc1
  v_lshlrev_b32 v72, 16, v252
  v_and_b32 v73, s63, v252
  v_mfma_f32_16x16x32_bf16 v[232:235], v[188:191], v[64:67], v[232:235]
  v_lshlrev_b32 v74, 16, v253
  v_and_b32 v75, s63, v253
  v_mfma_f32_16x16x32_bf16 v[232:235], v[192:195], v[68:71], v[232:235]
  s_add_u32 s61, s42, 0x37000
  buffer_load_dwordx4 v[48:51], v2, s[8:11], s61 offen sc1
  v_mfma_f32_16x16x32_bf16 v[232:235], v[196:199], v[16:19], v[232:235]
  v_xor_b32 v4, 0x8000, v8
  ds_write_b128 v4, v[240:243] offset:8192
  s_waitcnt lgkmcnt(4)
  v_add_f32 v72, v72, v32
  v_add_f32 v73, v73, v33
  v_mfma_f32_16x16x32_bf16 v[232:235], v[200:203], v[20:23], v[232:235]
  s_add_u32 s61, s42, 0x37400
  buffer_load_dwordx4 v[52:55], v2, s[8:11], s61 offen sc1
  v_add_f32 v74, v74, v34
  v_add_f32 v75, v75, v35
  ds_read_b128 v[32:35], v9 offset:4096
  v_mfma_f32_16x16x32_bf16 v[232:235], v[204:207], v[24:27], v[232:235]
  s_waitcnt lgkmcnt(4)
  v_add_f32 v72, v72, v36
  v_add_f32 v73, v73, v37
  v_mfma_f32_16x16x32_bf16 v[232:235], v[208:211], v[28:31], v[232:235]
  s_add_u32 s61, s42, 0x37800
  s_add_u32 s61, s61, s75
  buffer_load_dwordx4 v[56:59], v2, s[8:11], s61 offen sc1
  v_add_f32 v74, v74, v38
  v_add_f32 v75, v75, v39
  ds_read_b128 v[36:39], v9 offset:5120
  v_mfma_f32_16x16x32_bf16 v[236:239], v[212:215], v[60:63], 0
  s_waitcnt lgkmcnt(4)
  v_add_f32 v72, v72, v40
  v_add_f32 v73, v73, v41
  v_mfma_f32_16x16x32_bf16 v[236:239], v[76:79], v[64:67], v[236:239]
  v_add_f32 v74, v74, v42
  v_add_f32 v75, v75, v43
  ds_read_b128 v[40:43], v9 offset:6144
  v_mfma_f32_16x16x32_bf16 v[236:239], v[80:83], v[68:71], v[236:239]
  s_waitcnt lgkmcnt(4)
  v_add_f32 v72, v72, v44
  v_add_f32 v73, v73, v45
  v_mfma_f32_16x16x32_bf16 v[236:239], v[84:87], v[16:19], v[236:239]
  v_xor_b32 v4, 0x8040, v8
  ds_write_b128 v4, v[232:235] offset:16384
  v_add_f32 v74, v74, v46
  v_add_f32 v75, v75, v47
  ds_read_b128 v[44:47], v9 offset:7168
  v_mfma_f32_16x16x32_bf16 v[236:239], v[88:91], v[20:23], v[236:239]
  s_waitcnt lgkmcnt(4)
  v_add_f32 v72, v72, v32
  v_add_f32 v73, v73, v33
  v_mfma_f32_16x16x32_bf16 v[236:239], v[92:95], v[24:27], v[236:239]
  v_add_f32 v74, v74, v34
  v_add_f32 v75, v75, v35
  v_mfma_f32_16x16x32_bf16 v[236:239], v[96:99], v[28:31], v[236:239]
  s_waitcnt lgkmcnt(3)
  v_add_f32 v72, v72, v36
  v_add_f32 v73, v73, v37
  s_mov_b64 exec, s[50:51]
  buffer_load_dword v7, v3, s[8:11], s78 offen offset:0 sc1
  s_mov_b64 exec, -1
  v_mfma_f32_16x16x32_bf16 v[240:243], v[100:103], v[60:63], 0
  v_add_f32 v74, v74, v38
  v_add_f32 v75, v75, v39
  v_mfma_f32_16x16x32_bf16 v[240:243], v[104:107], v[64:67], v[240:243]
  s_waitcnt lgkmcnt(2)
  v_add_f32 v72, v72, v40
  v_add_f32 v73, v73, v41
  v_mfma_f32_16x16x32_bf16 v[240:243], v[108:111], v[68:71], v[240:243]
  v_add_f32 v74, v74, v42
  v_add_f32 v75, v75, v43
  v_mfma_f32_16x16x32_bf16 v[240:243], v[112:115], v[16:19], v[240:243]
  v_xor_b32 v4, 0x8080, v8
  ds_write_b128 v4, v[236:239] offset:24576
  s_waitcnt lgkmcnt(1)
  v_add_f32 v72, v72, v44
  v_add_f32 v73, v73, v45
  v_mfma_f32_16x16x32_bf16 v[240:243], v[116:119], v[20:23], v[240:243]
  v_add_f32 v74, v74, v46
  v_add_f32 v75, v75, v47
  v_mfma_f32_16x16x32_bf16 v[240:243], v[120:123], v[24:27], v[240:243]
  v_cvt_pk_bf16_f32 v14, v72, v73
  v_cvt_pk_bf16_f32 v15, v74, v75
  buffer_store_dwordx2 v[14:15], v5, s[12:15], s34 offen
  v_mfma_f32_16x16x32_bf16 v[240:243], v[124:127], v[28:31], v[240:243]
  v_mfma_f32_16x16x32_bf16 v[232:235], v[128:131], v[60:63], 0
  v_mfma_f32_16x16x32_bf16 v[232:235], v[132:135], v[64:67], v[232:235]
  v_mfma_f32_16x16x32_bf16 v[232:235], v[136:139], v[68:71], v[232:235]
  v_mfma_f32_16x16x32_bf16 v[232:235], v[140:143], v[16:19], v[232:235]
  v_xor_b32 v4, 0x100c0, v8
  s_nop 2
  ds_write_b128 v4, v[240:243] offset:0
  v_mfma_f32_16x16x32_bf16 v[232:235], v[144:147], v[20:23], v[232:235]
  v_mfma_f32_16x16x32_bf16 v[232:235], v[148:151], v[24:27], v[232:235]
  v_mfma_f32_16x16x32_bf16 v[232:235], v[152:155], v[28:31], v[232:235]
  buffer_load_dwordx2 v[252:253], v6, s[8:11], s32 offen sc1
  s_mov_b64 exec, s[50:51]
  s_waitcnt vmcnt(2)
  v_cmp_ne_u32 vcc, s27, v7
  s_nop 4
  s_cbranch_vccz Lchk29x
  s_mov_b32 s28, 0
Lchk29:
  s_sleep 2
  buffer_load_dword v7, v3, s[8:11], s78 offen offset:0 sc1
  s_add_u32 s28, s28, 1
  s_waitcnt vmcnt(0)
  s_cmp_gt_u32 s28, 1000000
  s_cbranch_scc1 Lchk29x
  v_cmp_ne_u32 vcc, s27, v7
  s_nop 4
  s_cbranch_vccnz Lchk29
Lchk29x:
  s_mov_b64 exec, -1
  v_mfma_f32_16x16x32_bf16 v[236:239], v[156:159], v[216:219], 0
  v_mfma_f32_16x16x32_bf16 v[236:239], v[160:163], v[220:223], v[236:239]
  s_add_u32 s61, s42, 0x51000
  buffer_load_dwordx4 v[60:63], v2, s[8:11], s61 offen sc1
  v_mfma_f32_16x16x32_bf16 v[236:239], v[164:167], v[224:227], v[236:239]
  v_mfma_f32_16x16x32_bf16 v[236:239], v[168:171], v[228:231], v[236:239]
  v_xor_b32 v4, 0x10000, v8
  ds_write_b128 v4, v[232:235] offset:8192
  s_add_u32 s61, s42, 0x51400
  buffer_load_dwordx4 v[64:67], v2, s[8:11], s61 offen sc1
  v_mfma_f32_16x16x32_bf16 v[236:239], v[172:175], v[48:51], v[236:239]
  v_mfma_f32_16x16x32_bf16 v[236:239], v[176:179], v[52:55], v[236:239]
  s_add_u32 s61, s42, 0x51800
  buffer_load_dwordx4 v[68:71], v2, s[8:11], s61 offen sc1
  v_mfma_f32_16x16x32_bf16 v[236:239], v[180:183], v[56:59], v[236:239]
  s_waitcnt lgkmcnt(0)
  s_barrier
  ds_read_b128 v[32:35], v9 offset:40960
  ds_read_b128 v[36:39], v9 offset:41984
  ds_read_b128 v[40:43], v9 offset:43008
  ds_read_b128 v[44:47], v9 offset:44032
  v_mfma_f32_16x16x32_bf16 v[240:243], v[184:187], v[216:219], 0
  s_add_u32 s61, s42, 0x51c00
  buffer_load_dwordx4 v[16:19], v2, s[8:11], s61 offen sc1
  v_lshlrev_b32 v72, 16, v254
  v_and_b32 v73, s63, v254
  v_mfma_f32_16x16x32_bf16 v[240:243], v[188:191], v[220:223], v[240:243]
  v_lshlrev_b32 v74, 16, v255
  v_and_b32 v75, s63, v255
  v_mfma_f32_16x16x32_bf16 v[240:243], v[192:195], v[224:227], v[240:243]
  s_add_u32 s61, s42, 0x52000
  buffer_load_dwordx4 v[20:23], v2, s[8:11], s61 offen sc1
  v_mfma_f32_16x16x32_bf16 v[240:243], v[196:199], v[228:231], v[240:243]
  v_xor_b32 v4, 0x0, v8
  ds_write_b128 v4, v[236:239] offset:0
  s_waitcnt lgkmcnt(4)
  v_add_f32 v72, v72, v32
  v_add_f32 v73, v73, v33
  v_mfma_f32_16x16x32_bf16 v[240:243], v[200:203], v[48:51], v[240:243]
  s_add_u32 s61, s42, 0x52400
  buffer_load_dwordx4 v[24:27], v2, s[8:11], s61 offen sc1
  v_add_f32 v74, v74, v34
  v_add_f32 v75, v75, v35
  ds_read_b128 v[32:35], v9 offset:45056
  v_mfma_f32_16x16x32_bf16 v[240:243], v[204:207], v[52:55], v[240:243]
  s_waitcnt lgkmcnt(4)
  v_add_f32 v72, v72, v36
  v_add_f32 v73, v73, v37
  v_mfma_f32_16x16x32_bf16 v[240:243], v[208:211], v[56:59], v[240:243]
  s_add_u32 s61, s42, 0x52800
  s_add_u32 s61, s61, s75
  buffer_load_dwordx4 v[28:31], v2, s[8:11], s61 offen sc1
  v_add_f32 v74, v74, v38
  v_add_f32 v75, v75, v39
  ds_read_b128 v[36:39], v9 offset:46080
  v_mfma_f32_16x16x32_bf16 v[232:235], v[212:215], v[216:219], 0
  s_waitcnt lgkmcnt(4)
  v_add_f32 v72, v72, v40
  v_add_f32 v73, v73, v41
  v_mfma_f32_16x16x32_bf16 v[232:235], v[76:79], v[220:223], v[232:235]
  v_add_f32 v74, v74, v42
  v_add_f32 v75, v75, v43
  ds_read_b128 v[40:43], v9 offset:47104
  v_mfma_f32_16x16x32_bf16 v[232:235], v[80:83], v[224:227], v[232:235]
  s_waitcnt lgkmcnt(4)
  v_add_f32 v72, v72, v44
  v_add_f32 v73, v73, v45
  v_mfma_f32_16x16x32_bf16 v[232:235], v[84:87], v[228:231], v[232:235]
  v_xor_b32 v4, 0x40, v8
  ds_write_b128 v4, v[240:243] offset:8192
  v_add_f32 v74, v74, v46
  v_add_f32 v75, v75, v47
  ds_read_b128 v[44:47], v9 offset:48128
  v_mfma_f32_16x16x32_bf16 v[232:235], v[88:91], v[48:51], v[232:235]
  s_waitcnt lgkmcnt(4)
  v_add_f32 v72, v72, v32
  v_add_f32 v73, v73, v33
  v_mfma_f32_16x16x32_bf16 v[232:235], v[92:95], v[52:55], v[232:235]
  v_add_f32 v74, v74, v34
  v_add_f32 v75, v75, v35
  v_mfma_f32_16x16x32_bf16 v[232:235], v[96:99], v[56:59], v[232:235]
  s_waitcnt lgkmcnt(3)
  v_add_f32 v72, v72, v36
  v_add_f32 v73, v73, v37
  v_mfma_f32_16x16x32_bf16 v[236:239], v[100:103], v[216:219], 0
  v_add_f32 v74, v74, v38
  v_add_f32 v75, v75, v39
  v_mfma_f32_16x16x32_bf16 v[236:239], v[104:107], v[220:223], v[236:239]
  s_waitcnt lgkmcnt(2)
  v_add_f32 v72, v72, v40
  v_add_f32 v73, v73, v41
  v_mfma_f32_16x16x32_bf16 v[236:239], v[108:111], v[224:227], v[236:239]
  v_add_f32 v74, v74, v42
  v_add_f32 v75, v75, v43
  v_mfma_f32_16x16x32_bf16 v[236:239], v[112:115], v[228:231], v[236:239]
  v_xor_b32 v4, 0x80, v8
  ds_write_b128 v4, v[232:235] offset:16384
  s_waitcnt lgkmcnt(1)
  v_add_f32 v72, v72, v44
  v_add_f32 v73, v73, v45
  v_mfma_f32_16x16x32_bf16 v[236:239], v[116:119], v[48:51], v[236:239]
  v_add_f32 v74, v74, v46
  v_add_f32 v75, v75, v47
  v_mfma_f32_16x16x32_bf16 v[236:239], v[120:123], v[52:55], v[236:239]
  v_cvt_pk_bf16_f32 v14, v72, v73
  v_cvt_pk_bf16_f32 v15, v74, v75
  buffer_store_dwordx2 v[14:15], v5, s[12:15], s35 offen
  v_mfma_f32_16x16x32_bf16 v[236:239], v[124:127], v[56:59], v[236:239]
  v_mfma_f32_16x16x32_bf16 v[240:243], v[128:131], v[216:219], 0
  v_mfma_f32_16x16x32_bf16 v[240:243], v[132:135], v[220:223], v[240:243]
  v_mfma_f32_16x16x32_bf16 v[240:243], v[136:139], v[224:227], v[240:243]
  v_mfma_f32_16x16x32_bf16 v[240:243], v[140:143], v[228:231], v[240:243]
  v_xor_b32 v4, 0xc0, v8
  s_nop 2
  ds_write_b128 v4, v[236:239] offset:24576
  v_mfma_f32_16x16x32_bf16 v[240:243], v[144:147], v[48:51], v[240:243]
  v_mfma_f32_16x16x32_bf16 v[240:243], v[148:151], v[52:55], v[240:243]
  v_mfma_f32_16x16x32_bf16 v[240:243], v[152:155], v[56:59], v[240:243]
  buffer_load_dwordx2 v[254:255], v6, s[8:11], s33 offen sc1
  s_waitcnt vmcnt(8)
  v_mfma_f32_16x16x32_bf16 v[232:235], v[156:159], v[60:63], 0
  s_waitcnt vmcnt(7)
  v_mfma_f32_16x16x32_bf16 v[232:235], v[160:163], v[64:67], v[232:235]
  s_waitcnt vmcnt(6)
  v_mfma_f32_16x16x32_bf16 v[232:235], v[164:167], v[68:71], v[232:235]
  s_waitcnt vmcnt(5)
  v_mfma_f32_16x16x32_bf16 v[232:235], v[168:171], v[16:19], v[232:235]
  v_xor_b32 v4, 0x8000, v8
  ds_write_b128 v4, v[240:243] offset:0
  s_waitcnt vmcnt(4)
  v_mfma_f32_16x16x32_bf16 v[232:235], v[172:175], v[20:23], v[232:235]
  s_waitcnt vmcnt(3)
  v_mfma_f32_16x16x32_bf16 v[232:235], v[176:179], v[24:27], v[232:235]
  s_waitcnt vmcnt(2)
  v_mfma_f32_16x16x32_bf16 v[232:235], v[180:183], v[28:31], v[232:235]
  s_waitcnt lgkmcnt(0)
  s_barrier
  ds_read_b128 v[32:35], v9 offset:0
  ds_read_b128 v[36:39], v9 offset:1024
  ds_read_b128 v[40:43], v9 offset:2048
  ds_read_b128 v[44:47], v9 offset:3072
  v_mfma_f32_16x16x32_bf16 v[236:239], v[184:187], v[60:63], 0
  v_lshlrev_b32 v72, 16, v252
  v_and_b32 v73, s63, v252
  v_mfma_f32_16x16x32_bf16 v[236:239], v[188:191], v[64:67], v[236:239]
  v_lshlrev_b32 v74, 16, v253
  v_and_b32 v75, s63, v253
  v_mfma_f32_16x16x32_bf16 v[236:239], v[192:195], v[68:71], v[236:239]
  v_mfma_f32_16x16x32_bf16 v[236:239], v[196:199], v[16:19], v[236:239]
  v_xor_b32 v4, 0x8000, v8
  ds_write_b128 v4, v[232:235] offset:8192
  s_waitcnt lgkmcnt(4)
  v_add_f32 v72, v72, v32
  v_add_f32 v73, v73, v33
  v_mfma_f32_16x16x32_bf16 v[236:239], v[200:203], v[20:23], v[236:239]
  v_add_f32 v74, v74, v34
  v_add_f32 v75, v75, v35
  ds_read_b128 v[32:35], v9 offset:4096
  v_mfma_f32_16x16x32_bf16 v[236:239], v[204:207], v[24:27], v[236:239]
  s_waitcnt lgkmcnt(4)
  v_add_f32 v72, v72, v36
  v_add_f32 v73, v73, v37
  v_mfma_f32_16x16x32_bf16 v[236:239], v[208:211], v[28:31], v[236:239]
  v_add_f32 v74, v74, v38
  v_add_f32 v75, v75, v39
  ds_read_b128 v[36:39], v9 offset:5120
  v_mfma_f32_16x16x32_bf16 v[240:243], v[212:215], v[60:63], 0
  s_waitcnt lgkmcnt(4)
  v_add_f32 v72, v72, v40
  v_add_f32 v73, v73, v41
  v_mfma_f32_16x16x32_bf16 v[240:243], v[76:79], v[64:67], v[240:243]
  v_add_f32 v74, v74, v42
  v_add_f32 v75, v75, v43
  ds_read_b128 v[40:43], v9 offset:6144
  v_mfma_f32_16x16x32_bf16 v[240:243], v[80:83], v[68:71], v[240:243]
  s_waitcnt lgkmcnt(4)
  v_add_f32 v72, v72, v44
  v_add_f32 v73, v73, v45
  v_mfma_f32_16x16x32_bf16 v[240:243], v[84:87], v[16:19], v[240:243]
  v_xor_b32 v4, 0x8040, v8
  ds_write_b128 v4, v[236:239] offset:16384
  v_add_f32 v74, v74, v46
  v_add_f32 v75, v75, v47
  ds_read_b128 v[44:47], v9 offset:7168
  v_mfma_f32_16x16x32_bf16 v[240:243], v[88:91], v[20:23], v[240:243]
  s_waitcnt lgkmcnt(4)
  v_add_f32 v72, v72, v32
  v_add_f32 v73, v73, v33
  v_mfma_f32_16x16x32_bf16 v[240:243], v[92:95], v[24:27], v[240:243]
  v_add_f32 v74, v74, v34
  v_add_f32 v75, v75, v35
  v_mfma_f32_16x16x32_bf16 v[240:243], v[96:99], v[28:31], v[240:243]
  s_waitcnt lgkmcnt(3)
  v_add_f32 v72, v72, v36
  v_add_f32 v73, v73, v37
  v_mfma_f32_16x16x32_bf16 v[232:235], v[100:103], v[60:63], 0
  v_add_f32 v74, v74, v38
  v_add_f32 v75, v75, v39
  v_mfma_f32_16x16x32_bf16 v[232:235], v[104:107], v[64:67], v[232:235]
  s_waitcnt lgkmcnt(2)
  v_add_f32 v72, v72, v40
  v_add_f32 v73, v73, v41
  v_mfma_f32_16x16x32_bf16 v[232:235], v[108:111], v[68:71], v[232:235]
  v_add_f32 v74, v74, v42
  v_add_f32 v75, v75, v43
  v_mfma_f32_16x16x32_bf16 v[232:235], v[112:115], v[16:19], v[232:235]
  v_xor_b32 v4, 0x8080, v8
  ds_write_b128 v4, v[240:243] offset:24576
  s_waitcnt lgkmcnt(1)
  v_add_f32 v72, v72, v44
  v_add_f32 v73, v73, v45
  v_mfma_f32_16x16x32_bf16 v[232:235], v[116:119], v[20:23], v[232:235]
  v_add_f32 v74, v74, v46
  v_add_f32 v75, v75, v47
  v_mfma_f32_16x16x32_bf16 v[232:235], v[120:123], v[24:27], v[232:235]
  v_cvt_pk_bf16_f32 v14, v72, v73
  v_cvt_pk_bf16_f32 v15, v74, v75
  buffer_store_dwordx2 v[14:15], v5, s[12:15], s36 offen
  v_mfma_f32_16x16x32_bf16 v[232:235], v[124:127], v[28:31], v[232:235]
  v_mfma_f32_16x16x32_bf16 v[236:239], v[128:131], v[60:63], 0
  v_mfma_f32_16x16x32_bf16 v[236:239], v[132:135], v[64:67], v[236:239]
  v_mfma_f32_16x16x32_bf16 v[236:239], v[136:139], v[68:71], v[236:239]
  v_mfma_f32_16x16x32_bf16 v[236:239], v[140:143], v[16:19], v[236:239]
  v_xor_b32 v4, 0x100c0, v8
  s_nop 2
  ds_write_b128 v4, v[232:235] offset:0
  v_mfma_f32_16x16x32_bf16 v[236:239], v[144:147], v[20:23], v[236:239]
  v_mfma_f32_16x16x32_bf16 v[236:239], v[148:151], v[24:27], v[236:239]
  v_mfma_f32_16x16x32_bf16 v[236:239], v[152:155], v[28:31], v[236:239]
  v_xor_b32 v4, 0x10000, v8
  s_nop 6
  ds_write_b128 v4, v[236:239] offset:8192
  s_waitcnt lgkmcnt(0)
  s_barrier
  ds_read_b128 v[32:35], v9 offset:40960
  ds_read_b128 v[36:39], v9 offset:41984
  ds_read_b128 v[40:43], v9 offset:43008
  ds_read_b128 v[44:47], v9 offset:44032
  s_waitcnt vmcnt(1)
  v_lshlrev_b32 v72, 16, v254
  v_and_b32 v73, s63, v254
  v_lshlrev_b32 v74, 16, v255
  v_and_b32 v75, s63, v255
  s_waitcnt lgkmcnt(3)
  v_add_f32 v72, v72, v32
  v_add_f32 v73, v73, v33
  v_add_f32 v74, v74, v34
  v_add_f32 v75, v75, v35
  ds_read_b128 v[32:35], v9 offset:45056
  s_waitcnt lgkmcnt(3)
  v_add_f32 v72, v72, v36
  v_add_f32 v73, v73, v37
  v_add_f32 v74, v74, v38
  v_add_f32 v75, v75, v39
  ds_read_b128 v[36:39], v9 offset:46080
  s_waitcnt lgkmcnt(3)
  v_add_f32 v72, v72, v40
  v_add_f32 v73, v73, v41
  v_add_f32 v74, v74, v42
  v_add_f32 v75, v75, v43
  ds_read_b128 v[40:43], v9 offset:47104
  s_waitcnt lgkmcnt(3)
  v_add_f32 v72, v72, v44
  v_add_f32 v73, v73, v45
  v_add_f32 v74, v74, v46
  v_add_f32 v75, v75, v47
  ds_read_b128 v[44:47], v9 offset:48128
  s_waitcnt lgkmcnt(3)
  v_add_f32 v72, v72, v32
  v_add_f32 v73, v73, v33
  v_add_f32 v74, v74, v34
  v_add_f32 v75, v75, v35
  s_waitcnt lgkmcnt(2)
  v_add_f32 v72, v72, v36
  v_add_f32 v73, v73, v37
  v_add_f32 v74, v74, v38
  v_add_f32 v75, v75, v39
  s_waitcnt lgkmcnt(1)
  v_add_f32 v72, v72, v40
  v_add_f32 v73, v73, v41
  v_add_f32 v74, v74, v42
  v_add_f32 v75, v75, v43
  s_waitcnt lgkmcnt(0)
  v_add_f32 v72, v72, v44
  v_add_f32 v73, v73, v45
  v_add_f32 v74, v74, v46
  v_add_f32 v75, v75, v47
  v_cvt_pk_bf16_f32 v14, v72, v73
  v_cvt_pk_bf16_f32 v15, v74, v75
  buffer_store_dwordx2 v[14:15], v5, s[12:15], s37 offen
LE_done:
Lk_end:
  s_endpgm
Lk_endcode:
.section .rodata,"a"
.p2align 6
.amdhsa_kernel sequential_preLN__sliding_block__glu_gated_glu__prompt_kernel
  .amdhsa_next_free_vgpr 256
  .amdhsa_next_free_sgpr 102
  .amdhsa_accum_offset 256
  .amdhsa_group_segment_fixed_size 0
  .amdhsa_kernarg_size 80
  .amdhsa_user_sgpr_count 2
  .amdhsa_user_sgpr_kernarg_segment_ptr 1
  .amdhsa_system_sgpr_workgroup_id_x 1
.end_amdhsa_kernel
```
